```python
import torch

def _softmax(x, axis=-1):
    return torch.softmax(x, dim=axis)

def _gelu(x):
    return torch.nn.functional.gelu(x, approximate='tanh')

def _silu(x):
    return torch.nn.functional.silu(x)

def _sigmoid(x):
    return torch.sigmoid(x)

def _layernorm(x, axis=-1, eps=1e-05):
    m = x.mean(dim=axis, keepdim=True)
    v = x.var(dim=axis, keepdim=True, unbiased=False)
    return (x - m) / torch.sqrt(v + eps)

def _scatter_add(tgt, idx, src, axis=0):
    return tgt.clone().index_add_(axis, idx, src)

def _segment_sum(src, seg, n):
    out = torch.zeros((n,) + src.shape[1:], dtype=src.dtype)
    return out.index_add_(0, seg, src)

def _pad(x, pw):
    flat = tuple((v for pair in reversed(pw) for v in pair))
    return torch.nn.functional.pad(x, flat)
kernel_name = 'gated_mix__memory_aug_recurrent_mem_tr__grouped_kv_mqa__prompt'

def setup_inputs():

    _w = lambda a: (lambda t: t.to(torch.bfloat16) if t.is_floating_point() else t)(torch.as_tensor(a))

    def _A_setup():
        B, S, Dm = (1, 2048, 1024)
        H, Dh = (32, 128)
        M, seg = (8, 32)
        seg = min(seg, S)
        S = S // seg * seg
        return {'x': _w((lambda *s: torch.randn(*s, dtype=torch.bfloat16) * 0.05)(B, S, Dm)), 'mem0': _w((lambda *s: torch.randn(*s, dtype=torch.bfloat16) * 0.4)(B, M, Dm)), 'Wq': _w((lambda *s: torch.randn(*s, dtype=torch.bfloat16) * 6.4)(Dm, H, Dh) * Dm ** (-0.5)), 'Wk': _w((lambda *s: torch.randn(*s, dtype=torch.bfloat16) * 6.4)(Dm, H, Dh) * Dm ** (-0.5)), 'Wv': _w((lambda *s: torch.randn(*s, dtype=torch.bfloat16) * 0.4)(Dm, H, Dh) * Dm ** (-0.5)), 'Wo': _w((lambda *s: torch.randn(*s, dtype=torch.bfloat16) * 0.4)(H, Dh, Dm) * (H * Dh) ** (-0.5)), 'seg_len': seg}
    _A_in = _A_setup()

    def _B_setup():
        B, S, D, H = (1, 2048, 1024, 32)
        Dh = D // H
        return {'x': _w((lambda *s: torch.randn(*s, dtype=torch.bfloat16) * 0.05)(B, S, D)), 'wq': _w((lambda *s: torch.randn(*s, dtype=torch.bfloat16) * 0.8)(D, H * Dh)), 'wk': _w((lambda *s: torch.randn(*s, dtype=torch.bfloat16) * 0.8)(D, Dh)), 'wv': _w((lambda *s: torch.randn(*s, dtype=torch.bfloat16) * 0.05)(D, Dh)), 'wo': _w((lambda *s: torch.randn(*s, dtype=torch.bfloat16) * 0.05)(H * Dh, D))}
    _B_in = _B_setup()
    return {'A_x': _A_in['x'], 'A_mem0': _A_in['mem0'], 'A_Wq': _A_in['Wq'], 'A_Wk': _A_in['Wk'], 'A_Wv': _A_in['Wv'], 'A_Wo': _A_in['Wo'], 'A_seg_len': _A_in['seg_len'], 'B_x': _B_in['x'], 'B_wq': _B_in['wq'], 'B_wk': _B_in['wk'], 'B_wv': _B_in['wv'], 'B_wo': _B_in['wo'], 'gate_w': _w((lambda *s: torch.randn(*s, dtype=torch.bfloat16) * 0.05)(1024) * 16.0)}

def reference(A_x, A_mem0, A_Wq, A_Wk, A_Wv, A_Wo, A_seg_len, B_x, B_wq, B_wk, B_wv, B_wo, gate_w):

    def _A_ref(x, mem0, Wq, Wk, Wv, Wo, seg_len):
        B, S, Dm = x.shape
        H, Dh = (Wq.shape[1], Wq.shape[2])
        M = mem0.shape[1]
        scale = Dh ** (-0.5)
        n_seg = S // seg_len
        L = M + seg_len
        idx = torch.arange(L)
        mask = (idx[:, None] < M) | (idx[:, None] >= idx[None, :])
        mem = mem0
        outs = []
        for s in range(n_seg):
            xs = x[:, s * seg_len:(s + 1) * seg_len, :].clone()
            h = torch.concatenate([mem, xs], axis=1)
            q = torch.einsum('btd,dhe->bhte', h, Wq)
            k = torch.einsum('btd,dhe->bhte', h, Wk)
            v = torch.einsum('btd,dhe->bhte', h, Wv)
            scores = torch.einsum('bhqe,bhke->bhqk', q, k) * scale
            scores = torch.where(mask[None, None], scores, -1000000000.0)
            p = _softmax(scores, axis=-1)
            o = torch.einsum('bhqk,bhke->bhqe', p, v)
            o = torch.einsum('bhte,hed->btd', o, Wo)
            mem = o[:, :M, :].clone()
            outs.append(o[:, M:, :])
        return torch.concatenate(outs, axis=1)

    def _B_ref(x, wq, wk, wv, wo):
        B, S, D = x.shape
        H = 32
        Dh = D // H
        q = (lambda x, *d: x.permute(*d))((x @ wq).reshape(B, S, H, Dh), 0, 2, 1, 3)
        k = x @ wk
        v = x @ wv
        scores = torch.einsum('bhqd,bkd->bhqk', q, k) * Dh ** (-0.5)
        p = _softmax(scores, axis=-1)
        o = torch.einsum('bhqk,bkd->bhqd', p, v)
        return (lambda x, *d: x.permute(*d))(o, 0, 2, 1, 3).reshape(B, S, H * Dh) @ wo
    x = A_x
    g = _sigmoid((x * gate_w).sum(-1, keepdims=True))
    a = _A_ref(x, A_mem0, A_Wq, A_Wk, A_Wv, A_Wo, A_seg_len)
    b = _B_ref(x, B_wq, B_wk, B_wv, B_wo)
    return g * a + (1 - g) * b
```

```asm
; @launch grid=(256,1,1) block=(256,1,1) lds=163840
.amdgcn_target "amdgcn-amd-amdhsa--gfx950"
.text
.globl gated_mix__memory_aug_recurrent_mem_tr__grouped_kv_mqa__prompt_kernel
.p2align 8
.type gated_mix__memory_aug_recurrent_mem_tr__grouped_kv_mqa__prompt_kernel,@function
gated_mix__memory_aug_recurrent_mem_tr__grouped_kv_mqa__prompt_kernel:
s_load_dwordx2 s[8:9], s[0:1], 0
s_load_dwordx2 s[12:13], s[0:1], 8
s_load_dwordx2 s[16:17], s[0:1], 16
s_load_dwordx2 s[20:21], s[0:1], 24
s_load_dwordx2 s[24:25], s[0:1], 32
s_load_dwordx2 s[28:29], s[0:1], 40
s_load_dwordx2 s[32:33], s[0:1], 64
s_load_dwordx2 s[36:37], s[0:1], 72
s_load_dwordx2 s[40:41], s[0:1], 80
s_load_dwordx2 s[44:45], s[0:1], 88
s_load_dwordx2 s[48:49], s[0:1], 96
s_load_dwordx2 s[52:53], s[0:1], 104
s_load_dwordx2 s[56:57], s[0:1], 112
s_load_dwordx2 s[60:61], s[0:1], 120
s_waitcnt lgkmcnt(0)
s_mov_b32 s10, 4194304
s_mov_b32 s11, 0x20000
s_mov_b32 s14, 16384
s_mov_b32 s15, 0x20000
s_mov_b32 s18, 8388608
s_mov_b32 s19, 0x20000
s_mov_b32 s22, 8388608
s_mov_b32 s23, 0x20000
s_mov_b32 s26, 8388608
s_mov_b32 s27, 0x20000
s_mov_b32 s30, 8388608
s_mov_b32 s31, 0x20000
s_mov_b32 s34, 2097152
s_mov_b32 s35, 0x20000
s_mov_b32 s38, 65536
s_mov_b32 s39, 0x20000
s_mov_b32 s42, 65536
s_mov_b32 s43, 0x20000
s_mov_b32 s46, 2097152
s_mov_b32 s47, 0x20000
s_mov_b32 s50, 2048
s_mov_b32 s51, 0x20000
s_mov_b32 s54, 4194304
s_mov_b32 s55, 0x20000
s_mov_b32 s58, 256
s_mov_b32 s59, 0x20000
s_mov_b32 s62, 268435456
s_mov_b32 s63, 0x20000
s_cmp_ge_u32 s2, 256
s_cbranch_scc1 L_exit
v_lshrrev_b32 v1, 6, v0
v_and_b32 v0, 63, v0
s_getreg_b32 s3, hwreg(HW_REG_XCC_ID, 0, 3)
v_readfirstlane_b32 s65, v1
s_lshl_b32 s4, s3, 2
v_mov_b32 v2, 0
v_mov_b32 v62, 0
s_cmp_eq_u32 s65, 0
s_cbranch_scc1 L_role_t
s_branch L_role_b0
L_role_t:
s_mov_b64 exec, 1
v_mov_b32 v1, 1
buffer_atomic_add v1, v2, s[56:59], s4 offen sc0 sc1
s_waitcnt vmcnt(0)
ds_write_b32 v2, v1
s_mov_b64 exec, -1
L_role_b0:
s_waitcnt lgkmcnt(0)
s_barrier
ds_read_b32 v1, v2
s_waitcnt lgkmcnt(0)
v_readfirstlane_b32 s7, v1
s_barrier
s_lshl_b32 s64, s3, 5
s_add_u32 s64, s64, s7
s_mov_b32 s90, 2
s_cmp_ge_u32 s7, 32
s_cbranch_scc1 L_role_all
s_cmp_lt_u32 s64, 64
s_cbranch_scc1 L_chain
s_cmp_lt_u32 s64, 0
s_cbranch_scc1 L_worker
L_role_all:
s_getreg_b32 s3, hwreg(HW_REG_XCC_ID, 0, 3)
v_mov_b32 v2, 0
s_cmp_lg_u32 s65, 0
s_cbranch_scc1 L_role_wait
s_mov_b64 exec, 1
v_mov_b32 v1, s7
s_mov_b32 s78, 0
L_role_poll:
buffer_load_dwordx4 v[4:7], v2, s[56:59], 0 offen sc1
buffer_load_dwordx4 v[8:11], v2, s[56:59], 0 offen offset:16 sc1
s_waitcnt vmcnt(0)
v_add3_u32 v3, v4, v5, v6
v_add3_u32 v3, v3, v7, v8
v_add3_u32 v3, v3, v9, v10
v_add_u32 v3, v3, v11
s_add_u32 s78, s78, 1
v_readfirstlane_b32 s5, v3
s_cmp_gt_u32 s78, 0x40000
s_cbranch_scc1 L_role_go
s_cmp_lt_u32 s5, 256
s_cbranch_scc1 L_role_poll
L_role_go:
s_cmp_gt_u32 s3, 0
s_cselect_b32 s5, -1, 0
v_and_b32 v3, s5, v4
v_add_u32 v1, v1, v3
s_cmp_gt_u32 s3, 1
s_cselect_b32 s5, -1, 0
v_and_b32 v3, s5, v5
v_add_u32 v1, v1, v3
s_cmp_gt_u32 s3, 2
s_cselect_b32 s5, -1, 0
v_and_b32 v3, s5, v6
v_add_u32 v1, v1, v3
s_cmp_gt_u32 s3, 3
s_cselect_b32 s5, -1, 0
v_and_b32 v3, s5, v7
v_add_u32 v1, v1, v3
s_cmp_gt_u32 s3, 4
s_cselect_b32 s5, -1, 0
v_and_b32 v3, s5, v8
v_add_u32 v1, v1, v3
s_cmp_gt_u32 s3, 5
s_cselect_b32 s5, -1, 0
v_and_b32 v3, s5, v9
v_add_u32 v1, v1, v3
s_cmp_gt_u32 s3, 6
s_cselect_b32 s5, -1, 0
v_and_b32 v3, s5, v10
v_add_u32 v1, v1, v3
v_xor_b32 v4, 32, v4
v_xor_b32 v5, 32, v5
v_or_b32 v3, v4, v5
v_mov_b32 v4, v1
v_mov_b32 v5, v3
v_mov_b32 v2, 163832
ds_write_b64 v2, v[4:5]
s_mov_b64 exec, -1
L_role_wait:
s_waitcnt lgkmcnt(0)
s_barrier
v_mov_b32 v2, 163832
ds_read_b64 v[4:5], v2
s_waitcnt lgkmcnt(0)
v_readfirstlane_b32 s6, v4
v_readfirstlane_b32 s5, v5
s_barrier
s_cmp_eq_u32 s90, 3
s_cselect_b32 s4, s64, -1
s_mov_b32 s90, 0
s_cmp_eq_u32 s5, 0
s_cselect_b32 s66, 1, 0
s_mov_b32 s64, s6
s_cmp_lg_u32 s4, s64
s_cbranch_scc1 L_disp
s_cmp_ge_u32 s64, 64
s_cbranch_scc1 L_epi_v
s_branch L_ch_const
L_disp:
s_cmp_ge_u32 s64, 64
s_cbranch_scc1 L_worker
L_chain:
s_lshr_b32 s72, s64, 5
s_and_b32 s73, s64, 31
s_lshr_b32 s74, s64, 1
s_and_b32 s75, s64, 1
v_lshlrev_b32 v2, 4, v0
v_and_b32 v10, 15, v0
v_lshrrev_b32 v11, 4, v0
v_and_b32 v12, 7, v0
v_bfe_u32 v13, v0, 3, 1
v_lshrrev_b32 v14, 3, v0
v_lshrrev_b32 v15, 5, v0
s_and_b32 s69, s65, 2
v_add_u32 v15, s69, v15
v_lshlrev_b32 v15, 1, v15
v_xor_b32 v15, v15, v12
v_lshlrev_b32 v15, 4, v15
v_lshl_add_u32 v14, v14, 13, v15
s_lshl_b32 s69, s64, 7
s_lshl_b32 s70, s65, 16
s_add_u32 s69, s69, s70
v_add_u32 v14, s69, v14
v_lshrrev_b32 v16, 2, v0
v_and_b32 v15, 3, v0
v_lshlrev_b32 v15, 4, v15
v_lshl_add_u32 v16, v16, 11, v15
s_lshl_b32 s69, s72, 22
s_lshl_b32 s70, s65, 20
s_add_u32 s69, s69, s70
s_lshl_b32 s70, s73, 6
s_add_u32 s69, s69, s70
v_add_u32 v16, s69, v16
v_lshrrev_b32 v17, 1, v11
v_lshlrev_b32 v17, 4, v17
v_and_b32 v18, 1, v11
v_lshl_add_u32 v17, v18, 2, v17
v_lshl_add_u32 v17, v13, 3, v17
v_bfe_u32 v18, v0, 2, 1
v_add_u32 v17, v17, v18
v_and_b32 v19, 3, v0
v_lshlrev_b32 v19, 3, v19
v_lshl_add_u32 v20, v17, 6, v19
s_lshl_b32 s69, s65, 13
v_add_u32 v20, s69, v20
v_and_b32 v18, 1, v11
v_lshrrev_b32 v17, 1, v11
v_lshlrev_b32 v17, 3, v17
v_lshl_add_u32 v17, v18, 4, v17
v_lshl_add_u32 v17, v13, 2, v17
v_bfe_u32 v21, v0, 2, 1
v_add_u32 v17, v17, v21
v_lshl_add_u32 v18, v18, 1, v13
v_xor_b32 v18, s65, v18
v_lshl_add_u32 v18, v18, 5, v19
v_lshl_add_u32 v18, v17, 7, v18
s_add_u32 s69, s65, 0
s_and_b32 s69, s69, 3
s_lshl_b32 s69, s69, 13
v_add_u32 v24, s69, v18
s_add_u32 s69, s65, 1
s_and_b32 s69, s69, 3
s_lshl_b32 s69, s69, 13
v_add_u32 v25, s69, v18
s_add_u32 s69, s65, 2
s_and_b32 s69, s69, 3
s_lshl_b32 s69, s69, 13
v_add_u32 v26, s69, v18
s_add_u32 s69, s65, 3
s_and_b32 s69, s69, 3
s_lshl_b32 s69, s69, 13
v_add_u32 v27, s69, v18
s_lshl_b32 s69, s65, 10
s_add_u32 m0, s69, 98304
s_mov_b32 s70, 0
buffer_load_dwordx4 v14, s[16:19], s70 offen lds
s_lshl_b32 s69, s65, 10
s_add_u32 m0, s69, 102400
s_mov_b32 s70, 262144
buffer_load_dwordx4 v14, s[16:19], s70 offen lds
s_lshl_b32 s69, s65, 10
s_add_u32 m0, s69, 106496
s_mov_b32 s70, 524288
buffer_load_dwordx4 v14, s[16:19], s70 offen lds
s_lshl_b32 s69, s65, 10
s_add_u32 m0, s69, 110592
s_mov_b32 s70, 786432
buffer_load_dwordx4 v14, s[16:19], s70 offen lds
s_lshl_b32 s69, s65, 10
s_add_u32 m0, s69, 114688
s_mov_b32 s70, 1048576
buffer_load_dwordx4 v14, s[16:19], s70 offen lds
s_lshl_b32 s69, s65, 10
s_add_u32 m0, s69, 118784
s_mov_b32 s70, 1310720
buffer_load_dwordx4 v14, s[16:19], s70 offen lds
s_lshl_b32 s69, s65, 10
s_add_u32 m0, s69, 122880
s_mov_b32 s70, 1572864
buffer_load_dwordx4 v14, s[16:19], s70 offen lds
s_lshl_b32 s69, s65, 10
s_add_u32 m0, s69, 126976
s_mov_b32 s70, 1835008
buffer_load_dwordx4 v14, s[16:19], s70 offen lds
s_lshl_b32 s69, s65, 10
s_add_u32 m0, s69, 131072
s_mov_b32 s70, 2097152
buffer_load_dwordx4 v14, s[16:19], s70 offen lds
s_lshl_b32 s69, s65, 10
s_add_u32 m0, s69, 135168
s_mov_b32 s70, 2359296
buffer_load_dwordx4 v14, s[16:19], s70 offen lds
s_lshl_b32 s69, s65, 10
s_add_u32 m0, s69, 139264
s_mov_b32 s70, 2621440
buffer_load_dwordx4 v14, s[16:19], s70 offen lds
s_lshl_b32 s69, s65, 10
s_add_u32 m0, s69, 143360
s_mov_b32 s70, 2883584
buffer_load_dwordx4 v14, s[16:19], s70 offen lds
s_lshl_b32 s69, s65, 10
s_add_u32 m0, s69, 147456
s_mov_b32 s70, 3145728
buffer_load_dwordx4 v14, s[16:19], s70 offen lds
s_lshl_b32 s69, s65, 10
s_add_u32 m0, s69, 151552
s_mov_b32 s70, 3407872
buffer_load_dwordx4 v14, s[16:19], s70 offen lds
s_lshl_b32 s69, s65, 10
s_add_u32 m0, s69, 155648
s_mov_b32 s70, 3670016
buffer_load_dwordx4 v14, s[16:19], s70 offen lds
s_lshl_b32 s69, s65, 10
s_add_u32 m0, s69, 159744
s_mov_b32 s70, 3932160
buffer_load_dwordx4 v14, s[16:19], s70 offen lds
s_lshl_b32 s69, s65, 10
s_add_u32 m0, s69, 0
s_mov_b32 s70, 4194304
buffer_load_dwordx4 v14, s[16:19], s70 offen lds
s_lshl_b32 s69, s65, 10
s_add_u32 m0, s69, 4096
s_mov_b32 s70, 4456448
buffer_load_dwordx4 v14, s[16:19], s70 offen lds
s_lshl_b32 s69, s65, 10
s_add_u32 m0, s69, 8192
s_mov_b32 s70, 4718592
buffer_load_dwordx4 v14, s[16:19], s70 offen lds
s_lshl_b32 s69, s65, 10
s_add_u32 m0, s69, 12288
s_mov_b32 s70, 4980736
buffer_load_dwordx4 v14, s[16:19], s70 offen lds
s_lshl_b32 s69, s65, 10
s_add_u32 m0, s69, 16384
s_mov_b32 s70, 5242880
buffer_load_dwordx4 v14, s[16:19], s70 offen lds
s_lshl_b32 s69, s65, 10
s_add_u32 m0, s69, 20480
s_mov_b32 s70, 5505024
buffer_load_dwordx4 v14, s[16:19], s70 offen lds
s_lshl_b32 s69, s65, 10
s_add_u32 m0, s69, 24576
s_mov_b32 s70, 5767168
buffer_load_dwordx4 v14, s[16:19], s70 offen lds
s_lshl_b32 s69, s65, 10
s_add_u32 m0, s69, 28672
s_mov_b32 s70, 6029312
buffer_load_dwordx4 v14, s[16:19], s70 offen lds
s_lshl_b32 s69, s65, 10
s_add_u32 m0, s69, 32768
s_mov_b32 s70, 6291456
buffer_load_dwordx4 v14, s[16:19], s70 offen lds
s_lshl_b32 s69, s65, 10
s_add_u32 m0, s69, 36864
s_mov_b32 s70, 6553600
buffer_load_dwordx4 v14, s[16:19], s70 offen lds
s_lshl_b32 s69, s65, 10
s_add_u32 m0, s69, 40960
s_mov_b32 s70, 6815744
buffer_load_dwordx4 v14, s[16:19], s70 offen lds
s_lshl_b32 s69, s65, 10
s_add_u32 m0, s69, 45056
s_mov_b32 s70, 7077888
buffer_load_dwordx4 v14, s[16:19], s70 offen lds
s_lshl_b32 s69, s65, 10
s_add_u32 m0, s69, 49152
s_mov_b32 s70, 7340032
buffer_load_dwordx4 v14, s[16:19], s70 offen lds
s_lshl_b32 s69, s65, 10
s_add_u32 m0, s69, 53248
s_mov_b32 s70, 7602176
buffer_load_dwordx4 v14, s[16:19], s70 offen lds
s_lshl_b32 s69, s65, 10
s_add_u32 m0, s69, 57344
s_mov_b32 s70, 7864320
buffer_load_dwordx4 v14, s[16:19], s70 offen lds
s_lshl_b32 s69, s65, 10
s_add_u32 m0, s69, 61440
s_mov_b32 s70, 8126464
buffer_load_dwordx4 v14, s[16:19], s70 offen lds
s_waitcnt vmcnt(24)
s_barrier
s_lshl_b32 s69, s65, 10
s_add_u32 m0, s69, 65536
s_mov_b32 s70, 0
buffer_load_dwordx4 v14, s[20:23], s70 offen lds
s_lshl_b32 s69, s65, 10
s_add_u32 m0, s69, 69632
s_mov_b32 s70, 262144
buffer_load_dwordx4 v14, s[20:23], s70 offen lds
s_lshl_b32 s69, s65, 10
s_add_u32 m0, s69, 73728
s_mov_b32 s70, 524288
buffer_load_dwordx4 v14, s[20:23], s70 offen lds
s_lshl_b32 s69, s65, 10
s_add_u32 m0, s69, 77824
s_mov_b32 s70, 786432
buffer_load_dwordx4 v14, s[20:23], s70 offen lds
s_lshl_b32 s69, s65, 10
s_add_u32 m0, s69, 81920
s_mov_b32 s70, 1048576
buffer_load_dwordx4 v14, s[20:23], s70 offen lds
s_lshl_b32 s69, s65, 10
s_add_u32 m0, s69, 86016
s_mov_b32 s70, 1310720
buffer_load_dwordx4 v14, s[20:23], s70 offen lds
s_lshl_b32 s69, s65, 10
s_add_u32 m0, s69, 90112
s_mov_b32 s70, 1572864
buffer_load_dwordx4 v14, s[20:23], s70 offen lds
s_lshl_b32 s69, s65, 10
s_add_u32 m0, s69, 94208
s_mov_b32 s70, 1835008
buffer_load_dwordx4 v14, s[20:23], s70 offen lds
s_mov_b32 s69, 98304
v_add_u32 v21, s69, v24
ds_read_b64_tr_b16 a[0:1], v21 offset:0
ds_read_b64_tr_b16 a[2:3], v21 offset:256
ds_read_b64_tr_b16 a[4:5], v21 offset:4096
ds_read_b64_tr_b16 a[6:7], v21 offset:4352
v_add_u32 v21, s69, v25
ds_read_b64_tr_b16 a[8:9], v21 offset:0
ds_read_b64_tr_b16 a[10:11], v21 offset:256
ds_read_b64_tr_b16 a[12:13], v21 offset:4096
ds_read_b64_tr_b16 a[14:15], v21 offset:4352
v_add_u32 v21, s69, v26
ds_read_b64_tr_b16 a[16:17], v21 offset:0
ds_read_b64_tr_b16 a[18:19], v21 offset:256
ds_read_b64_tr_b16 a[20:21], v21 offset:4096
ds_read_b64_tr_b16 a[22:23], v21 offset:4352
v_add_u32 v21, s69, v27
ds_read_b64_tr_b16 a[24:25], v21 offset:0
ds_read_b64_tr_b16 a[26:27], v21 offset:256
ds_read_b64_tr_b16 a[28:29], v21 offset:4096
ds_read_b64_tr_b16 a[30:31], v21 offset:4352
s_waitcnt lgkmcnt(0)
s_waitcnt vmcnt(24)
s_barrier
s_lshl_b32 s69, s65, 10
s_add_u32 m0, s69, 98304
s_mov_b32 s70, 2097152
buffer_load_dwordx4 v14, s[20:23], s70 offen lds
s_lshl_b32 s69, s65, 10
s_add_u32 m0, s69, 102400
s_mov_b32 s70, 2359296
buffer_load_dwordx4 v14, s[20:23], s70 offen lds
s_lshl_b32 s69, s65, 10
s_add_u32 m0, s69, 106496
s_mov_b32 s70, 2621440
buffer_load_dwordx4 v14, s[20:23], s70 offen lds
s_lshl_b32 s69, s65, 10
s_add_u32 m0, s69, 110592
s_mov_b32 s70, 2883584
buffer_load_dwordx4 v14, s[20:23], s70 offen lds
s_lshl_b32 s69, s65, 10
s_add_u32 m0, s69, 114688
s_mov_b32 s70, 3145728
buffer_load_dwordx4 v14, s[20:23], s70 offen lds
s_lshl_b32 s69, s65, 10
s_add_u32 m0, s69, 118784
s_mov_b32 s70, 3407872
buffer_load_dwordx4 v14, s[20:23], s70 offen lds
s_lshl_b32 s69, s65, 10
s_add_u32 m0, s69, 122880
s_mov_b32 s70, 3670016
buffer_load_dwordx4 v14, s[20:23], s70 offen lds
s_lshl_b32 s69, s65, 10
s_add_u32 m0, s69, 126976
s_mov_b32 s70, 3932160
buffer_load_dwordx4 v14, s[20:23], s70 offen lds
s_mov_b32 s69, 131072
v_add_u32 v21, s69, v24
ds_read_b64_tr_b16 a[32:33], v21 offset:0
ds_read_b64_tr_b16 a[34:35], v21 offset:256
ds_read_b64_tr_b16 a[36:37], v21 offset:4096
ds_read_b64_tr_b16 a[38:39], v21 offset:4352
v_add_u32 v21, s69, v25
ds_read_b64_tr_b16 a[40:41], v21 offset:0
ds_read_b64_tr_b16 a[42:43], v21 offset:256
ds_read_b64_tr_b16 a[44:45], v21 offset:4096
ds_read_b64_tr_b16 a[46:47], v21 offset:4352
v_add_u32 v21, s69, v26
ds_read_b64_tr_b16 a[48:49], v21 offset:0
ds_read_b64_tr_b16 a[50:51], v21 offset:256
ds_read_b64_tr_b16 a[52:53], v21 offset:4096
ds_read_b64_tr_b16 a[54:55], v21 offset:4352
v_add_u32 v21, s69, v27
ds_read_b64_tr_b16 a[56:57], v21 offset:0
ds_read_b64_tr_b16 a[58:59], v21 offset:256
ds_read_b64_tr_b16 a[60:61], v21 offset:4096
ds_read_b64_tr_b16 a[62:63], v21 offset:4352
s_waitcnt lgkmcnt(0)
s_waitcnt vmcnt(24)
s_barrier
s_lshl_b32 s69, s65, 10
s_add_u32 m0, s69, 131072
s_mov_b32 s70, 4194304
buffer_load_dwordx4 v14, s[20:23], s70 offen lds
s_lshl_b32 s69, s65, 10
s_add_u32 m0, s69, 135168
s_mov_b32 s70, 4456448
buffer_load_dwordx4 v14, s[20:23], s70 offen lds
s_lshl_b32 s69, s65, 10
s_add_u32 m0, s69, 139264
s_mov_b32 s70, 4718592
buffer_load_dwordx4 v14, s[20:23], s70 offen lds
s_lshl_b32 s69, s65, 10
s_add_u32 m0, s69, 143360
s_mov_b32 s70, 4980736
buffer_load_dwordx4 v14, s[20:23], s70 offen lds
s_lshl_b32 s69, s65, 10
s_add_u32 m0, s69, 147456
s_mov_b32 s70, 5242880
buffer_load_dwordx4 v14, s[20:23], s70 offen lds
s_lshl_b32 s69, s65, 10
s_add_u32 m0, s69, 151552
s_mov_b32 s70, 5505024
buffer_load_dwordx4 v14, s[20:23], s70 offen lds
s_lshl_b32 s69, s65, 10
s_add_u32 m0, s69, 155648
s_mov_b32 s70, 5767168
buffer_load_dwordx4 v14, s[20:23], s70 offen lds
s_lshl_b32 s69, s65, 10
s_add_u32 m0, s69, 159744
s_mov_b32 s70, 6029312
buffer_load_dwordx4 v14, s[20:23], s70 offen lds
s_mov_b32 s69, 0
v_add_u32 v21, s69, v24
ds_read_b64_tr_b16 a[64:65], v21 offset:0
ds_read_b64_tr_b16 a[66:67], v21 offset:256
ds_read_b64_tr_b16 a[68:69], v21 offset:4096
ds_read_b64_tr_b16 a[70:71], v21 offset:4352
v_add_u32 v21, s69, v25
ds_read_b64_tr_b16 a[72:73], v21 offset:0
ds_read_b64_tr_b16 a[74:75], v21 offset:256
ds_read_b64_tr_b16 a[76:77], v21 offset:4096
ds_read_b64_tr_b16 a[78:79], v21 offset:4352
v_add_u32 v21, s69, v26
ds_read_b64_tr_b16 a[80:81], v21 offset:0
ds_read_b64_tr_b16 a[82:83], v21 offset:256
ds_read_b64_tr_b16 a[84:85], v21 offset:4096
ds_read_b64_tr_b16 a[86:87], v21 offset:4352
v_add_u32 v21, s69, v27
ds_read_b64_tr_b16 a[88:89], v21 offset:0
ds_read_b64_tr_b16 a[90:91], v21 offset:256
ds_read_b64_tr_b16 a[92:93], v21 offset:4096
ds_read_b64_tr_b16 a[94:95], v21 offset:4352
s_waitcnt lgkmcnt(0)
s_waitcnt vmcnt(24)
s_barrier
s_lshl_b32 s69, s65, 10
s_add_u32 m0, s69, 0
s_mov_b32 s70, 6291456
buffer_load_dwordx4 v14, s[20:23], s70 offen lds
s_lshl_b32 s69, s65, 10
s_add_u32 m0, s69, 4096
s_mov_b32 s70, 6553600
buffer_load_dwordx4 v14, s[20:23], s70 offen lds
s_lshl_b32 s69, s65, 10
s_add_u32 m0, s69, 8192
s_mov_b32 s70, 6815744
buffer_load_dwordx4 v14, s[20:23], s70 offen lds
s_lshl_b32 s69, s65, 10
s_add_u32 m0, s69, 12288
s_mov_b32 s70, 7077888
buffer_load_dwordx4 v14, s[20:23], s70 offen lds
s_lshl_b32 s69, s65, 10
s_add_u32 m0, s69, 16384
s_mov_b32 s70, 7340032
buffer_load_dwordx4 v14, s[20:23], s70 offen lds
s_lshl_b32 s69, s65, 10
s_add_u32 m0, s69, 20480
s_mov_b32 s70, 7602176
buffer_load_dwordx4 v14, s[20:23], s70 offen lds
s_lshl_b32 s69, s65, 10
s_add_u32 m0, s69, 24576
s_mov_b32 s70, 7864320
buffer_load_dwordx4 v14, s[20:23], s70 offen lds
s_lshl_b32 s69, s65, 10
s_add_u32 m0, s69, 28672
s_mov_b32 s70, 8126464
buffer_load_dwordx4 v14, s[20:23], s70 offen lds
s_mov_b32 s69, 32768
v_add_u32 v21, s69, v24
ds_read_b64_tr_b16 a[96:97], v21 offset:0
ds_read_b64_tr_b16 a[98:99], v21 offset:256
ds_read_b64_tr_b16 a[100:101], v21 offset:4096
ds_read_b64_tr_b16 a[102:103], v21 offset:4352
v_add_u32 v21, s69, v25
ds_read_b64_tr_b16 a[104:105], v21 offset:0
ds_read_b64_tr_b16 a[106:107], v21 offset:256
ds_read_b64_tr_b16 a[108:109], v21 offset:4096
ds_read_b64_tr_b16 a[110:111], v21 offset:4352
v_add_u32 v21, s69, v26
ds_read_b64_tr_b16 a[112:113], v21 offset:0
ds_read_b64_tr_b16 a[114:115], v21 offset:256
ds_read_b64_tr_b16 a[116:117], v21 offset:4096
ds_read_b64_tr_b16 a[118:119], v21 offset:4352
v_add_u32 v21, s69, v27
ds_read_b64_tr_b16 a[120:121], v21 offset:0
ds_read_b64_tr_b16 a[122:123], v21 offset:256
ds_read_b64_tr_b16 a[124:125], v21 offset:4096
ds_read_b64_tr_b16 a[126:127], v21 offset:4352
s_waitcnt lgkmcnt(0)
s_waitcnt vmcnt(24)
s_barrier
s_lshl_b32 s69, s65, 10
s_add_u32 m0, s69, 32768
s_mov_b32 s70, 0
buffer_load_dwordx4 v14, s[24:27], s70 offen lds
s_lshl_b32 s69, s65, 10
s_add_u32 m0, s69, 36864
s_mov_b32 s70, 262144
buffer_load_dwordx4 v14, s[24:27], s70 offen lds
s_lshl_b32 s69, s65, 10
s_add_u32 m0, s69, 40960
s_mov_b32 s70, 524288
buffer_load_dwordx4 v14, s[24:27], s70 offen lds
s_lshl_b32 s69, s65, 10
s_add_u32 m0, s69, 45056
s_mov_b32 s70, 786432
buffer_load_dwordx4 v14, s[24:27], s70 offen lds
s_lshl_b32 s69, s65, 10
s_add_u32 m0, s69, 49152
s_mov_b32 s70, 1048576
buffer_load_dwordx4 v14, s[24:27], s70 offen lds
s_lshl_b32 s69, s65, 10
s_add_u32 m0, s69, 53248
s_mov_b32 s70, 1310720
buffer_load_dwordx4 v14, s[24:27], s70 offen lds
s_lshl_b32 s69, s65, 10
s_add_u32 m0, s69, 57344
s_mov_b32 s70, 1572864
buffer_load_dwordx4 v14, s[24:27], s70 offen lds
s_lshl_b32 s69, s65, 10
s_add_u32 m0, s69, 61440
s_mov_b32 s70, 1835008
buffer_load_dwordx4 v14, s[24:27], s70 offen lds
s_mov_b32 s69, 65536
v_add_u32 v21, s69, v24
ds_read_b64_tr_b16 a[128:129], v21 offset:0
ds_read_b64_tr_b16 a[130:131], v21 offset:256
ds_read_b64_tr_b16 a[132:133], v21 offset:4096
ds_read_b64_tr_b16 a[134:135], v21 offset:4352
v_add_u32 v21, s69, v25
ds_read_b64_tr_b16 a[136:137], v21 offset:0
ds_read_b64_tr_b16 a[138:139], v21 offset:256
ds_read_b64_tr_b16 a[140:141], v21 offset:4096
ds_read_b64_tr_b16 a[142:143], v21 offset:4352
v_add_u32 v21, s69, v26
ds_read_b64_tr_b16 a[144:145], v21 offset:0
ds_read_b64_tr_b16 a[146:147], v21 offset:256
ds_read_b64_tr_b16 a[148:149], v21 offset:4096
ds_read_b64_tr_b16 a[150:151], v21 offset:4352
v_add_u32 v21, s69, v27
ds_read_b64_tr_b16 a[152:153], v21 offset:0
ds_read_b64_tr_b16 a[154:155], v21 offset:256
ds_read_b64_tr_b16 a[156:157], v21 offset:4096
ds_read_b64_tr_b16 a[158:159], v21 offset:4352
s_waitcnt lgkmcnt(0)
s_waitcnt vmcnt(24)
s_barrier
s_lshl_b32 s69, s65, 10
s_add_u32 m0, s69, 65536
s_mov_b32 s70, 2097152
buffer_load_dwordx4 v14, s[24:27], s70 offen lds
s_lshl_b32 s69, s65, 10
s_add_u32 m0, s69, 69632
s_mov_b32 s70, 2359296
buffer_load_dwordx4 v14, s[24:27], s70 offen lds
s_lshl_b32 s69, s65, 10
s_add_u32 m0, s69, 73728
s_mov_b32 s70, 2621440
buffer_load_dwordx4 v14, s[24:27], s70 offen lds
s_lshl_b32 s69, s65, 10
s_add_u32 m0, s69, 77824
s_mov_b32 s70, 2883584
buffer_load_dwordx4 v14, s[24:27], s70 offen lds
s_lshl_b32 s69, s65, 10
s_add_u32 m0, s69, 81920
s_mov_b32 s70, 3145728
buffer_load_dwordx4 v14, s[24:27], s70 offen lds
s_lshl_b32 s69, s65, 10
s_add_u32 m0, s69, 86016
s_mov_b32 s70, 3407872
buffer_load_dwordx4 v14, s[24:27], s70 offen lds
s_lshl_b32 s69, s65, 10
s_add_u32 m0, s69, 90112
s_mov_b32 s70, 3670016
buffer_load_dwordx4 v14, s[24:27], s70 offen lds
s_lshl_b32 s69, s65, 10
s_add_u32 m0, s69, 94208
s_mov_b32 s70, 3932160
buffer_load_dwordx4 v14, s[24:27], s70 offen lds
s_mov_b32 s69, 98304
v_add_u32 v21, s69, v24
ds_read_b64_tr_b16 a[160:161], v21 offset:0
ds_read_b64_tr_b16 a[162:163], v21 offset:256
ds_read_b64_tr_b16 a[164:165], v21 offset:4096
ds_read_b64_tr_b16 a[166:167], v21 offset:4352
v_add_u32 v21, s69, v25
ds_read_b64_tr_b16 a[168:169], v21 offset:0
ds_read_b64_tr_b16 a[170:171], v21 offset:256
ds_read_b64_tr_b16 a[172:173], v21 offset:4096
ds_read_b64_tr_b16 a[174:175], v21 offset:4352
v_add_u32 v21, s69, v26
ds_read_b64_tr_b16 a[176:177], v21 offset:0
ds_read_b64_tr_b16 a[178:179], v21 offset:256
ds_read_b64_tr_b16 a[180:181], v21 offset:4096
ds_read_b64_tr_b16 a[182:183], v21 offset:4352
v_add_u32 v21, s69, v27
ds_read_b64_tr_b16 a[184:185], v21 offset:0
ds_read_b64_tr_b16 a[186:187], v21 offset:256
ds_read_b64_tr_b16 a[188:189], v21 offset:4096
ds_read_b64_tr_b16 a[190:191], v21 offset:4352
s_waitcnt lgkmcnt(0)
s_waitcnt vmcnt(24)
s_barrier
s_lshl_b32 s69, s65, 10
s_add_u32 m0, s69, 98304
s_mov_b32 s70, 4194304
buffer_load_dwordx4 v14, s[24:27], s70 offen lds
s_lshl_b32 s69, s65, 10
s_add_u32 m0, s69, 102400
s_mov_b32 s70, 4456448
buffer_load_dwordx4 v14, s[24:27], s70 offen lds
s_lshl_b32 s69, s65, 10
s_add_u32 m0, s69, 106496
s_mov_b32 s70, 4718592
buffer_load_dwordx4 v14, s[24:27], s70 offen lds
s_lshl_b32 s69, s65, 10
s_add_u32 m0, s69, 110592
s_mov_b32 s70, 4980736
buffer_load_dwordx4 v14, s[24:27], s70 offen lds
s_lshl_b32 s69, s65, 10
s_add_u32 m0, s69, 114688
s_mov_b32 s70, 5242880
buffer_load_dwordx4 v14, s[24:27], s70 offen lds
s_lshl_b32 s69, s65, 10
s_add_u32 m0, s69, 118784
s_mov_b32 s70, 5505024
buffer_load_dwordx4 v14, s[24:27], s70 offen lds
s_lshl_b32 s69, s65, 10
s_add_u32 m0, s69, 122880
s_mov_b32 s70, 5767168
buffer_load_dwordx4 v14, s[24:27], s70 offen lds
s_lshl_b32 s69, s65, 10
s_add_u32 m0, s69, 126976
s_mov_b32 s70, 6029312
buffer_load_dwordx4 v14, s[24:27], s70 offen lds
s_mov_b32 s69, 131072
v_add_u32 v21, s69, v24
ds_read_b64_tr_b16 a[192:193], v21 offset:0
ds_read_b64_tr_b16 a[194:195], v21 offset:256
ds_read_b64_tr_b16 a[196:197], v21 offset:4096
ds_read_b64_tr_b16 a[198:199], v21 offset:4352
v_add_u32 v21, s69, v25
ds_read_b64_tr_b16 a[200:201], v21 offset:0
ds_read_b64_tr_b16 a[202:203], v21 offset:256
ds_read_b64_tr_b16 a[204:205], v21 offset:4096
ds_read_b64_tr_b16 a[206:207], v21 offset:4352
v_add_u32 v21, s69, v26
ds_read_b64_tr_b16 a[208:209], v21 offset:0
ds_read_b64_tr_b16 a[210:211], v21 offset:256
ds_read_b64_tr_b16 a[212:213], v21 offset:4096
ds_read_b64_tr_b16 a[214:215], v21 offset:4352
v_add_u32 v21, s69, v27
ds_read_b64_tr_b16 a[216:217], v21 offset:0
ds_read_b64_tr_b16 a[218:219], v21 offset:256
ds_read_b64_tr_b16 a[220:221], v21 offset:4096
ds_read_b64_tr_b16 a[222:223], v21 offset:4352
s_waitcnt lgkmcnt(0)
s_waitcnt vmcnt(24)
s_barrier
s_lshl_b32 s69, s65, 10
s_add_u32 m0, s69, 131072
s_mov_b32 s70, 6291456
buffer_load_dwordx4 v14, s[24:27], s70 offen lds
s_lshl_b32 s69, s65, 10
s_add_u32 m0, s69, 135168
s_mov_b32 s70, 6553600
buffer_load_dwordx4 v14, s[24:27], s70 offen lds
s_lshl_b32 s69, s65, 10
s_add_u32 m0, s69, 139264
s_mov_b32 s70, 6815744
buffer_load_dwordx4 v14, s[24:27], s70 offen lds
s_lshl_b32 s69, s65, 10
s_add_u32 m0, s69, 143360
s_mov_b32 s70, 7077888
buffer_load_dwordx4 v14, s[24:27], s70 offen lds
s_lshl_b32 s69, s65, 10
s_add_u32 m0, s69, 147456
s_mov_b32 s70, 7340032
buffer_load_dwordx4 v14, s[24:27], s70 offen lds
s_lshl_b32 s69, s65, 10
s_add_u32 m0, s69, 151552
s_mov_b32 s70, 7602176
buffer_load_dwordx4 v14, s[24:27], s70 offen lds
s_lshl_b32 s69, s65, 10
s_add_u32 m0, s69, 155648
s_mov_b32 s70, 7864320
buffer_load_dwordx4 v14, s[24:27], s70 offen lds
s_lshl_b32 s69, s65, 10
s_add_u32 m0, s69, 159744
s_mov_b32 s70, 8126464
buffer_load_dwordx4 v14, s[24:27], s70 offen lds
s_mov_b32 s69, 0
v_add_u32 v21, s69, v24
ds_read_b64_tr_b16 a[224:225], v21 offset:0
ds_read_b64_tr_b16 a[226:227], v21 offset:256
ds_read_b64_tr_b16 a[228:229], v21 offset:4096
ds_read_b64_tr_b16 a[230:231], v21 offset:4352
v_add_u32 v21, s69, v25
ds_read_b64_tr_b16 a[232:233], v21 offset:0
ds_read_b64_tr_b16 a[234:235], v21 offset:256
ds_read_b64_tr_b16 a[236:237], v21 offset:4096
ds_read_b64_tr_b16 a[238:239], v21 offset:4352
v_add_u32 v21, s69, v26
ds_read_b64_tr_b16 a[240:241], v21 offset:0
ds_read_b64_tr_b16 a[242:243], v21 offset:256
ds_read_b64_tr_b16 a[244:245], v21 offset:4096
ds_read_b64_tr_b16 a[246:247], v21 offset:4352
v_add_u32 v21, s69, v27
ds_read_b64_tr_b16 a[248:249], v21 offset:0
ds_read_b64_tr_b16 a[250:251], v21 offset:256
ds_read_b64_tr_b16 a[252:253], v21 offset:4096
ds_read_b64_tr_b16 a[254:255], v21 offset:4352
s_waitcnt lgkmcnt(0)
s_waitcnt vmcnt(24)
s_barrier
s_lshl_b32 s69, s65, 13
s_add_u32 m0, s69, 0
s_mov_b32 s70, 0
buffer_load_dwordx4 v16, s[28:31], s70 offen lds
s_lshl_b32 s69, s65, 13
s_add_u32 m0, s69, 1024
s_mov_b32 s70, 32768
buffer_load_dwordx4 v16, s[28:31], s70 offen lds
s_lshl_b32 s69, s65, 13
s_add_u32 m0, s69, 2048
s_mov_b32 s70, 65536
buffer_load_dwordx4 v16, s[28:31], s70 offen lds
s_lshl_b32 s69, s65, 13
s_add_u32 m0, s69, 3072
s_mov_b32 s70, 98304
buffer_load_dwordx4 v16, s[28:31], s70 offen lds
s_lshl_b32 s69, s65, 13
s_add_u32 m0, s69, 4096
s_mov_b32 s70, 131072
buffer_load_dwordx4 v16, s[28:31], s70 offen lds
s_lshl_b32 s69, s65, 13
s_add_u32 m0, s69, 5120
s_mov_b32 s70, 163840
buffer_load_dwordx4 v16, s[28:31], s70 offen lds
s_lshl_b32 s69, s65, 13
s_add_u32 m0, s69, 6144
s_mov_b32 s70, 196608
buffer_load_dwordx4 v16, s[28:31], s70 offen lds
s_lshl_b32 s69, s65, 13
s_add_u32 m0, s69, 7168
s_mov_b32 s70, 229376
buffer_load_dwordx4 v16, s[28:31], s70 offen lds
s_mov_b32 s69, 32768
v_add_u32 v21, s69, v24
ds_read_b64_tr_b16 v[128:129], v21 offset:0
ds_read_b64_tr_b16 v[130:131], v21 offset:256
ds_read_b64_tr_b16 v[132:133], v21 offset:4096
ds_read_b64_tr_b16 v[134:135], v21 offset:4352
v_add_u32 v21, s69, v25
ds_read_b64_tr_b16 v[136:137], v21 offset:0
ds_read_b64_tr_b16 v[138:139], v21 offset:256
ds_read_b64_tr_b16 v[140:141], v21 offset:4096
ds_read_b64_tr_b16 v[142:143], v21 offset:4352
v_add_u32 v21, s69, v26
ds_read_b64_tr_b16 v[144:145], v21 offset:0
ds_read_b64_tr_b16 v[146:147], v21 offset:256
ds_read_b64_tr_b16 v[148:149], v21 offset:4096
ds_read_b64_tr_b16 v[150:151], v21 offset:4352
v_add_u32 v21, s69, v27
ds_read_b64_tr_b16 v[152:153], v21 offset:0
ds_read_b64_tr_b16 v[154:155], v21 offset:256
ds_read_b64_tr_b16 v[156:157], v21 offset:4096
ds_read_b64_tr_b16 v[158:159], v21 offset:4352
s_waitcnt lgkmcnt(0)
s_waitcnt vmcnt(24)
s_barrier
s_lshl_b32 s69, s65, 13
s_add_u32 m0, s69, 32768
s_mov_b32 s70, 262144
buffer_load_dwordx4 v16, s[28:31], s70 offen lds
s_lshl_b32 s69, s65, 13
s_add_u32 m0, s69, 33792
s_mov_b32 s70, 294912
buffer_load_dwordx4 v16, s[28:31], s70 offen lds
s_lshl_b32 s69, s65, 13
s_add_u32 m0, s69, 34816
s_mov_b32 s70, 327680
buffer_load_dwordx4 v16, s[28:31], s70 offen lds
s_lshl_b32 s69, s65, 13
s_add_u32 m0, s69, 35840
s_mov_b32 s70, 360448
buffer_load_dwordx4 v16, s[28:31], s70 offen lds
s_lshl_b32 s69, s65, 13
s_add_u32 m0, s69, 36864
s_mov_b32 s70, 393216
buffer_load_dwordx4 v16, s[28:31], s70 offen lds
s_lshl_b32 s69, s65, 13
s_add_u32 m0, s69, 37888
s_mov_b32 s70, 425984
buffer_load_dwordx4 v16, s[28:31], s70 offen lds
s_lshl_b32 s69, s65, 13
s_add_u32 m0, s69, 38912
s_mov_b32 s70, 458752
buffer_load_dwordx4 v16, s[28:31], s70 offen lds
s_lshl_b32 s69, s65, 13
s_add_u32 m0, s69, 39936
s_mov_b32 s70, 491520
buffer_load_dwordx4 v16, s[28:31], s70 offen lds
s_mov_b32 s69, 65536
v_add_u32 v21, s69, v24
ds_read_b64_tr_b16 v[160:161], v21 offset:0
ds_read_b64_tr_b16 v[162:163], v21 offset:256
ds_read_b64_tr_b16 v[164:165], v21 offset:4096
ds_read_b64_tr_b16 v[166:167], v21 offset:4352
v_add_u32 v21, s69, v25
ds_read_b64_tr_b16 v[168:169], v21 offset:0
ds_read_b64_tr_b16 v[170:171], v21 offset:256
ds_read_b64_tr_b16 v[172:173], v21 offset:4096
ds_read_b64_tr_b16 v[174:175], v21 offset:4352
v_add_u32 v21, s69, v26
ds_read_b64_tr_b16 v[176:177], v21 offset:0
ds_read_b64_tr_b16 v[178:179], v21 offset:256
ds_read_b64_tr_b16 v[180:181], v21 offset:4096
ds_read_b64_tr_b16 v[182:183], v21 offset:4352
v_add_u32 v21, s69, v27
ds_read_b64_tr_b16 v[184:185], v21 offset:0
ds_read_b64_tr_b16 v[186:187], v21 offset:256
ds_read_b64_tr_b16 v[188:189], v21 offset:4096
ds_read_b64_tr_b16 v[190:191], v21 offset:4352
s_waitcnt lgkmcnt(0)
s_waitcnt vmcnt(24)
s_barrier
s_lshl_b32 s69, s65, 13
s_add_u32 m0, s69, 65536
s_mov_b32 s70, 524288
buffer_load_dwordx4 v16, s[28:31], s70 offen lds
s_lshl_b32 s69, s65, 13
s_add_u32 m0, s69, 66560
s_mov_b32 s70, 557056
buffer_load_dwordx4 v16, s[28:31], s70 offen lds
s_lshl_b32 s69, s65, 13
s_add_u32 m0, s69, 67584
s_mov_b32 s70, 589824
buffer_load_dwordx4 v16, s[28:31], s70 offen lds
s_lshl_b32 s69, s65, 13
s_add_u32 m0, s69, 68608
s_mov_b32 s70, 622592
buffer_load_dwordx4 v16, s[28:31], s70 offen lds
s_lshl_b32 s69, s65, 13
s_add_u32 m0, s69, 69632
s_mov_b32 s70, 655360
buffer_load_dwordx4 v16, s[28:31], s70 offen lds
s_lshl_b32 s69, s65, 13
s_add_u32 m0, s69, 70656
s_mov_b32 s70, 688128
buffer_load_dwordx4 v16, s[28:31], s70 offen lds
s_lshl_b32 s69, s65, 13
s_add_u32 m0, s69, 71680
s_mov_b32 s70, 720896
buffer_load_dwordx4 v16, s[28:31], s70 offen lds
s_lshl_b32 s69, s65, 13
s_add_u32 m0, s69, 72704
s_mov_b32 s70, 753664
buffer_load_dwordx4 v16, s[28:31], s70 offen lds
s_mov_b32 s69, 98304
v_add_u32 v21, s69, v24
ds_read_b64_tr_b16 v[192:193], v21 offset:0
ds_read_b64_tr_b16 v[194:195], v21 offset:256
ds_read_b64_tr_b16 v[196:197], v21 offset:4096
ds_read_b64_tr_b16 v[198:199], v21 offset:4352
v_add_u32 v21, s69, v25
ds_read_b64_tr_b16 v[200:201], v21 offset:0
ds_read_b64_tr_b16 v[202:203], v21 offset:256
ds_read_b64_tr_b16 v[204:205], v21 offset:4096
ds_read_b64_tr_b16 v[206:207], v21 offset:4352
v_add_u32 v21, s69, v26
ds_read_b64_tr_b16 v[208:209], v21 offset:0
ds_read_b64_tr_b16 v[210:211], v21 offset:256
ds_read_b64_tr_b16 v[212:213], v21 offset:4096
ds_read_b64_tr_b16 v[214:215], v21 offset:4352
v_add_u32 v21, s69, v27
ds_read_b64_tr_b16 v[216:217], v21 offset:0
ds_read_b64_tr_b16 v[218:219], v21 offset:256
ds_read_b64_tr_b16 v[220:221], v21 offset:4096
ds_read_b64_tr_b16 v[222:223], v21 offset:4352
s_waitcnt lgkmcnt(0)
s_waitcnt vmcnt(24)
s_barrier
s_lshl_b32 s69, s65, 13
s_add_u32 m0, s69, 98304
s_mov_b32 s70, 786432
buffer_load_dwordx4 v16, s[28:31], s70 offen lds
s_lshl_b32 s69, s65, 13
s_add_u32 m0, s69, 99328
s_mov_b32 s70, 819200
buffer_load_dwordx4 v16, s[28:31], s70 offen lds
s_lshl_b32 s69, s65, 13
s_add_u32 m0, s69, 100352
s_mov_b32 s70, 851968
buffer_load_dwordx4 v16, s[28:31], s70 offen lds
s_lshl_b32 s69, s65, 13
s_add_u32 m0, s69, 101376
s_mov_b32 s70, 884736
buffer_load_dwordx4 v16, s[28:31], s70 offen lds
s_lshl_b32 s69, s65, 13
s_add_u32 m0, s69, 102400
s_mov_b32 s70, 917504
buffer_load_dwordx4 v16, s[28:31], s70 offen lds
s_lshl_b32 s69, s65, 13
s_add_u32 m0, s69, 103424
s_mov_b32 s70, 950272
buffer_load_dwordx4 v16, s[28:31], s70 offen lds
s_lshl_b32 s69, s65, 13
s_add_u32 m0, s69, 104448
s_mov_b32 s70, 983040
buffer_load_dwordx4 v16, s[28:31], s70 offen lds
s_lshl_b32 s69, s65, 13
s_add_u32 m0, s69, 105472
s_mov_b32 s70, 1015808
buffer_load_dwordx4 v16, s[28:31], s70 offen lds
s_mov_b32 s69, 131072
v_add_u32 v21, s69, v24
ds_read_b64_tr_b16 v[224:225], v21 offset:0
ds_read_b64_tr_b16 v[226:227], v21 offset:256
ds_read_b64_tr_b16 v[228:229], v21 offset:4096
ds_read_b64_tr_b16 v[230:231], v21 offset:4352
v_add_u32 v21, s69, v25
ds_read_b64_tr_b16 v[232:233], v21 offset:0
ds_read_b64_tr_b16 v[234:235], v21 offset:256
ds_read_b64_tr_b16 v[236:237], v21 offset:4096
ds_read_b64_tr_b16 v[238:239], v21 offset:4352
v_add_u32 v21, s69, v26
ds_read_b64_tr_b16 v[240:241], v21 offset:0
ds_read_b64_tr_b16 v[242:243], v21 offset:256
ds_read_b64_tr_b16 v[244:245], v21 offset:4096
ds_read_b64_tr_b16 v[246:247], v21 offset:4352
v_add_u32 v21, s69, v27
ds_read_b64_tr_b16 v[248:249], v21 offset:0
ds_read_b64_tr_b16 v[250:251], v21 offset:256
ds_read_b64_tr_b16 v[252:253], v21 offset:4096
ds_read_b64_tr_b16 v[254:255], v21 offset:4352
s_waitcnt lgkmcnt(0)
s_waitcnt vmcnt(24)
s_barrier
s_mov_b32 s69, 0
v_add_u32 v21, s69, v20
s_lshl_b32 s70, s65, 13
s_add_u32 s69, s69, s70
v_add_u32 v22, s69, v2
ds_read_b64_tr_b16 v[32:33], v21 offset:0
ds_read_b64_tr_b16 v[34:35], v21 offset:128
ds_read_b64_tr_b16 v[36:37], v21 offset:2048
ds_read_b64_tr_b16 v[38:39], v21 offset:2176
ds_read_b64_tr_b16 v[40:41], v21 offset:32
ds_read_b64_tr_b16 v[42:43], v21 offset:160
ds_read_b64_tr_b16 v[44:45], v21 offset:2080
ds_read_b64_tr_b16 v[46:47], v21 offset:2208
ds_read_b64_tr_b16 v[48:49], v21 offset:4096
ds_read_b64_tr_b16 v[50:51], v21 offset:4224
ds_read_b64_tr_b16 v[52:53], v21 offset:6144
ds_read_b64_tr_b16 v[54:55], v21 offset:6272
ds_read_b64_tr_b16 v[56:57], v21 offset:4128
ds_read_b64_tr_b16 v[58:59], v21 offset:4256
ds_read_b64_tr_b16 v[60:61], v21 offset:6176
ds_read_b64_tr_b16 v[62:63], v21 offset:6304
s_waitcnt lgkmcnt(0)
ds_write_b128 v22, v[32:35] offset:0
ds_write_b128 v22, v[36:39] offset:1024
ds_write_b128 v22, v[40:43] offset:2048
ds_write_b128 v22, v[44:47] offset:3072
ds_write_b128 v22, v[48:51] offset:4096
ds_write_b128 v22, v[52:55] offset:5120
ds_write_b128 v22, v[56:59] offset:6144
ds_write_b128 v22, v[60:63] offset:7168
s_waitcnt lgkmcnt(0)
s_waitcnt vmcnt(16)
s_barrier
s_mov_b32 s69, 32768
v_add_u32 v21, s69, v20
s_lshl_b32 s70, s65, 13
s_add_u32 s69, s69, s70
v_add_u32 v22, s69, v2
ds_read_b64_tr_b16 v[32:33], v21 offset:0
ds_read_b64_tr_b16 v[34:35], v21 offset:128
ds_read_b64_tr_b16 v[36:37], v21 offset:2048
ds_read_b64_tr_b16 v[38:39], v21 offset:2176
ds_read_b64_tr_b16 v[40:41], v21 offset:32
ds_read_b64_tr_b16 v[42:43], v21 offset:160
ds_read_b64_tr_b16 v[44:45], v21 offset:2080
ds_read_b64_tr_b16 v[46:47], v21 offset:2208
ds_read_b64_tr_b16 v[48:49], v21 offset:4096
ds_read_b64_tr_b16 v[50:51], v21 offset:4224
ds_read_b64_tr_b16 v[52:53], v21 offset:6144
ds_read_b64_tr_b16 v[54:55], v21 offset:6272
ds_read_b64_tr_b16 v[56:57], v21 offset:4128
ds_read_b64_tr_b16 v[58:59], v21 offset:4256
ds_read_b64_tr_b16 v[60:61], v21 offset:6176
ds_read_b64_tr_b16 v[62:63], v21 offset:6304
s_waitcnt lgkmcnt(0)
ds_write_b128 v22, v[32:35] offset:0
ds_write_b128 v22, v[36:39] offset:1024
ds_write_b128 v22, v[40:43] offset:2048
ds_write_b128 v22, v[44:47] offset:3072
ds_write_b128 v22, v[48:51] offset:4096
ds_write_b128 v22, v[52:55] offset:5120
ds_write_b128 v22, v[56:59] offset:6144
ds_write_b128 v22, v[60:63] offset:7168
s_waitcnt lgkmcnt(0)
s_waitcnt vmcnt(8)
s_barrier
s_mov_b32 s69, 65536
v_add_u32 v21, s69, v20
s_lshl_b32 s70, s65, 13
s_add_u32 s69, s69, s70
v_add_u32 v22, s69, v2
ds_read_b64_tr_b16 v[32:33], v21 offset:0
ds_read_b64_tr_b16 v[34:35], v21 offset:128
ds_read_b64_tr_b16 v[36:37], v21 offset:2048
ds_read_b64_tr_b16 v[38:39], v21 offset:2176
ds_read_b64_tr_b16 v[40:41], v21 offset:32
ds_read_b64_tr_b16 v[42:43], v21 offset:160
ds_read_b64_tr_b16 v[44:45], v21 offset:2080
ds_read_b64_tr_b16 v[46:47], v21 offset:2208
ds_read_b64_tr_b16 v[48:49], v21 offset:4096
ds_read_b64_tr_b16 v[50:51], v21 offset:4224
ds_read_b64_tr_b16 v[52:53], v21 offset:6144
ds_read_b64_tr_b16 v[54:55], v21 offset:6272
ds_read_b64_tr_b16 v[56:57], v21 offset:4128
ds_read_b64_tr_b16 v[58:59], v21 offset:4256
ds_read_b64_tr_b16 v[60:61], v21 offset:6176
ds_read_b64_tr_b16 v[62:63], v21 offset:6304
s_waitcnt lgkmcnt(0)
ds_write_b128 v22, v[32:35] offset:0
ds_write_b128 v22, v[36:39] offset:1024
ds_write_b128 v22, v[40:43] offset:2048
ds_write_b128 v22, v[44:47] offset:3072
ds_write_b128 v22, v[48:51] offset:4096
ds_write_b128 v22, v[52:55] offset:5120
ds_write_b128 v22, v[56:59] offset:6144
ds_write_b128 v22, v[60:63] offset:7168
s_waitcnt lgkmcnt(0)
s_waitcnt vmcnt(0)
s_barrier
s_mov_b32 s69, 98304
v_add_u32 v21, s69, v20
s_lshl_b32 s70, s65, 13
s_add_u32 s69, s69, s70
v_add_u32 v22, s69, v2
ds_read_b64_tr_b16 v[32:33], v21 offset:0
ds_read_b64_tr_b16 v[34:35], v21 offset:128
ds_read_b64_tr_b16 v[36:37], v21 offset:2048
ds_read_b64_tr_b16 v[38:39], v21 offset:2176
ds_read_b64_tr_b16 v[40:41], v21 offset:32
ds_read_b64_tr_b16 v[42:43], v21 offset:160
ds_read_b64_tr_b16 v[44:45], v21 offset:2080
ds_read_b64_tr_b16 v[46:47], v21 offset:2208
ds_read_b64_tr_b16 v[48:49], v21 offset:4096
ds_read_b64_tr_b16 v[50:51], v21 offset:4224
ds_read_b64_tr_b16 v[52:53], v21 offset:6144
ds_read_b64_tr_b16 v[54:55], v21 offset:6272
ds_read_b64_tr_b16 v[56:57], v21 offset:4128
ds_read_b64_tr_b16 v[58:59], v21 offset:4256
ds_read_b64_tr_b16 v[60:61], v21 offset:6176
ds_read_b64_tr_b16 v[62:63], v21 offset:6304
s_waitcnt lgkmcnt(0)
ds_write_b128 v22, v[32:35] offset:0
ds_write_b128 v22, v[36:39] offset:1024
ds_write_b128 v22, v[40:43] offset:2048
ds_write_b128 v22, v[44:47] offset:3072
ds_write_b128 v22, v[48:51] offset:4096
ds_write_b128 v22, v[52:55] offset:5120
ds_write_b128 v22, v[56:59] offset:6144
ds_write_b128 v22, v[60:63] offset:7168
s_waitcnt lgkmcnt(0)
s_cmp_lg_u32 s90, 2
s_cbranch_scc1 L_ch_const
s_mov_b32 s90, 3
s_branch L_role_all
L_ch_const:
v_lshlrev_b32 v2, 4, v0
v_and_b32 v10, 15, v0
v_lshrrev_b32 v11, 4, v0
v_and_b32 v14, 1, v11
v_lshrrev_b32 v15, 5, v0
v_lshl_add_u32 v30, v15, 4, v10
v_lshlrev_b32 v1, 4, v30
v_lshl_add_u32 v30, v14, 3, v1
s_lshl_b32 s69, s65, 10
s_add_u32 s70, s69, 131072
v_add_u32 v30, s70, v30
s_lshl_b32 s71, s72, 14
s_add_u32 s69, s69, s71
s_xor_b32 s71, s69, 0x4000
s_add_u32 s71, s71, 32768
v_mov_b32 v16, s69
v_mov_b32 v17, s71
v_cmp_eq_u32 vcc, 1, v14
s_lshl_b32 s85, s64, 9
s_sub_u32 s85, s85, s70
v_add_u32 v1, v2, v16
s_add_u32 s86, s85, 32768
v_mov_b32 v3, 0x4444
v_mov_b32 v16, 0xeeee
v_cmp_eq_u32 vcc, 1, v13
s_lshl_b32 s69, s75, 7
s_nop 0
v_cndmask_b32 v3, v3, v16, vcc
v_lshlrev_b32 v4, 8, v11
v_lshl_add_u32 v4, v10, 4, v4
v_add_u32 v4, s69, v4
v_lshlrev_b32 v5, 7, v15
v_lshl_add_u32 v5, v10, 4, v5
v_lshl_add_u32 v5, v14, 3, v5
v_lshlrev_b32 v24, 4, v10
v_lshl_add_u32 v24, v14, 3, v24
v_lshl_add_u32 v24, v15, 10, v24
s_lshl_b32 s69, s65, 8
s_add_u32 s69, s69, 147456
v_add_u32 v24, s69, v24
v_bfe_u32 v17, v0, 2, 2
v_lshl_add_u32 v25, v11, 3, v17
v_lshlrev_b32 v25, 4, v25
v_and_b32 v18, 1, v0
v_lshl_add_u32 v25, v18, 3, v25
v_add_u32 v25, 147456, v25
v_mov_b32 v29, 0
v_mov_b32 v16, 0xff000000
v_cmp_lt_u32 vcc, 31, v0
s_lshl_b32 s69, s65, 13
v_add_u32 v31, s69, v2
v_cndmask_b32 v29, v29, v16, vcc
v_lshl_add_u32 v19, v15, 5, v17
v_lshl_add_u32 v19, v14, 3, v19
v_bfe_u32 v16, v0, 1, 1
v_lshl_add_u32 v19, v16, 2, v19
v_lshlrev_b32 v19, 4, v19
v_lshl_add_u32 v19, v18, 3, v19
v_mov_b32 v50, 0
v_mov_b32 v51, 0
v_mov_b32 v28, 128
s_mov_b32 s87, 0
v_lshrrev_b32 v16, 3, v0
v_lshlrev_b32 v17, 11, v12
v_lshl_add_u32 v17, v16, 4, v17
s_lshl_b32 s69, s65, 9
s_lshl_b32 s70, s65, 12
s_add_u32 s70, s70, 131072
v_lshlrev_b32 v16, 7, v16
v_lshl_add_u32 v16, v12, 1, v16
v_add_u32 v16, s70, v16
buffer_load_dwordx4 v[64:67], v17, s[12:15], s69 offen offset:0
buffer_load_dwordx4 v[68:71], v17, s[12:15], s69 offen offset:128
buffer_load_dwordx4 v[72:75], v17, s[12:15], s69 offen offset:256
buffer_load_dwordx4 v[76:79], v17, s[12:15], s69 offen offset:384
s_waitcnt vmcnt(0)
ds_write_b16 v16, v64 offset:0
ds_write_b16_d16_hi v16, v64 offset:16
ds_write_b16 v16, v65 offset:32
ds_write_b16_d16_hi v16, v65 offset:48
ds_write_b16 v16, v66 offset:64
ds_write_b16_d16_hi v16, v66 offset:80
ds_write_b16 v16, v67 offset:96
ds_write_b16_d16_hi v16, v67 offset:112
ds_write_b16 v16, v68 offset:1024
ds_write_b16_d16_hi v16, v68 offset:1040
ds_write_b16 v16, v69 offset:1056
ds_write_b16_d16_hi v16, v69 offset:1072
ds_write_b16 v16, v70 offset:1088
ds_write_b16_d16_hi v16, v70 offset:1104
ds_write_b16 v16, v71 offset:1120
ds_write_b16_d16_hi v16, v71 offset:1136
ds_write_b16 v16, v72 offset:2048
ds_write_b16_d16_hi v16, v72 offset:2064
ds_write_b16 v16, v73 offset:2080
ds_write_b16_d16_hi v16, v73 offset:2096
ds_write_b16 v16, v74 offset:2112
ds_write_b16_d16_hi v16, v74 offset:2128
ds_write_b16 v16, v75 offset:2144
ds_write_b16_d16_hi v16, v75 offset:2160
ds_write_b16 v16, v76 offset:3072
ds_write_b16_d16_hi v16, v76 offset:3088
ds_write_b16 v16, v77 offset:3104
ds_write_b16_d16_hi v16, v77 offset:3120
ds_write_b16 v16, v78 offset:3136
ds_write_b16_d16_hi v16, v78 offset:3152
ds_write_b16 v16, v79 offset:3168
ds_write_b16_d16_hi v16, v79 offset:3184
s_add_u32 s69, s65, 0
s_and_b32 s69, s69, 3
s_lshl_b32 s69, s69, 10
s_add_u32 s69, s69, 131072
v_add_u32 v0, s69, v19
s_add_u32 s69, s65, 1
s_and_b32 s69, s69, 3
s_lshl_b32 s69, s69, 10
s_add_u32 s69, s69, 131072
v_add_u32 v8, s69, v19
s_add_u32 s69, s65, 2
s_and_b32 s69, s69, 3
s_lshl_b32 s69, s69, 10
s_add_u32 s69, s69, 131072
v_add_u32 v26, s69, v19
s_add_u32 s69, s65, 3
s_and_b32 s69, s69, 3
s_lshl_b32 s69, s69, 10
s_add_u32 s69, s69, 131072
v_add_u32 v27, s69, v19
v_add_u32 v11, 0x10000, v31
s_mov_b32 s32, 50331651
s_mov_b32 s33, 0
s_mov_b32 s34, 201326604
s_mov_b32 s35, 0
s_mov_b32 s36, 805306416
s_mov_b32 s37, 0
s_mov_b32 s38, 3221225664
s_mov_b32 s39, 0
s_mov_b32 s40, 0xaaaaaaaa
s_mov_b32 s41, 0xaaaaaaaa
s_mov_b32 s42, 1040356334
s_mov_b32 s43, 1040356334
s_lshl_b32 s69, s64, 13
s_lshl_b32 s70, s65, 11
s_add_u32 s76, s69, s70
s_lshl_b32 s70, s65, 10
s_add_u32 s77, s69, s70
s_add_u32 s77, s77, 4096
s_lshl_b32 s79, s64, 11
s_add_u32 s79, s79, 50331648
s_lshl_b32 s69, s64, 2
s_add_u32 s69, s69, s65
s_lshl_b32 s80, s65, 8
s_add_u32 s80, s80, s79
s_add_u32 s80, s80, 1024
s_lshl_b32 s81, s69, 8
s_add_u32 s81, s81, 65536
s_lshl_b32 s69, s72, 15
s_lshl_b32 s70, s65, 13
s_add_u32 s83, s69, s70
s_add_u32 s83, s83, 65536
s_mul_i32 s84, s74, 3072
s_add_u32 s84, s84, 131072
s_lshl_b32 s82, s65, 10
s_add_u32 s82, s82, s84
s_mov_b32 s67, 0
s_mov_b32 s4, 0x00ff00ff
s_mov_b32 s5, 0x00ff00ff
s_mov_b32 s6, -1
s_mov_b32 s7, 0
s_mov_b32 s68, 100663296
s_mov_b32 s78, 0
v_mov_b32 v9, 0
Lw_1:
buffer_load_dword v10, v9, s[56:59], 64 offen sc1
s_waitcnt vmcnt(0)
v_readfirstlane_b32 s71, v10
s_add_u32 s78, s78, 1
s_cmp_gt_u32 s78, 0x40000
s_cbranch_scc1 Lw_2
s_cmp_ge_u32 s71, 128
s_cbranch_scc1 Lw_2
s_sleep 2
s_branch Lw_1
Lw_2:
s_cmp_eq_u32 s65, 2
s_cbranch_scc1 Lk_3
buffer_load_dwordx4 v[56:59], v2, s[60:63], s76 offen sc1
buffer_load_dwordx4 v[60:63], v2, s[60:63], s76 offen offset:1024 sc1
Lk_3:
buffer_load_dwordx4 v[52:55], v2, s[60:63], s77 offen sc1
s_add_u32 s76, s76, 524288
s_add_u32 s77, s77, 524288
v_mov_b32 v12, 0
v_mov_b32 v13, 0
v_mov_b32 v14, 0
v_mov_b32 v15, 0
v_mov_b32 v16, 0
v_mov_b32 v17, 0
v_mov_b32 v18, 0
v_mov_b32 v19, 0
v_mov_b32 v20, 0
v_mov_b32 v21, 0
v_mov_b32 v22, 0
v_mov_b32 v23, 0
s_waitcnt vmcnt(0) lgkmcnt(0)
s_barrier
ds_read_b64_tr_b16 v[64:65], v0 offset:0
ds_read_b64_tr_b16 v[66:67], v0 offset:256
ds_read_b64_tr_b16 v[80:81], v0 offset:4096
ds_read_b64_tr_b16 v[82:83], v0 offset:4352
ds_read_b64_tr_b16 v[96:97], v0 offset:8192
ds_read_b64_tr_b16 v[98:99], v0 offset:8448
ds_read_b64_tr_b16 v[112:113], v0 offset:12288
ds_read_b64_tr_b16 v[114:115], v0 offset:12544
s_branch L_ch_B
L_ch_step:
v_mov_b32 v9, 0x3f80
v_mov_b32 v10, 0x3f800000
s_add_u32 s69, s68, 4096
v_cndmask_b32 v10, v9, v10, s[40:41]
s_add_u32 s70, s68, 8192
s_add_u32 s71, s68, 12288
buffer_load_dwordx4 v[96:99], v1, s[60:63], s68 offen sc1
buffer_load_dwordx4 v[100:103], v1, s[60:63], s69 offen sc1
buffer_load_dwordx4 v[104:107], v1, s[60:63], s70 offen sc1
buffer_load_dwordx4 v[108:111], v1, s[60:63], s71 offen sc1
v_xor_b32 v44, 0x4000, v1
v_add_u32 v44, 32768, v44
v_cndmask_b32 v40, 0, v10, s[32:33]
v_mov_b32 v32, 0
v_cndmask_b32 v41, 0, v10, s[34:35]
v_mov_b32 v33, 0
v_cndmask_b32 v42, 0, v10, s[36:37]
v_mov_b32 v34, 0
v_cndmask_b32 v43, 0, v10, s[38:39]
v_mov_b32 v35, 0
v_mov_b32 v36, v40
v_mov_b32 v37, v41
v_mov_b32 v38, v42
v_mov_b32 v39, v43
v_mov_b32 v12, 0
v_mov_b32 v13, 0
v_mov_b32 v14, 0
v_mov_b32 v15, 0
v_mov_b32 v16, 0
v_mov_b32 v17, 0
v_mov_b32 v18, 0
v_mov_b32 v19, 0
v_mov_b32 v20, 0
v_mov_b32 v21, 0
v_mov_b32 v22, 0
v_mov_b32 v23, 0
v_permlane32_swap_b32 v32, v36
v_permlane32_swap_b32 v33, v37
v_permlane32_swap_b32 v34, v38
v_permlane32_swap_b32 v35, v39
s_sleep 7
buffer_load_dwordx4 v[112:115], v44, s[60:63], s68 offen sc1
buffer_load_dwordx4 v[116:119], v44, s[60:63], s69 offen sc1
buffer_load_dwordx4 v[120:123], v44, s[60:63], s70 offen sc1
buffer_load_dwordx4 v[124:127], v44, s[60:63], s71 offen sc1
s_waitcnt vmcnt(7)
v_max3_u32 v9, v96, v97, v98
v_max_u32 v9, v9, v99
s_waitcnt vmcnt(6)
v_max3_u32 v9, v9, v100, v101
v_max3_u32 v9, v9, v102, v103
s_waitcnt vmcnt(5)
v_max3_u32 v9, v9, v104, v105
v_max3_u32 v9, v9, v106, v107
s_waitcnt vmcnt(4)
v_max3_u32 v9, v9, v108, v109
v_max3_u32 v9, v9, v110, v111
v_cmp_eq_u32 vcc, -1, v9
s_cbranch_vccz Lp_5
s_mov_b32 s78, 0
Lp_4:
buffer_load_dwordx4 v[96:99], v1, s[60:63], s68 offen sc1
buffer_load_dwordx4 v[100:103], v1, s[60:63], s69 offen sc1
buffer_load_dwordx4 v[104:107], v1, s[60:63], s70 offen sc1
buffer_load_dwordx4 v[108:111], v1, s[60:63], s71 offen sc1
s_add_u32 s78, s78, 1
s_add_u32 s87, s87, 1
s_waitcnt vmcnt(3)
v_max3_u32 v9, v96, v97, v98
v_max_u32 v9, v9, v99
s_waitcnt vmcnt(2)
v_max3_u32 v9, v9, v100, v101
v_max3_u32 v9, v9, v102, v103
s_waitcnt vmcnt(1)
v_max3_u32 v9, v9, v104, v105
v_max3_u32 v9, v9, v106, v107
s_waitcnt vmcnt(0)
v_max3_u32 v9, v9, v108, v109
v_max3_u32 v9, v9, v110, v111
v_cmp_eq_u32 vcc, -1, v9
s_cmp_gt_u32 s78, 0x40000
s_cbranch_scc1 Lp_5
s_cbranch_vccnz Lp_4
Lp_5:
v_mfma_f32_16x16x32_bf16 v[64:67], v[40:43], v[96:99], 0
v_mfma_f32_16x16x32_bf16 v[68:71], v[32:35], v[96:99], 0
v_mfma_f32_16x16x32_bf16 v[72:75], v[40:43], v[100:103], 0
v_mfma_f32_16x16x32_bf16 v[76:79], v[32:35], v[100:103], 0
v_mfma_f32_16x16x32_bf16 v[80:83], v[40:43], v[104:107], 0
v_mfma_f32_16x16x32_bf16 v[84:87], v[32:35], v[104:107], 0
v_mfma_f32_16x16x32_bf16 v[88:91], v[40:43], v[108:111], 0
v_mfma_f32_16x16x32_bf16 v[92:95], v[32:35], v[108:111], 0
s_waitcnt vmcnt(3)
v_max3_u32 v9, v112, v113, v114
v_max_u32 v9, v9, v115
s_waitcnt vmcnt(2)
v_max3_u32 v9, v9, v116, v117
v_max3_u32 v9, v9, v118, v119
s_waitcnt vmcnt(1)
v_max3_u32 v9, v9, v120, v121
v_max3_u32 v9, v9, v122, v123
s_waitcnt vmcnt(0)
v_max3_u32 v9, v9, v124, v125
v_max3_u32 v9, v9, v126, v127
v_cmp_eq_u32 vcc, -1, v9
s_cbranch_vccz Lp_7
s_mov_b32 s78, 0
Lp_6:
buffer_load_dwordx4 v[112:115], v44, s[60:63], s68 offen sc1
buffer_load_dwordx4 v[116:119], v44, s[60:63], s69 offen sc1
buffer_load_dwordx4 v[120:123], v44, s[60:63], s70 offen sc1
buffer_load_dwordx4 v[124:127], v44, s[60:63], s71 offen sc1
s_add_u32 s78, s78, 1
s_add_u32 s87, s87, 1
s_waitcnt vmcnt(3)
v_max3_u32 v9, v112, v113, v114
v_max_u32 v9, v9, v115
s_waitcnt vmcnt(2)
v_max3_u32 v9, v9, v116, v117
v_max3_u32 v9, v9, v118, v119
s_waitcnt vmcnt(1)
v_max3_u32 v9, v9, v120, v121
v_max3_u32 v9, v9, v122, v123
s_waitcnt vmcnt(0)
v_max3_u32 v9, v9, v124, v125
v_max3_u32 v9, v9, v126, v127
v_cmp_eq_u32 vcc, -1, v9
s_cmp_gt_u32 s78, 0x40000
s_cbranch_scc1 Lp_7
s_cbranch_vccnz Lp_6
Lp_7:
v_mfma_f32_16x16x32_bf16 v[64:67], v[40:43], v[112:115], v[64:67]
v_mfma_f32_16x16x32_bf16 v[68:71], v[32:35], v[112:115], v[68:71]
v_mfma_f32_16x16x32_bf16 v[72:75], v[40:43], v[116:119], v[72:75]
s_nop 5
v_cvt_pk_bf16_f32 v64, v64, v65
v_cvt_pk_bf16_f32 v65, v66, v67
ds_write_b64 v30, v[64:65] offset:0
v_mfma_f32_16x16x32_bf16 v[76:79], v[32:35], v[116:119], v[76:79]
v_cvt_pk_bf16_f32 v68, v68, v69
v_cvt_pk_bf16_f32 v69, v70, v71
ds_write_b64 v30, v[68:69] offset:512
v_mfma_f32_16x16x32_bf16 v[80:83], v[40:43], v[120:123], v[80:83]
v_cvt_pk_bf16_f32 v72, v72, v73
v_cvt_pk_bf16_f32 v73, v74, v75
ds_write_b64 v30, v[72:73] offset:4096
v_mfma_f32_16x16x32_bf16 v[84:87], v[32:35], v[120:123], v[84:87]
v_cvt_pk_bf16_f32 v76, v76, v77
v_cvt_pk_bf16_f32 v77, v78, v79
ds_write_b64 v30, v[76:77] offset:4608
v_mfma_f32_16x16x32_bf16 v[88:91], v[40:43], v[124:127], v[88:91]
v_cvt_pk_bf16_f32 v80, v80, v81
v_cvt_pk_bf16_f32 v81, v82, v83
ds_write_b64 v30, v[80:81] offset:8192
v_mfma_f32_16x16x32_bf16 v[92:95], v[32:35], v[124:127], v[92:95]
v_cvt_pk_bf16_f32 v84, v84, v85
v_cvt_pk_bf16_f32 v85, v86, v87
ds_write_b64 v30, v[84:85] offset:8704
s_add_u32 s68, s68, 262144
s_nop 0
v_cvt_pk_bf16_f32 v88, v88, v89
v_cvt_pk_bf16_f32 v89, v90, v91
ds_write_b64 v30, v[88:89] offset:12288
s_nop 0
v_cvt_pk_bf16_f32 v92, v92, v93
v_cvt_pk_bf16_f32 v93, v94, v95
ds_write_b64 v30, v[92:93] offset:12800
ds_read_b64_tr_b16 v[64:65], v0 offset:0
ds_read_b64_tr_b16 v[66:67], v0 offset:256
ds_read_b64_tr_b16 v[80:81], v0 offset:4096
ds_read_b64_tr_b16 v[82:83], v0 offset:4352
ds_read_b64_tr_b16 v[96:97], v0 offset:8192
ds_read_b64_tr_b16 v[98:99], v0 offset:8448
ds_read_b64_tr_b16 v[112:113], v0 offset:12288
ds_read_b64_tr_b16 v[114:115], v0 offset:12544
s_waitcnt lgkmcnt(8)
s_barrier
L_ch_B:
ds_read_b64_tr_b16 v[68:69], v8 offset:0
ds_read_b64_tr_b16 v[70:71], v8 offset:256
ds_read_b64_tr_b16 v[84:85], v8 offset:4096
ds_read_b64_tr_b16 v[86:87], v8 offset:4352
ds_read_b64_tr_b16 v[100:101], v8 offset:8192
ds_read_b64_tr_b16 v[102:103], v8 offset:8448
s_waitcnt lgkmcnt(12)
v_smfmac_f32_16x16x64_bf16 v[12:15], v[64:67], a[0:7], v3
ds_read_b64_tr_b16 v[116:117], v8 offset:12288
ds_read_b64_tr_b16 v[118:119], v8 offset:12544
v_smfmac_f32_16x16x64_bf16 v[16:19], v[64:67], a[128:135], v3
s_waitcnt lgkmcnt(12)
v_smfmac_f32_16x16x64_bf16 v[12:15], v[80:83], a[32:39], v3
ds_read_b64_tr_b16 v[72:73], v26 offset:0
ds_read_b64_tr_b16 v[74:75], v26 offset:256
v_smfmac_f32_16x16x64_bf16 v[16:19], v[80:83], a[160:167], v3
s_waitcnt lgkmcnt(12)
v_smfmac_f32_16x16x64_bf16 v[12:15], v[96:99], a[64:71], v3
ds_read_b64_tr_b16 v[88:89], v26 offset:4096
ds_read_b64_tr_b16 v[90:91], v26 offset:4352
v_smfmac_f32_16x16x64_bf16 v[16:19], v[96:99], a[192:199], v3
s_waitcnt lgkmcnt(12)
v_smfmac_f32_16x16x64_bf16 v[12:15], v[112:115], a[96:103], v3
ds_read_b64_tr_b16 v[104:105], v26 offset:8192
ds_read_b64_tr_b16 v[106:107], v26 offset:8448
v_smfmac_f32_16x16x64_bf16 v[16:19], v[112:115], a[224:231], v3
s_waitcnt lgkmcnt(12)
v_smfmac_f32_16x16x64_bf16 v[12:15], v[68:71], a[8:15], v3
ds_read_b64_tr_b16 v[120:121], v26 offset:12288
ds_read_b64_tr_b16 v[122:123], v26 offset:12544
v_smfmac_f32_16x16x64_bf16 v[16:19], v[68:71], a[136:143], v3
s_waitcnt lgkmcnt(12)
v_smfmac_f32_16x16x64_bf16 v[12:15], v[84:87], a[40:47], v3
ds_read_b64_tr_b16 v[76:77], v27 offset:0
ds_read_b64_tr_b16 v[78:79], v27 offset:256
v_smfmac_f32_16x16x64_bf16 v[16:19], v[84:87], a[168:175], v3
s_waitcnt lgkmcnt(12)
v_smfmac_f32_16x16x64_bf16 v[12:15], v[100:103], a[72:79], v3
ds_read_b64_tr_b16 v[92:93], v27 offset:4096
ds_read_b64_tr_b16 v[94:95], v27 offset:4352
v_smfmac_f32_16x16x64_bf16 v[16:19], v[100:103], a[200:207], v3
s_waitcnt lgkmcnt(12)
v_smfmac_f32_16x16x64_bf16 v[12:15], v[116:119], a[104:111], v3
ds_read_b64_tr_b16 v[108:109], v27 offset:8192
ds_read_b64_tr_b16 v[110:111], v27 offset:8448
v_smfmac_f32_16x16x64_bf16 v[16:19], v[116:119], a[232:239], v3
s_waitcnt lgkmcnt(12)
v_smfmac_f32_16x16x64_bf16 v[12:15], v[72:75], a[16:23], v3
ds_read_b64_tr_b16 v[124:125], v27 offset:12288
ds_read_b64_tr_b16 v[126:127], v27 offset:12544
v_smfmac_f32_16x16x64_bf16 v[16:19], v[72:75], a[144:151], v3
s_waitcnt lgkmcnt(12)
v_smfmac_f32_16x16x64_bf16 v[12:15], v[88:91], a[48:55], v3
v_smfmac_f32_16x16x64_bf16 v[16:19], v[88:91], a[176:183], v3
s_waitcnt lgkmcnt(10)
v_smfmac_f32_16x16x64_bf16 v[12:15], v[104:107], a[80:87], v3
v_smfmac_f32_16x16x64_bf16 v[16:19], v[104:107], a[208:215], v3
s_waitcnt lgkmcnt(8)
v_smfmac_f32_16x16x64_bf16 v[12:15], v[120:123], a[112:119], v3
v_smfmac_f32_16x16x64_bf16 v[16:19], v[120:123], a[240:247], v3
s_waitcnt lgkmcnt(6)
v_smfmac_f32_16x16x64_bf16 v[12:15], v[76:79], a[24:31], v3
v_smfmac_f32_16x16x64_bf16 v[16:19], v[76:79], a[152:159], v3
s_waitcnt lgkmcnt(4)
v_smfmac_f32_16x16x64_bf16 v[12:15], v[92:95], a[56:63], v3
v_smfmac_f32_16x16x64_bf16 v[16:19], v[92:95], a[184:191], v3
s_waitcnt lgkmcnt(2)
v_smfmac_f32_16x16x64_bf16 v[12:15], v[108:111], a[88:95], v3
v_smfmac_f32_16x16x64_bf16 v[16:19], v[108:111], a[216:223], v3
s_waitcnt lgkmcnt(0)
v_smfmac_f32_16x16x64_bf16 v[12:15], v[124:127], a[120:127], v3
v_smfmac_f32_16x16x64_bf16 v[16:19], v[124:127], a[248:255], v3
s_add_u32 s69, s82, s68
s_add_u32 s70, s84, s68
s_nop 5
v_permlane32_swap_b32 v12, v16
v_permlane32_swap_b32 v13, v17
v_permlane32_swap_b32 v14, v18
v_permlane32_swap_b32 v15, v19
v_pk_add_f32 v[12:13], v[12:13], v[16:17]
v_pk_add_f32 v[14:15], v[14:15], v[18:19]
v_cvt_pk_bf16_f32 v12, v12, v13
v_cvt_pk_bf16_f32 v13, v14, v15
ds_write_b64 v24, v[12:13]
s_waitcnt lgkmcnt(0)
s_barrier
ds_read_b64_tr_b16 v[32:33], v25 offset:0
ds_read_b64_tr_b16 v[34:35], v25 offset:64
ds_read_b64_tr_b16 v[36:37], v25 offset:512
ds_read_b64_tr_b16 v[38:39], v25 offset:576
s_cmp_lg_u32 s65, 2
s_cbranch_scc1 Lq_9
s_waitcnt vmcnt(1)
ds_read_b64_tr_b16 v[56:57], v25 offset:1024
ds_read_b64_tr_b16 v[58:59], v25 offset:1088
ds_read_b64_tr_b16 v[60:61], v25 offset:1536
ds_read_b64_tr_b16 v[62:63], v25 offset:1600
Lq_9:
s_cmp_eq_u32 s67, 63
s_cselect_b32 s71, 3, s65
s_cmp_eq_u32 s71, 3
s_waitcnt lgkmcnt(0)
s_cbranch_scc1 Lq_8
s_waitcnt vmcnt(1)
v_mfma_f32_16x16x32_bf16 v[44:47], v[56:59], v[32:35], 0
v_mfma_f32_16x16x32_bf16 v[44:47], v[60:63], v[36:39], v[44:47]
s_mov_b64 exec, s[4:5]
s_nop 4
s_cmp_eq_u32 s66, 0
s_cbranch_scc1 Ls_10
buffer_store_dwordx4 v[44:47], v4, s[60:63], s69 offen
s_branch Ls_11
Ls_10:
buffer_store_dwordx4 v[44:47], v4, s[60:63], s69 offen sc1
Ls_11:
s_mov_b64 exec, -1
Lq_8:
v_smfmac_f32_16x16x64_bf16 v[20:23], v[64:67], v[128:135], v3
v_smfmac_f32_16x16x64_bf16 v[20:23], v[68:71], v[136:143], v3
v_smfmac_f32_16x16x64_bf16 v[20:23], v[72:75], v[144:151], v3
v_smfmac_f32_16x16x64_bf16 v[20:23], v[76:79], v[152:159], v3
v_smfmac_f32_16x16x64_bf16 v[20:23], v[80:83], v[160:167], v3
v_smfmac_f32_16x16x64_bf16 v[20:23], v[84:87], v[168:175], v3
v_smfmac_f32_16x16x64_bf16 v[20:23], v[88:91], v[176:183], v3
v_smfmac_f32_16x16x64_bf16 v[20:23], v[92:95], v[184:191], v3
v_smfmac_f32_16x16x64_bf16 v[20:23], v[96:99], v[192:199], v3
v_smfmac_f32_16x16x64_bf16 v[20:23], v[100:103], v[200:207], v3
v_smfmac_f32_16x16x64_bf16 v[20:23], v[104:107], v[208:215], v3
buffer_load_dwordx4 v[32:35], v2, s[60:63], s70 offen offset:0 sc1
buffer_load_dwordx4 v[36:39], v2, s[60:63], s70 offen offset:1024 sc1
buffer_load_dwordx4 v[40:43], v2, s[60:63], s70 offen offset:2048 sc1
v_smfmac_f32_16x16x64_bf16 v[20:23], v[108:111], v[216:223], v3
v_smfmac_f32_16x16x64_bf16 v[20:23], v[112:115], v[224:231], v3
v_smfmac_f32_16x16x64_bf16 v[20:23], v[116:119], v[232:239], v3
v_smfmac_f32_16x16x64_bf16 v[20:23], v[120:123], v[240:247], v3
v_smfmac_f32_16x16x64_bf16 v[20:23], v[124:127], v[248:255], v3
ds_read_b128 v[64:67], v31 offset:0
ds_read_b128 v[68:71], v31 offset:1024
ds_read_b128 v[72:75], v31 offset:2048
ds_read_b128 v[76:79], v31 offset:3072
ds_read_b128 v[80:83], v31 offset:4096
ds_read_b128 v[84:87], v31 offset:5120
ds_read_b128 v[88:91], v31 offset:6144
ds_read_b128 v[92:95], v31 offset:7168
ds_read_b128 v[96:99], v31 offset:32768
ds_read_b128 v[100:103], v31 offset:33792
ds_read_b128 v[104:107], v31 offset:34816
ds_read_b128 v[108:111], v31 offset:35840
v_mov_b32 v16, v20
v_mov_b32 v17, v21
v_mov_b32 v18, v22
v_mov_b32 v19, v23
v_mov_b32 v112, 0x3f803f80
v_mov_b32 v113, 0x3f803f80
v_mov_b32 v114, 0x3f803f80
v_mov_b32 v115, 0x3f803f80
v_permlane32_swap_b32 v16, v20
v_permlane32_swap_b32 v17, v21
v_permlane32_swap_b32 v18, v22
v_permlane32_swap_b32 v19, v23
v_add_f32 v20, v16, v20
v_add_f32 v21, v17, v21
v_add_f32 v22, v18, v22
v_add_f32 v23, v19, v23
v_cvt_pk_bf16_f32 v20, v20, v21
v_cvt_pk_bf16_f32 v21, v22, v23
v_mov_b32 v22, 0
v_mov_b32 v23, 0
s_cmp_eq_u32 s67, 63
s_cbranch_scc1 L_ch_F
s_waitcnt vmcnt(2)
v_max3_u32 v9, v32, v33, v34
v_max_u32 v9, v9, v35
s_waitcnt vmcnt(1)
v_max3_u32 v9, v9, v36, v37
v_max3_u32 v9, v9, v38, v39
s_waitcnt vmcnt(0)
v_max3_u32 v9, v9, v40, v41
v_max3_u32 v9, v9, v42, v43
v_cmp_eq_u32 vcc, -1, v9
s_cbranch_vccz Lp_13
s_mov_b32 s78, 0
Lp_12:
buffer_load_dwordx4 v[32:35], v2, s[60:63], s70 offen offset:0 sc1
buffer_load_dwordx4 v[36:39], v2, s[60:63], s70 offen offset:1024 sc1
buffer_load_dwordx4 v[40:43], v2, s[60:63], s70 offen offset:2048 sc1
s_add_u32 s78, s78, 1
s_add_u32 s87, s87, 1
s_waitcnt vmcnt(2)
v_max3_u32 v9, v32, v33, v34
v_max_u32 v9, v9, v35
s_waitcnt vmcnt(1)
v_max3_u32 v9, v9, v36, v37
v_max3_u32 v9, v9, v38, v39
s_waitcnt vmcnt(0)
v_max3_u32 v9, v9, v40, v41
v_max3_u32 v9, v9, v42, v43
v_cmp_eq_u32 vcc, -1, v9
s_cmp_gt_u32 s78, 0x40000
s_cbranch_scc1 Lp_13
s_cbranch_vccnz Lp_12
Lp_13:
v_add_f32_dpp v32, v32, v32 row_ror:8 row_mask:0xf bank_mask:0xf
v_add_f32_dpp v33, v33, v33 row_ror:8 row_mask:0xf bank_mask:0xf
v_add_f32_dpp v34, v34, v34 row_ror:8 row_mask:0xf bank_mask:0xf
v_add_f32_dpp v35, v35, v35 row_ror:8 row_mask:0xf bank_mask:0xf
v_add_f32_dpp v36, v36, v36 row_ror:8 row_mask:0xf bank_mask:0xf
v_add_f32_dpp v37, v37, v37 row_ror:8 row_mask:0xf bank_mask:0xf
v_add_f32_dpp v38, v38, v38 row_ror:8 row_mask:0xf bank_mask:0xf
v_add_f32_dpp v39, v39, v39 row_ror:8 row_mask:0xf bank_mask:0xf
v_add_f32_dpp v40, v40, v40 row_ror:8 row_mask:0xf bank_mask:0xf
v_add_f32_dpp v41, v41, v41 row_ror:8 row_mask:0xf bank_mask:0xf
v_add_f32_dpp v42, v42, v42 row_ror:8 row_mask:0xf bank_mask:0xf
v_add_f32_dpp v43, v43, v43 row_ror:8 row_mask:0xf bank_mask:0xf
v_max3_f32 v9, v32, v33, v34
v_max3_f32 v10, v35, v36, v37
v_max3_f32 v9, v9, v38, v39
v_max3_f32 v10, v10, v40, v41
v_max3_f32 v9, v9, v42, v43
v_max_f32 v9, v9, v10
v_mov_b32 v10, v9
s_add_u32 s69, s81, s68
s_add_u32 s70, s83, s68
v_permlane32_swap_b32 v9, v10
v_max_f32 v9, v9, v10
v_mov_b32 v10, v9
s_add_u32 s71, s70, 4096
s_nop 0
v_permlane16_swap_b32 v9, v10
v_max_f32 v9, v9, v10
v_mul_f32 v12, s42, v9
v_fma_f32 v14, v9, s42, -v29
v_pk_fma_f32 v[32:33], v[32:33], s[42:43], v[12:13] op_sel_hi:[1,1,0] neg_lo:[0,0,1] neg_hi:[0,0,1]
v_pk_fma_f32 v[34:35], v[34:35], s[42:43], v[12:13] op_sel_hi:[1,1,0] neg_lo:[0,0,1] neg_hi:[0,0,1]
v_pk_fma_f32 v[36:37], v[36:37], s[42:43], v[12:13] op_sel_hi:[1,1,0] neg_lo:[0,0,1] neg_hi:[0,0,1]
v_pk_fma_f32 v[38:39], v[38:39], s[42:43], v[12:13] op_sel_hi:[1,1,0] neg_lo:[0,0,1] neg_hi:[0,0,1]
v_pk_fma_f32 v[40:41], v[40:41], s[42:43], v[14:15] op_sel_hi:[1,1,0] neg_lo:[0,0,1] neg_hi:[0,0,1]
v_pk_fma_f32 v[42:43], v[42:43], s[42:43], v[14:15] op_sel_hi:[1,1,0] neg_lo:[0,0,1] neg_hi:[0,0,1]
v_exp_f32 v32, v32
v_exp_f32 v33, v33
v_exp_f32 v34, v34
v_exp_f32 v35, v35
v_exp_f32 v36, v36
v_exp_f32 v37, v37
v_exp_f32 v38, v38
v_exp_f32 v39, v39
v_exp_f32 v40, v40
v_exp_f32 v41, v41
v_exp_f32 v42, v42
v_exp_f32 v43, v43
v_cvt_pk_bf16_f32 v44, v32, v33
v_cvt_pk_bf16_f32 v45, v34, v35
v_cvt_pk_bf16_f32 v46, v36, v37
v_cvt_pk_bf16_f32 v47, v38, v39
v_cvt_pk_bf16_f32 v48, v40, v41
v_cvt_pk_bf16_f32 v49, v42, v43
v_mfma_f32_16x16x32_bf16 v[16:19], v[112:115], v[44:47], 0
v_mfma_f32_16x16x32_bf16 v[12:15], v[52:55], v[44:47], 0
v_mfma_f32_16x16x32_bf16 v[16:19], v[112:115], v[48:51], v[16:19]
v_mfma_f32_16x16x32_bf16 v[12:15], v[20:23], v[48:51], v[12:15]
s_mov_b64 exec, s[4:5]
s_nop 5
v_rcp_f32 v16, v16
s_nop 0
v_pk_mul_f32 v[12:13], v[12:13], v[16:17] op_sel_hi:[1,0]
v_pk_mul_f32 v[14:15], v[14:15], v[16:17] op_sel_hi:[1,0]
v_cvt_pk_bf16_f32 v12, v12, v13
v_cvt_pk_bf16_f32 v13, v14, v15
s_cmp_eq_u32 s66, 0
s_cbranch_scc1 Ls_14
buffer_store_dwordx2 v[12:13], v5, s[60:63], s69 offen
s_branch Ls_15
Ls_14:
buffer_store_dwordx2 v[12:13], v5, s[60:63], s69 offen sc1
Ls_15:
s_mov_b64 exec, -1
s_sleep 6
buffer_load_dwordx4 v[32:35], v2, s[60:63], s70 offen offset:0 sc1
buffer_load_dwordx4 v[36:39], v2, s[60:63], s70 offen offset:1024 sc1
buffer_load_dwordx4 v[40:43], v2, s[60:63], s70 offen offset:2048 sc1
buffer_load_dwordx4 v[44:47], v2, s[60:63], s70 offen offset:3072 sc1
buffer_load_dwordx4 v[112:115], v2, s[60:63], s71 offen offset:0 sc1
buffer_load_dwordx4 v[116:119], v2, s[60:63], s71 offen offset:1024 sc1
buffer_load_dwordx4 v[120:123], v2, s[60:63], s71 offen offset:2048 sc1
buffer_load_dwordx4 v[124:127], v2, s[60:63], s71 offen offset:3072 sc1
v_mov_b32 v12, 0
v_mov_b32 v13, 0
v_mov_b32 v14, 0
v_mov_b32 v15, 0
v_mov_b32 v16, 0
v_mov_b32 v17, 0
v_mov_b32 v18, 0
v_mov_b32 v19, 0
v_mov_b32 v48, v20
v_mov_b32 v49, v21
s_lshl_b32 s69, s65, 10
v_add_u32 v22, 149504, v2
v_add_u32 v23, s69, v22
s_waitcnt lgkmcnt(0)
s_waitcnt vmcnt(7)
v_max3_u32 v9, v32, v33, v34
v_max_u32 v9, v9, v35
v_smfmac_f32_16x16x64_bf16 v[12:15], v[32:35], v[64:71], v3
ds_read_b128 v[64:67], v31 offset:36864
ds_read_b128 v[68:71], v31 offset:37888
v_smfmac_f32_16x16x64_bf16 v[16:19], v[32:35], v[72:79], v3
ds_read_b128 v[72:75], v31 offset:38912
ds_read_b128 v[76:79], v31 offset:39936
s_waitcnt vmcnt(6)
v_max3_u32 v9, v9, v36, v37
v_max3_u32 v9, v9, v38, v39
v_smfmac_f32_16x16x64_bf16 v[12:15], v[36:39], v[80:87], v3
ds_read_b128 v[80:83], v11 offset:0
ds_read_b128 v[84:87], v11 offset:1024
v_smfmac_f32_16x16x64_bf16 v[16:19], v[36:39], v[88:95], v3
ds_read_b128 v[88:91], v11 offset:2048
ds_read_b128 v[92:95], v11 offset:3072
s_waitcnt vmcnt(5)
v_max3_u32 v9, v9, v40, v41
v_max3_u32 v9, v9, v42, v43
v_smfmac_f32_16x16x64_bf16 v[12:15], v[40:43], v[96:103], v3
ds_read_b128 v[96:99], v11 offset:4096
ds_read_b128 v[100:103], v11 offset:5120
v_smfmac_f32_16x16x64_bf16 v[16:19], v[40:43], v[104:111], v3
ds_read_b128 v[104:107], v11 offset:6144
ds_read_b128 v[108:111], v11 offset:7168
s_waitcnt vmcnt(4)
v_max3_u32 v9, v9, v44, v45
v_max3_u32 v9, v9, v46, v47
s_waitcnt lgkmcnt(10)
v_smfmac_f32_16x16x64_bf16 v[12:15], v[44:47], v[64:71], v3
ds_read_b128 v[64:67], v11 offset:32768
ds_read_b128 v[68:71], v11 offset:33792
s_waitcnt lgkmcnt(10)
v_smfmac_f32_16x16x64_bf16 v[16:19], v[44:47], v[72:79], v3
ds_read_b128 v[72:75], v11 offset:34816
ds_read_b128 v[76:79], v11 offset:35840
s_waitcnt vmcnt(3)
v_max3_u32 v9, v9, v112, v113
v_max3_u32 v9, v9, v114, v115
s_waitcnt lgkmcnt(10)
v_smfmac_f32_16x16x64_bf16 v[12:15], v[112:115], v[80:87], v3
ds_read_b128 v[80:83], v11 offset:36864
ds_read_b128 v[84:87], v11 offset:37888
s_waitcnt lgkmcnt(10)
v_smfmac_f32_16x16x64_bf16 v[16:19], v[112:115], v[88:95], v3
ds_read_b128 v[88:91], v11 offset:38912
ds_read_b128 v[92:95], v11 offset:39936
s_waitcnt vmcnt(2)
v_max3_u32 v9, v9, v116, v117
v_max3_u32 v9, v9, v118, v119
s_waitcnt lgkmcnt(10)
v_smfmac_f32_16x16x64_bf16 v[12:15], v[116:119], v[96:103], v3
s_waitcnt lgkmcnt(8)
v_smfmac_f32_16x16x64_bf16 v[16:19], v[116:119], v[104:111], v3
s_waitcnt vmcnt(1)
v_max3_u32 v9, v9, v120, v121
v_max3_u32 v9, v9, v122, v123
s_waitcnt lgkmcnt(6)
v_smfmac_f32_16x16x64_bf16 v[12:15], v[120:123], v[64:71], v3
s_waitcnt lgkmcnt(4)
v_smfmac_f32_16x16x64_bf16 v[16:19], v[120:123], v[72:79], v3
s_waitcnt vmcnt(0)
v_max3_u32 v9, v9, v124, v125
v_max3_u32 v9, v9, v126, v127
s_waitcnt lgkmcnt(2)
v_smfmac_f32_16x16x64_bf16 v[12:15], v[124:127], v[80:87], v3
s_waitcnt lgkmcnt(0)
v_smfmac_f32_16x16x64_bf16 v[16:19], v[124:127], v[88:95], v3
v_cmp_eq_u32 vcc, -1, v9
s_cbranch_vccz L_ch_Eok
s_add_u32 s87, s87, 1
buffer_load_dwordx4 v[32:35], v2, s[60:63], s70 offen offset:0 sc1
buffer_load_dwordx4 v[36:39], v2, s[60:63], s70 offen offset:1024 sc1
buffer_load_dwordx4 v[40:43], v2, s[60:63], s70 offen offset:2048 sc1
buffer_load_dwordx4 v[44:47], v2, s[60:63], s70 offen offset:3072 sc1
buffer_load_dwordx4 v[112:115], v2, s[60:63], s71 offen offset:0 sc1
buffer_load_dwordx4 v[116:119], v2, s[60:63], s71 offen offset:1024 sc1
buffer_load_dwordx4 v[120:123], v2, s[60:63], s71 offen offset:2048 sc1
buffer_load_dwordx4 v[124:127], v2, s[60:63], s71 offen offset:3072 sc1
ds_read_b128 v[64:67], v31 offset:0
ds_read_b128 v[68:71], v31 offset:1024
ds_read_b128 v[72:75], v31 offset:2048
ds_read_b128 v[76:79], v31 offset:3072
ds_read_b128 v[80:83], v31 offset:4096
ds_read_b128 v[84:87], v31 offset:5120
ds_read_b128 v[88:91], v31 offset:6144
ds_read_b128 v[92:95], v31 offset:7168
ds_read_b128 v[96:99], v31 offset:32768
ds_read_b128 v[100:103], v31 offset:33792
ds_read_b128 v[104:107], v31 offset:34816
ds_read_b128 v[108:111], v31 offset:35840
v_mov_b32 v12, 0
v_mov_b32 v13, 0
v_mov_b32 v14, 0
v_mov_b32 v15, 0
v_mov_b32 v16, 0
v_mov_b32 v17, 0
v_mov_b32 v18, 0
v_mov_b32 v19, 0
s_waitcnt lgkmcnt(0)
s_waitcnt vmcnt(7)
v_max3_u32 v9, v32, v33, v34
v_max_u32 v9, v9, v35
s_waitcnt vmcnt(6)
v_max3_u32 v9, v9, v36, v37
v_max3_u32 v9, v9, v38, v39
s_waitcnt vmcnt(5)
v_max3_u32 v9, v9, v40, v41
v_max3_u32 v9, v9, v42, v43
s_waitcnt vmcnt(4)
v_max3_u32 v9, v9, v44, v45
v_max3_u32 v9, v9, v46, v47
s_waitcnt vmcnt(3)
v_max3_u32 v9, v9, v112, v113
v_max3_u32 v9, v9, v114, v115
s_waitcnt vmcnt(2)
v_max3_u32 v9, v9, v116, v117
v_max3_u32 v9, v9, v118, v119
s_waitcnt vmcnt(1)
v_max3_u32 v9, v9, v120, v121
v_max3_u32 v9, v9, v122, v123
s_waitcnt vmcnt(0)
v_max3_u32 v9, v9, v124, v125
v_max3_u32 v9, v9, v126, v127
v_cmp_eq_u32 vcc, -1, v9
s_cbranch_vccz Lp_17
s_mov_b32 s78, 0
Lp_16:
buffer_load_dwordx4 v[32:35], v2, s[60:63], s70 offen offset:0 sc1
buffer_load_dwordx4 v[36:39], v2, s[60:63], s70 offen offset:1024 sc1
buffer_load_dwordx4 v[40:43], v2, s[60:63], s70 offen offset:2048 sc1
buffer_load_dwordx4 v[44:47], v2, s[60:63], s70 offen offset:3072 sc1
buffer_load_dwordx4 v[112:115], v2, s[60:63], s71 offen offset:0 sc1
buffer_load_dwordx4 v[116:119], v2, s[60:63], s71 offen offset:1024 sc1
buffer_load_dwordx4 v[120:123], v2, s[60:63], s71 offen offset:2048 sc1
buffer_load_dwordx4 v[124:127], v2, s[60:63], s71 offen offset:3072 sc1
s_add_u32 s78, s78, 1
s_add_u32 s87, s87, 1
s_waitcnt vmcnt(7)
v_max3_u32 v9, v32, v33, v34
v_max_u32 v9, v9, v35
s_waitcnt vmcnt(6)
v_max3_u32 v9, v9, v36, v37
v_max3_u32 v9, v9, v38, v39
s_waitcnt vmcnt(5)
v_max3_u32 v9, v9, v40, v41
v_max3_u32 v9, v9, v42, v43
s_waitcnt vmcnt(4)
v_max3_u32 v9, v9, v44, v45
v_max3_u32 v9, v9, v46, v47
s_waitcnt vmcnt(3)
v_max3_u32 v9, v9, v112, v113
v_max3_u32 v9, v9, v114, v115
s_waitcnt vmcnt(2)
v_max3_u32 v9, v9, v116, v117
v_max3_u32 v9, v9, v118, v119
s_waitcnt vmcnt(1)
v_max3_u32 v9, v9, v120, v121
v_max3_u32 v9, v9, v122, v123
s_waitcnt vmcnt(0)
v_max3_u32 v9, v9, v124, v125
v_max3_u32 v9, v9, v126, v127
v_cmp_eq_u32 vcc, -1, v9
s_cmp_gt_u32 s78, 0x40000
s_cbranch_scc1 Lp_17
s_cbranch_vccnz Lp_16
Lp_17:
v_smfmac_f32_16x16x64_bf16 v[12:15], v[32:35], v[64:71], v3
ds_read_b128 v[64:67], v31 offset:36864
ds_read_b128 v[68:71], v31 offset:37888
v_smfmac_f32_16x16x64_bf16 v[16:19], v[32:35], v[72:79], v3
ds_read_b128 v[72:75], v31 offset:38912
ds_read_b128 v[76:79], v31 offset:39936
v_smfmac_f32_16x16x64_bf16 v[12:15], v[36:39], v[80:87], v3
ds_read_b128 v[80:83], v11 offset:0
ds_read_b128 v[84:87], v11 offset:1024
v_smfmac_f32_16x16x64_bf16 v[16:19], v[36:39], v[88:95], v3
ds_read_b128 v[88:91], v11 offset:2048
ds_read_b128 v[92:95], v11 offset:3072
v_smfmac_f32_16x16x64_bf16 v[12:15], v[40:43], v[96:103], v3
ds_read_b128 v[96:99], v11 offset:4096
ds_read_b128 v[100:103], v11 offset:5120
v_smfmac_f32_16x16x64_bf16 v[16:19], v[40:43], v[104:111], v3
ds_read_b128 v[104:107], v11 offset:6144
ds_read_b128 v[108:111], v11 offset:7168
s_waitcnt lgkmcnt(10)
v_smfmac_f32_16x16x64_bf16 v[12:15], v[44:47], v[64:71], v3
ds_read_b128 v[64:67], v11 offset:32768
ds_read_b128 v[68:71], v11 offset:33792
s_waitcnt lgkmcnt(10)
v_smfmac_f32_16x16x64_bf16 v[16:19], v[44:47], v[72:79], v3
ds_read_b128 v[72:75], v11 offset:34816
ds_read_b128 v[76:79], v11 offset:35840
s_waitcnt lgkmcnt(10)
v_smfmac_f32_16x16x64_bf16 v[12:15], v[112:115], v[80:87], v3
ds_read_b128 v[80:83], v11 offset:36864
ds_read_b128 v[84:87], v11 offset:37888
s_waitcnt lgkmcnt(10)
v_smfmac_f32_16x16x64_bf16 v[16:19], v[112:115], v[88:95], v3
ds_read_b128 v[88:91], v11 offset:38912
ds_read_b128 v[92:95], v11 offset:39936
s_waitcnt lgkmcnt(10)
v_smfmac_f32_16x16x64_bf16 v[12:15], v[116:119], v[96:103], v3
s_waitcnt lgkmcnt(8)
v_smfmac_f32_16x16x64_bf16 v[16:19], v[116:119], v[104:111], v3
s_waitcnt lgkmcnt(6)
v_smfmac_f32_16x16x64_bf16 v[12:15], v[120:123], v[64:71], v3
s_waitcnt lgkmcnt(4)
v_smfmac_f32_16x16x64_bf16 v[16:19], v[120:123], v[72:79], v3
s_waitcnt lgkmcnt(2)
v_smfmac_f32_16x16x64_bf16 v[12:15], v[124:127], v[80:87], v3
s_waitcnt lgkmcnt(0)
v_smfmac_f32_16x16x64_bf16 v[16:19], v[124:127], v[88:95], v3
L_ch_Eok:
s_add_u32 s69, s68, s85
s_add_u32 s70, s68, s86
s_nop 5
v_permlane32_swap_b32 v12, v16
v_permlane32_swap_b32 v13, v17
v_permlane32_swap_b32 v14, v18
v_permlane32_swap_b32 v15, v19
v_pk_add_f32 v[12:13], v[12:13], v[16:17]
v_pk_add_f32 v[14:15], v[14:15], v[18:19]
ds_write_b128 v23, v[12:15]
s_cmp_ge_u32 s65, 2
s_waitcnt lgkmcnt(0)
s_barrier
s_cbranch_scc1 Lr_18
ds_read_b128 v[32:35], v22 offset:0
ds_read_b128 v[36:39], v22 offset:1024
ds_read_b128 v[40:43], v22 offset:2048
ds_read_b128 v[44:47], v22 offset:3072
s_cmp_eq_u32 s65, 0
s_waitcnt lgkmcnt(2)
v_pk_add_f32 v[32:33], v[32:33], v[36:37]
v_pk_add_f32 v[34:35], v[34:35], v[38:39]
s_waitcnt lgkmcnt(1)
v_pk_add_f32 v[32:33], v[32:33], v[40:41]
v_pk_add_f32 v[34:35], v[34:35], v[42:43]
s_waitcnt lgkmcnt(0)
v_pk_add_f32 v[32:33], v[32:33], v[44:45]
v_pk_add_f32 v[34:35], v[34:35], v[46:47]
v_cvt_pk_bf16_f32 v32, v32, v33
v_cvt_pk_bf16_f32 v33, v34, v35
s_cbranch_scc1 Lr_19
s_cmp_eq_u32 s66, 0
s_cbranch_scc1 Ls_20
buffer_store_dwordx2 v[32:33], v30, s[60:63], s69 offen
s_branch Ls_21
Ls_20:
buffer_store_dwordx2 v[32:33], v30, s[60:63], s69 offen sc1
Ls_21:
s_branch Lr_18
Lr_19:
buffer_store_dwordx2 v[32:33], v30, s[60:63], s70 offen sc1
Lr_18:
v_lshrrev_b32 v9, 1, v2
s_mov_b64 exec, s[6:7]
buffer_store_dwordx2 v[48:49], v9, s[60:63], s80 offen sc1
s_cmp_lg_u32 s65, 2
s_mov_b64 exec, -1
s_cbranch_scc1 Lv_22
v_and_b32 v10, 0x70, v2
v_and_b32 v9, 0x180, v9
v_or_b32 v9, v9, v10
s_mov_b64 exec, s[4:5]
buffer_store_dwordx4 v[56:59], v9, s[60:63], s79 offen sc1
buffer_store_dwordx4 v[60:63], v9, s[60:63], s79 offen offset:512 sc1
s_mov_b64 exec, -1
Lv_22:
s_add_u32 s79, s79, 131072
s_add_u32 s80, s80, 131072
v_readfirstlane_b32 s69, v28
s_add_u32 s67, s67, 1
s_cmp_ge_u32 s69, 128
s_cbranch_scc1 Lc_23
s_lshr_b32 s69, s67, 3
s_lshl_b32 s69, s69, 2
s_add_u32 s69, s69, 64
s_mov_b32 s78, 0
v_mov_b32 v9, 0
Lw_24:
buffer_load_dword v10, v9, s[56:59], s69 offen sc1
s_waitcnt vmcnt(0)
v_readfirstlane_b32 s71, v10
s_add_u32 s78, s78, 1
s_cmp_gt_u32 s78, 0x40000
s_cbranch_scc1 Lw_25
s_cmp_ge_u32 s71, 128
s_cbranch_scc1 Lw_25
s_sleep 2
s_branch Lw_24
Lw_25:
Lc_23:
s_cmp_eq_u32 s65, 2
s_cbranch_scc1 Lk_26
buffer_load_dwordx4 v[56:59], v2, s[60:63], s76 offen sc1
buffer_load_dwordx4 v[60:63], v2, s[60:63], s76 offen offset:1024 sc1
Lk_26:
buffer_load_dwordx4 v[52:55], v2, s[60:63], s77 offen sc1
s_add_u32 s76, s76, 524288
s_add_u32 s77, s77, 524288
s_add_u32 s69, s67, 1
s_lshr_b32 s69, s69, 3
s_min_u32 s69, s69, 7
s_lshl_b32 s69, s69, 2
buffer_load_dword v28, v50, s[56:59], s69 offen offset:64 sc1
s_lshl_b32 s69, s64, 2
s_add_u32 s69, s69, s65
s_cmp_lg_u32 s69, 3
s_cbranch_scc1 Lc_27
s_sub_u32 s69, s67, 1
v_mov_b32 v9, s69
s_mov_b64 exec, 1
buffer_store_dword v9, v50, s[56:59], 0 offen offset:160 sc1
s_mov_b64 exec, -1
Lc_27:
s_branch L_ch_step
L_ch_F:
v_mov_b32 v48, v20
v_mov_b32 v49, v21
v_lshrrev_b32 v9, 1, v2
s_mov_b64 exec, s[6:7]
buffer_store_dwordx2 v[48:49], v9, s[60:63], s80 offen sc1
s_cmp_lg_u32 s65, 2
s_mov_b64 exec, -1
s_cbranch_scc1 Lv_28
v_and_b32 v10, 0x70, v2
v_and_b32 v9, 0x180, v9
v_or_b32 v9, v9, v10
s_mov_b64 exec, s[4:5]
buffer_store_dwordx4 v[56:59], v9, s[60:63], s79 offen sc1
buffer_store_dwordx4 v[60:63], v9, s[60:63], s79 offen offset:512 sc1
s_mov_b64 exec, -1
Lv_28:
s_add_u32 s79, s79, 131072
s_add_u32 s80, s80, 131072
s_endpgm
L_worker:
s_sub_u32 s76, s64, 64
s_mov_b32 s91, -1
L_task:
s_mov_b64 s[92:93], s[8:9]
s_mov_b64 s[94:95], s[10:11]
s_mov_b32 s87, -1
s_mov_b32 s88, 1.0
s_mov_b32 s89, 1.0
v_and_b32 v1, 31, v0
v_and_b32 v2, 15, v0
v_lshrrev_b32 v3, 5, v0
v_bfe_u32 v4, v0, 4, 1
s_mov_b32 s100, 1
s_cmp_ge_u32 s76, 576
s_cbranch_scc1 L_t_notkv
s_lshr_b32 s86, s76, 1
s_mov_b32 s85, 0
s_cmp_lt_u32 s76, 128
s_cbranch_scc1 L_t_kv
s_mov_b32 s100, 2
s_sub_u32 s86, s76, 512
s_mov_b32 s85, 7
s_cmp_ge_u32 s76, 512
s_cbranch_scc1 L_t_kv
s_lshr_b32 s85, s76, 7
s_lshl_b32 s85, s85, 1
s_and_b32 s71, s76, 1
s_add_u32 s85, s85, s71
s_sub_u32 s85, s85, 1
s_bfe_u32 s86, s76, 0x60001
L_t_kv:
s_lshl_b32 s71, s85, 3
s_lshr_b32 s72, s86, 3
s_add_u32 s71, s71, s72
s_lshl_b32 s71, s71, 18
s_and_b32 s72, s86, 7
s_mul_i32 s72, s72, 28672
s_add_u32 s71, s71, s72
s_lshl_b32 s72, s65, 10
s_add_u32 s71, s71, s72
s_add_u32 s87, s71, 100663296
s_mov_b32 s3, 8192
s_cmp_ge_u32 s86, 32
s_cbranch_scc1 L_t_v
s_mov_b32 s77, 0
s_mov_b32 s79, 524288
s_mov_b32 s80, 1
s_mov_b32 s81, 8192
s_mov_b32 s82, 1024
s_mov_b32 s83, 512
s_lshl_b32 s84, s85, 2
s_add_u32 s84, s84, 64
s_mov_b64 s[96:97], s[20:21]
s_mov_b64 s[98:99], s[22:23]
v_bfe_u32 v5, v0, 2, 1
v_lshlrev_b32 v62, 11, v5
v_bfe_u32 v5, v0, 3, 2
v_lshl_add_u32 v62, v5, 6, v62
v_and_b32 v5, 3, v0
v_lshl_add_u32 v62, v5, 4, v62
v_lshl_add_u32 v62, v3, 8, v62
s_branch L_gemmT
L_t_v:
s_sub_u32 s86, s86, 32
s_mov_b32 s77, 4096
s_mov_b32 s79, 524288
s_mov_b32 s80, 1
s_mov_b32 s81, 8192
s_mov_b32 s82, 2048
s_mov_b32 s83, 512
s_lshl_b32 s84, s85, 2
s_add_u32 s84, s84, 64
s_mov_b64 s[96:97], s[24:25]
s_mov_b64 s[98:99], s[26:27]
v_lshlrev_b32 v62, 10, v4
v_lshl_add_u32 v62, v2, 4, v62
v_lshl_add_u32 v62, v3, 8, v62
s_branch L_gemmN
L_t_notkv:
s_cmp_ge_u32 s76, 640
s_cbranch_scc1 L_t_notqb
s_sub_u32 s71, s76, 576
s_lshr_b32 s85, s71, 3
s_and_b32 s86, s71, 7
s_mov_b32 s77, 58720256
s_mov_b32 s79, 65536
s_mov_b32 s80, 0
s_mov_b32 s81, 2048
s_mov_b32 s82, 0
s_mov_b32 s83, 1024
s_lshl_b32 s84, s85, 2
s_add_u32 s84, s84, 128
s_mov_b64 s[96:97], s[32:33]
s_mov_b64 s[98:99], s[34:35]
s_mov_b32 s88, 1048744942
s_mov_b32 s89, 1048744942
s_mov_b32 s3, 2048
v_lshlrev_b32 v62, 4, v0
s_branch L_gemmT
L_t_notqb:
s_cmp_ge_u32 s76, 656
s_cbranch_scc1 L_t_notkb
s_sub_u32 s71, s76, 640
s_lshr_b32 s85, s71, 1
s_mov_b32 s86, 0
s_mov_b32 s3, 64
s_mov_b32 s77, 62914560
s_mov_b32 s79, 2048
s_mov_b32 s80, 2
s_mov_b32 s81, 0
s_mov_b32 s82, 268435456
s_mov_b32 s83, 1024
s_mov_b32 s84, 100
s_and_b32 s71, s76, 1
s_cbranch_scc1 L_t_vb
s_mov_b64 s[96:97], s[36:37]
s_mov_b64 s[98:99], s[38:39]
v_bfe_u32 v5, v0, 2, 1
v_lshl_add_u32 v5, v4, 1, v5
v_lshlrev_b32 v62, 7, v5
v_bfe_u32 v5, v0, 3, 1
v_lshl_add_u32 v62, v5, 6, v62
v_and_b32 v5, 3, v0
v_lshl_add_u32 v62, v5, 4, v62
v_lshl_add_u32 v62, v3, 9, v62
s_branch L_gemmT
L_t_vb:
s_mov_b32 s77, 63045632
s_mov_b64 s[96:97], s[40:41]
s_mov_b64 s[98:99], s[42:43]
v_lshlrev_b32 v62, 4, v0
s_branch L_gemmN
L_t_notkb:
s_cmp_ge_u32 s76, 912
s_cbranch_scc1 L_t_attn
s_sub_u32 s71, s76, 656
s_and_b32 s85, s71, 7
s_lshr_b32 s86, s71, 3
s_mov_b32 s3, 8192
s_mov_b32 s77, 33554432
s_mov_b32 s79, 262144
s_mov_b32 s80, 2
s_mov_b32 s81, 8192
s_mov_b32 s82, 1024
s_mov_b32 s83, 512
s_lshl_b32 s84, s85, 2
s_add_u32 s84, s84, 192
s_mov_b64 s[96:97], s[16:17]
s_mov_b64 s[98:99], s[18:19]
v_lshlrev_b32 v62, 12, v4
v_lshl_add_u32 v62, v2, 4, v62
v_lshl_add_u32 v62, v3, 8, v62
L_gemmT:
s_cmp_lt_u32 s76, 128
s_cbranch_scc1 L_half1
v_lshrrev_b32 v40, 3, v0
s_lshl_b32 s71, s65, 3
v_add_u32 v40, s71, v40
v_bfe_u32 v41, v40, 1, 3
v_and_b32 v42, 7, v0
v_xor_b32 v41, v41, v42
v_lshlrev_b32 v41, 4, v41
s_mov_b32 s71, 2048
v_mul_lo_u32 v40, v40, s71
v_add_u32 v40, v40, v41
s_lshl_b32 s71, s71, 5
v_add_u32 v41, s71, v40
v_add_u32 v42, s71, v41
v_add_u32 v43, s71, v42
v_add_u32 v44, s71, v43
v_add_u32 v45, s71, v44
v_add_u32 v46, s71, v45
v_add_u32 v47, s71, v46
v_lshrrev_b32 v48, 4, v0
v_and_b32 v50, 15, v0
v_lshlrev_b32 v49, 2, v48
v_xor_b32 v49, v49, v50
v_lshlrev_b32 v49, 4, v49
s_mul_i32 s71, s65, 4
v_add_u32 v48, s71, v48
s_mov_b32 s71, s3
v_mul_lo_u32 v48, v48, s71
v_add_u32 v48, v48, v49
s_lshl_b32 s68, s71, 6
s_mul_i32 s71, s71, 16
v_add_u32 v49, s71, v48
v_add_u32 v50, s71, v49
v_add_u32 v51, s71, v50
v_and_b32 v58, 31, v0
v_bfe_u32 v59, v0, 1, 3
v_lshrrev_b32 v60, 5, v0
v_xor_b32 v59, v59, v60
s_lshr_b32 s71, s65, 1
s_mul_i32 s71, s71, 16384
v_lshl_add_u32 v58, v58, 7, s71
v_xor_b32 v61, 0, v59
v_lshl_add_u32 v52, v61, 4, v58
v_xor_b32 v61, 2, v59
v_lshl_add_u32 v53, v61, 4, v58
v_xor_b32 v61, 4, v59
v_lshl_add_u32 v54, v61, 4, v58
v_xor_b32 v61, 6, v59
v_lshl_add_u32 v55, v61, 4, v58
v_bfe_u32 v58, v0, 2, 2
v_lshl_add_u32 v60, v60, 3, v58
v_mul_u32_u24 v60, 256, v60
v_bfe_u32 v61, v0, 4, 1
v_lshl_add_u32 v60, v61, 5, v60
v_and_b32 v61, 3, v0
v_lshl_add_u32 v60, v61, 3, v60
v_add_u32 v60, 32768, v60
s_and_b32 s71, s65, 1
s_mul_i32 s71, s71, 2
s_add_u32 s72, s71, 0
v_xor_b32 v61, s72, v58
v_lshl_add_u32 v56, v61, 6, v60
s_add_u32 s72, s71, 1
v_xor_b32 v61, s72, v58
v_lshl_add_u32 v57, v61, 6, v60
s_lshl_b32 s66, s85, 19
s_lshl_b32 s67, s86, 8
s_mov_b32 s69, 16
s_lshl_b32 s73, s65, 10
s_mov_b32 s70, 0
s_mov_b32 s75, 0
s_barrier
s_add_u32 m0, s73, 0
s_nop 0
buffer_load_dwordx4 v40, s[92:95], s66 offen  lds
s_add_u32 m0, s73, 4096
s_nop 0
buffer_load_dwordx4 v41, s[92:95], s66 offen  lds
s_add_u32 m0, s73, 8192
s_nop 0
buffer_load_dwordx4 v42, s[92:95], s66 offen  lds
s_add_u32 m0, s73, 12288
s_nop 0
buffer_load_dwordx4 v43, s[92:95], s66 offen  lds
s_add_u32 m0, s73, 16384
s_nop 0
buffer_load_dwordx4 v44, s[92:95], s66 offen  lds
s_add_u32 m0, s73, 20480
s_nop 0
buffer_load_dwordx4 v45, s[92:95], s66 offen  lds
s_add_u32 m0, s73, 24576
s_nop 0
buffer_load_dwordx4 v46, s[92:95], s66 offen  lds
s_add_u32 m0, s73, 28672
s_nop 0
buffer_load_dwordx4 v47, s[92:95], s66 offen  lds
s_add_u32 m0, s73, 32768
s_nop 0
buffer_load_dwordx4 v48, s[96:99], s67 offen lds
s_add_u32 m0, s73, 36864
s_nop 0
buffer_load_dwordx4 v49, s[96:99], s67 offen lds
s_add_u32 m0, s73, 40960
s_nop 0
buffer_load_dwordx4 v50, s[96:99], s67 offen lds
s_add_u32 m0, s73, 45056
s_nop 0
buffer_load_dwordx4 v51, s[96:99], s67 offen lds
s_add_u32 s66, s66, 128
s_add_u32 s67, s67, s68
s_add_u32 s73, s73, 49152
s_cmp_ge_u32 s73, 147456
s_cselect_b32 s71, 147456, 0
s_sub_u32 s73, s73, s71
s_add_u32 m0, s73, 0
s_nop 0
buffer_load_dwordx4 v40, s[92:95], s66 offen  lds
s_add_u32 m0, s73, 4096
s_nop 0
buffer_load_dwordx4 v41, s[92:95], s66 offen  lds
s_add_u32 m0, s73, 8192
s_nop 0
buffer_load_dwordx4 v42, s[92:95], s66 offen  lds
s_add_u32 m0, s73, 12288
s_nop 0
buffer_load_dwordx4 v43, s[92:95], s66 offen  lds
s_add_u32 m0, s73, 16384
s_nop 0
buffer_load_dwordx4 v44, s[92:95], s66 offen  lds
s_add_u32 m0, s73, 20480
s_nop 0
buffer_load_dwordx4 v45, s[92:95], s66 offen  lds
s_add_u32 m0, s73, 24576
s_nop 0
buffer_load_dwordx4 v46, s[92:95], s66 offen  lds
s_add_u32 m0, s73, 28672
s_nop 0
buffer_load_dwordx4 v47, s[92:95], s66 offen  lds
s_add_u32 m0, s73, 32768
s_nop 0
buffer_load_dwordx4 v48, s[96:99], s67 offen lds
s_add_u32 m0, s73, 36864
s_nop 0
buffer_load_dwordx4 v49, s[96:99], s67 offen lds
s_add_u32 m0, s73, 40960
s_nop 0
buffer_load_dwordx4 v50, s[96:99], s67 offen lds
s_add_u32 m0, s73, 45056
s_nop 0
buffer_load_dwordx4 v51, s[96:99], s67 offen lds
s_add_u32 s66, s66, 128
s_add_u32 s67, s67, s68
s_add_u32 s73, s73, 49152
s_cmp_ge_u32 s73, 147456
s_cselect_b32 s71, 147456, 0
s_sub_u32 s73, s73, s71
v_accvgpr_write_b32 a0, 0
v_accvgpr_write_b32 a1, 0
v_accvgpr_write_b32 a2, 0
v_accvgpr_write_b32 a3, 0
v_accvgpr_write_b32 a4, 0
v_accvgpr_write_b32 a5, 0
v_accvgpr_write_b32 a6, 0
v_accvgpr_write_b32 a7, 0
v_accvgpr_write_b32 a8, 0
v_accvgpr_write_b32 a9, 0
v_accvgpr_write_b32 a10, 0
v_accvgpr_write_b32 a11, 0
v_accvgpr_write_b32 a12, 0
v_accvgpr_write_b32 a13, 0
v_accvgpr_write_b32 a14, 0
v_accvgpr_write_b32 a15, 0
v_accvgpr_write_b32 a16, 0
v_accvgpr_write_b32 a17, 0
v_accvgpr_write_b32 a18, 0
v_accvgpr_write_b32 a19, 0
v_accvgpr_write_b32 a20, 0
v_accvgpr_write_b32 a21, 0
v_accvgpr_write_b32 a22, 0
v_accvgpr_write_b32 a23, 0
v_accvgpr_write_b32 a24, 0
v_accvgpr_write_b32 a25, 0
v_accvgpr_write_b32 a26, 0
v_accvgpr_write_b32 a27, 0
v_accvgpr_write_b32 a28, 0
v_accvgpr_write_b32 a29, 0
v_accvgpr_write_b32 a30, 0
v_accvgpr_write_b32 a31, 0
v_accvgpr_write_b32 a32, 0
v_accvgpr_write_b32 a33, 0
v_accvgpr_write_b32 a34, 0
v_accvgpr_write_b32 a35, 0
v_accvgpr_write_b32 a36, 0
v_accvgpr_write_b32 a37, 0
v_accvgpr_write_b32 a38, 0
v_accvgpr_write_b32 a39, 0
v_accvgpr_write_b32 a40, 0
v_accvgpr_write_b32 a41, 0
v_accvgpr_write_b32 a42, 0
v_accvgpr_write_b32 a43, 0
v_accvgpr_write_b32 a44, 0
v_accvgpr_write_b32 a45, 0
v_accvgpr_write_b32 a46, 0
v_accvgpr_write_b32 a47, 0
v_accvgpr_write_b32 a48, 0
v_accvgpr_write_b32 a49, 0
v_accvgpr_write_b32 a50, 0
v_accvgpr_write_b32 a51, 0
v_accvgpr_write_b32 a52, 0
v_accvgpr_write_b32 a53, 0
v_accvgpr_write_b32 a54, 0
v_accvgpr_write_b32 a55, 0
v_accvgpr_write_b32 a56, 0
v_accvgpr_write_b32 a57, 0
v_accvgpr_write_b32 a58, 0
v_accvgpr_write_b32 a59, 0
v_accvgpr_write_b32 a60, 0
v_accvgpr_write_b32 a61, 0
v_accvgpr_write_b32 a62, 0
v_accvgpr_write_b32 a63, 0
v_accvgpr_write_b32 a64, 0
v_accvgpr_write_b32 a65, 0
v_accvgpr_write_b32 a66, 0
v_accvgpr_write_b32 a67, 0
v_accvgpr_write_b32 a68, 0
v_accvgpr_write_b32 a69, 0
v_accvgpr_write_b32 a70, 0
v_accvgpr_write_b32 a71, 0
v_accvgpr_write_b32 a72, 0
v_accvgpr_write_b32 a73, 0
v_accvgpr_write_b32 a74, 0
v_accvgpr_write_b32 a75, 0
v_accvgpr_write_b32 a76, 0
v_accvgpr_write_b32 a77, 0
v_accvgpr_write_b32 a78, 0
v_accvgpr_write_b32 a79, 0
v_accvgpr_write_b32 a80, 0
v_accvgpr_write_b32 a81, 0
v_accvgpr_write_b32 a82, 0
v_accvgpr_write_b32 a83, 0
v_accvgpr_write_b32 a84, 0
v_accvgpr_write_b32 a85, 0
v_accvgpr_write_b32 a86, 0
v_accvgpr_write_b32 a87, 0
v_accvgpr_write_b32 a88, 0
v_accvgpr_write_b32 a89, 0
v_accvgpr_write_b32 a90, 0
v_accvgpr_write_b32 a91, 0
v_accvgpr_write_b32 a92, 0
v_accvgpr_write_b32 a93, 0
v_accvgpr_write_b32 a94, 0
v_accvgpr_write_b32 a95, 0
v_accvgpr_write_b32 a96, 0
v_accvgpr_write_b32 a97, 0
v_accvgpr_write_b32 a98, 0
v_accvgpr_write_b32 a99, 0
v_accvgpr_write_b32 a100, 0
v_accvgpr_write_b32 a101, 0
v_accvgpr_write_b32 a102, 0
v_accvgpr_write_b32 a103, 0
v_accvgpr_write_b32 a104, 0
v_accvgpr_write_b32 a105, 0
v_accvgpr_write_b32 a106, 0
v_accvgpr_write_b32 a107, 0
v_accvgpr_write_b32 a108, 0
v_accvgpr_write_b32 a109, 0
v_accvgpr_write_b32 a110, 0
v_accvgpr_write_b32 a111, 0
v_accvgpr_write_b32 a112, 0
v_accvgpr_write_b32 a113, 0
v_accvgpr_write_b32 a114, 0
v_accvgpr_write_b32 a115, 0
v_accvgpr_write_b32 a116, 0
v_accvgpr_write_b32 a117, 0
v_accvgpr_write_b32 a118, 0
v_accvgpr_write_b32 a119, 0
v_accvgpr_write_b32 a120, 0
v_accvgpr_write_b32 a121, 0
v_accvgpr_write_b32 a122, 0
v_accvgpr_write_b32 a123, 0
v_accvgpr_write_b32 a124, 0
v_accvgpr_write_b32 a125, 0
v_accvgpr_write_b32 a126, 0
v_accvgpr_write_b32 a127, 0
Lg_29:
s_waitcnt vmcnt(12)
s_barrier
ds_read_b128 v[64:67], v52 offset:0
ds_read_b128 v[68:71], v52 offset:4096
ds_read_b128 v[72:75], v52 offset:8192
ds_read_b128 v[76:79], v52 offset:12288
ds_read_b64_tr_b16 v[80:81], v56 offset:0
ds_read_b64_tr_b16 v[82:83], v56 offset:1024
ds_read_b64_tr_b16 v[84:85], v57 offset:0
ds_read_b64_tr_b16 v[86:87], v57 offset:1024
s_cmp_eq_u32 s91, -1
s_cbranch_scc1 Lfl_30
v_mov_b32 v9, 0
v_mov_b32 v10, s101
s_mov_b64 exec, 1
buffer_atomic_add v10, v9, s[56:59], s91 offen sc1
s_mov_b64 exec, -1
s_mov_b32 s91, -1
Lfl_30:
s_add_u32 s70, s70, 49152
s_cmp_ge_u32 s70, 147456
s_cselect_b32 s71, 147456, 0
s_sub_u32 s70, s70, s71
s_sub_u32 s74, 49152, s71
ds_read_b128 v[88:91], v53 offset:0
s_waitcnt lgkmcnt(1)
v_mfma_f32_32x32x16_bf16 a[0:15], v[80:83], v[64:67], a[0:15]
ds_read_b128 v[92:95], v53 offset:4096
ds_read_b128 v[96:99], v53 offset:8192
v_mfma_f32_32x32x16_bf16 a[16:31], v[84:87], v[64:67], a[16:31]
ds_read_b128 v[100:103], v53 offset:12288
ds_read_b64_tr_b16 v[104:105], v56 offset:4096
v_mfma_f32_32x32x16_bf16 a[32:47], v[80:83], v[68:71], a[32:47]
ds_read_b64_tr_b16 v[106:107], v56 offset:5120
v_mfma_f32_32x32x16_bf16 a[48:63], v[84:87], v[68:71], a[48:63]
ds_read_b64_tr_b16 v[108:109], v57 offset:4096
v_mfma_f32_32x32x16_bf16 a[64:79], v[80:83], v[72:75], a[64:79]
ds_read_b64_tr_b16 v[110:111], v57 offset:5120
v_mfma_f32_32x32x16_bf16 a[80:95], v[84:87], v[72:75], a[80:95]
s_add_u32 m0, s73, 0
s_nop 0
buffer_load_dwordx4 v40, s[92:95], s66 offen  lds
v_mfma_f32_32x32x16_bf16 a[96:111], v[80:83], v[76:79], a[96:111]
s_add_u32 m0, s73, 4096
s_nop 0
buffer_load_dwordx4 v41, s[92:95], s66 offen  lds
v_mfma_f32_32x32x16_bf16 a[112:127], v[84:87], v[76:79], a[112:127]
s_add_u32 m0, s73, 8192
s_nop 0
buffer_load_dwordx4 v42, s[92:95], s66 offen  lds
ds_read_b128 v[64:67], v54 offset:0
s_waitcnt lgkmcnt(1)
v_mfma_f32_32x32x16_bf16 a[0:15], v[104:107], v[88:91], a[0:15]
ds_read_b128 v[68:71], v54 offset:4096
ds_read_b128 v[72:75], v54 offset:8192
v_mfma_f32_32x32x16_bf16 a[16:31], v[108:111], v[88:91], a[16:31]
ds_read_b128 v[76:79], v54 offset:12288
ds_read_b64_tr_b16 v[80:81], v56 offset:8192
v_mfma_f32_32x32x16_bf16 a[32:47], v[104:107], v[92:95], a[32:47]
ds_read_b64_tr_b16 v[82:83], v56 offset:9216
v_mfma_f32_32x32x16_bf16 a[48:63], v[108:111], v[92:95], a[48:63]
ds_read_b64_tr_b16 v[84:85], v57 offset:8192
v_mfma_f32_32x32x16_bf16 a[64:79], v[104:107], v[96:99], a[64:79]
ds_read_b64_tr_b16 v[86:87], v57 offset:9216
v_mfma_f32_32x32x16_bf16 a[80:95], v[108:111], v[96:99], a[80:95]
s_add_u32 m0, s73, 12288
s_nop 0
buffer_load_dwordx4 v43, s[92:95], s66 offen  lds
v_mfma_f32_32x32x16_bf16 a[96:111], v[104:107], v[100:103], a[96:111]
s_add_u32 m0, s73, 16384
s_nop 0
buffer_load_dwordx4 v44, s[92:95], s66 offen  lds
v_mfma_f32_32x32x16_bf16 a[112:127], v[108:111], v[100:103], a[112:127]
s_add_u32 m0, s73, 20480
s_nop 0
buffer_load_dwordx4 v45, s[92:95], s66 offen  lds
ds_read_b128 v[88:91], v55 offset:0
s_waitcnt lgkmcnt(1)
v_mfma_f32_32x32x16_bf16 a[0:15], v[80:83], v[64:67], a[0:15]
ds_read_b128 v[92:95], v55 offset:4096
ds_read_b128 v[96:99], v55 offset:8192
v_mfma_f32_32x32x16_bf16 a[16:31], v[84:87], v[64:67], a[16:31]
ds_read_b128 v[100:103], v55 offset:12288
ds_read_b64_tr_b16 v[104:105], v56 offset:12288
v_mfma_f32_32x32x16_bf16 a[32:47], v[80:83], v[68:71], a[32:47]
ds_read_b64_tr_b16 v[106:107], v56 offset:13312
v_mfma_f32_32x32x16_bf16 a[48:63], v[84:87], v[68:71], a[48:63]
ds_read_b64_tr_b16 v[108:109], v57 offset:12288
v_mfma_f32_32x32x16_bf16 a[64:79], v[80:83], v[72:75], a[64:79]
ds_read_b64_tr_b16 v[110:111], v57 offset:13312
v_mfma_f32_32x32x16_bf16 a[80:95], v[84:87], v[72:75], a[80:95]
s_add_u32 m0, s73, 24576
s_nop 0
buffer_load_dwordx4 v46, s[92:95], s66 offen  lds
v_mfma_f32_32x32x16_bf16 a[96:111], v[80:83], v[76:79], a[96:111]
s_add_u32 m0, s73, 28672
s_nop 0
buffer_load_dwordx4 v47, s[92:95], s66 offen  lds
v_mfma_f32_32x32x16_bf16 a[112:127], v[84:87], v[76:79], a[112:127]
s_add_u32 m0, s73, 32768
s_nop 0
buffer_load_dwordx4 v48, s[96:99], s67 offen lds
s_waitcnt lgkmcnt(0)
v_mfma_f32_32x32x16_bf16 a[0:15], v[104:107], v[88:91], a[0:15]
s_add_u32 m0, s73, 36864
s_nop 0
buffer_load_dwordx4 v49, s[96:99], s67 offen lds
s_add_u32 m0, s73, 40960
s_nop 0
buffer_load_dwordx4 v50, s[96:99], s67 offen lds
v_mfma_f32_32x32x16_bf16 a[16:31], v[108:111], v[88:91], a[16:31]
s_add_u32 m0, s73, 45056
s_nop 0
buffer_load_dwordx4 v51, s[96:99], s67 offen lds
v_mfma_f32_32x32x16_bf16 a[32:47], v[104:107], v[92:95], a[32:47]
v_add_u32 v52, s74, v52
v_mfma_f32_32x32x16_bf16 a[48:63], v[108:111], v[92:95], a[48:63]
v_add_u32 v53, s74, v53
v_mfma_f32_32x32x16_bf16 a[64:79], v[104:107], v[96:99], a[64:79]
v_add_u32 v54, s74, v54
v_mfma_f32_32x32x16_bf16 a[80:95], v[108:111], v[96:99], a[80:95]
v_add_u32 v55, s74, v55
v_mfma_f32_32x32x16_bf16 a[96:111], v[104:107], v[100:103], a[96:111]
v_add_u32 v56, s74, v56
v_mfma_f32_32x32x16_bf16 a[112:127], v[108:111], v[100:103], a[112:127]
v_add_u32 v57, s74, v57
s_add_u32 s66, s66, 128
s_add_u32 s67, s67, s68
s_add_u32 s73, s73, 49152
s_cmp_ge_u32 s73, 147456
s_cselect_b32 s71, 147456, 0
s_sub_u32 s73, s73, s71
s_sub_u32 s69, s69, 1
s_cmp_lg_u32 s69, 0
s_cbranch_scc1 Lg_29
s_waitcnt vmcnt(0)
s_nop 7
s_branch L_epi
L_gemmN:
s_cmp_lt_u32 s76, 128
s_cbranch_scc1 L_half0
v_lshrrev_b32 v40, 3, v0
s_lshl_b32 s71, s65, 3
v_add_u32 v40, s71, v40
v_bfe_u32 v41, v40, 1, 3
v_and_b32 v42, 7, v0
v_xor_b32 v41, v41, v42
v_lshlrev_b32 v41, 4, v41
s_mov_b32 s71, 2048
v_mul_lo_u32 v40, v40, s71
v_add_u32 v40, v40, v41
s_lshl_b32 s71, s71, 5
v_add_u32 v41, s71, v40
v_add_u32 v42, s71, v41
v_add_u32 v43, s71, v42
v_add_u32 v44, s71, v43
v_add_u32 v45, s71, v44
v_add_u32 v46, s71, v45
v_add_u32 v47, s71, v46
v_lshrrev_b32 v48, 4, v0
v_and_b32 v50, 15, v0
v_lshlrev_b32 v49, 2, v48
v_xor_b32 v49, v49, v50
v_lshlrev_b32 v49, 4, v49
s_mul_i32 s71, s65, 4
v_add_u32 v48, s71, v48
s_mov_b32 s71, s3
v_mul_lo_u32 v48, v48, s71
v_add_u32 v48, v48, v49
s_lshl_b32 s68, s71, 6
s_mul_i32 s71, s71, 16
v_add_u32 v49, s71, v48
v_add_u32 v50, s71, v49
v_add_u32 v51, s71, v50
v_and_b32 v58, 31, v0
v_bfe_u32 v59, v0, 1, 3
v_lshrrev_b32 v60, 5, v0
v_xor_b32 v59, v59, v60
s_lshr_b32 s71, s65, 1
s_mul_i32 s71, s71, 16384
v_lshl_add_u32 v58, v58, 7, s71
v_xor_b32 v61, 0, v59
v_lshl_add_u32 v52, v61, 4, v58
v_xor_b32 v61, 2, v59
v_lshl_add_u32 v53, v61, 4, v58
v_xor_b32 v61, 4, v59
v_lshl_add_u32 v54, v61, 4, v58
v_xor_b32 v61, 6, v59
v_lshl_add_u32 v55, v61, 4, v58
v_bfe_u32 v58, v0, 2, 2
v_lshl_add_u32 v60, v60, 3, v58
v_mul_u32_u24 v60, 256, v60
v_bfe_u32 v61, v0, 4, 1
v_lshl_add_u32 v60, v61, 5, v60
v_and_b32 v61, 3, v0
v_lshl_add_u32 v60, v61, 3, v60
v_add_u32 v60, 32768, v60
s_and_b32 s71, s65, 1
s_mul_i32 s71, s71, 2
s_add_u32 s72, s71, 0
v_xor_b32 v61, s72, v58
v_lshl_add_u32 v56, v61, 6, v60
s_add_u32 s72, s71, 1
v_xor_b32 v61, s72, v58
v_lshl_add_u32 v57, v61, 6, v60
s_lshl_b32 s66, s85, 19
s_lshl_b32 s67, s86, 8
s_mov_b32 s69, 16
s_lshl_b32 s73, s65, 10
s_mov_b32 s70, 0
s_mov_b32 s75, 0
s_barrier
s_add_u32 m0, s73, 0
s_nop 0
buffer_load_dwordx4 v40, s[92:95], s66 offen  lds
s_add_u32 m0, s73, 4096
s_nop 0
buffer_load_dwordx4 v41, s[92:95], s66 offen  lds
s_add_u32 m0, s73, 8192
s_nop 0
buffer_load_dwordx4 v42, s[92:95], s66 offen  lds
s_add_u32 m0, s73, 12288
s_nop 0
buffer_load_dwordx4 v43, s[92:95], s66 offen  lds
s_add_u32 m0, s73, 16384
s_nop 0
buffer_load_dwordx4 v44, s[92:95], s66 offen  lds
s_add_u32 m0, s73, 20480
s_nop 0
buffer_load_dwordx4 v45, s[92:95], s66 offen  lds
s_add_u32 m0, s73, 24576
s_nop 0
buffer_load_dwordx4 v46, s[92:95], s66 offen  lds
s_add_u32 m0, s73, 28672
s_nop 0
buffer_load_dwordx4 v47, s[92:95], s66 offen  lds
s_add_u32 m0, s73, 32768
s_nop 0
buffer_load_dwordx4 v48, s[96:99], s67 offen lds
s_add_u32 m0, s73, 36864
s_nop 0
buffer_load_dwordx4 v49, s[96:99], s67 offen lds
s_add_u32 m0, s73, 40960
s_nop 0
buffer_load_dwordx4 v50, s[96:99], s67 offen lds
s_add_u32 m0, s73, 45056
s_nop 0
buffer_load_dwordx4 v51, s[96:99], s67 offen lds
s_add_u32 s66, s66, 128
s_add_u32 s67, s67, s68
s_add_u32 s73, s73, 49152
s_cmp_ge_u32 s73, 147456
s_cselect_b32 s71, 147456, 0
s_sub_u32 s73, s73, s71
s_add_u32 m0, s73, 0
s_nop 0
buffer_load_dwordx4 v40, s[92:95], s66 offen  lds
s_add_u32 m0, s73, 4096
s_nop 0
buffer_load_dwordx4 v41, s[92:95], s66 offen  lds
s_add_u32 m0, s73, 8192
s_nop 0
buffer_load_dwordx4 v42, s[92:95], s66 offen  lds
s_add_u32 m0, s73, 12288
s_nop 0
buffer_load_dwordx4 v43, s[92:95], s66 offen  lds
s_add_u32 m0, s73, 16384
s_nop 0
buffer_load_dwordx4 v44, s[92:95], s66 offen  lds
s_add_u32 m0, s73, 20480
s_nop 0
buffer_load_dwordx4 v45, s[92:95], s66 offen  lds
s_add_u32 m0, s73, 24576
s_nop 0
buffer_load_dwordx4 v46, s[92:95], s66 offen  lds
s_add_u32 m0, s73, 28672
s_nop 0
buffer_load_dwordx4 v47, s[92:95], s66 offen  lds
s_add_u32 m0, s73, 32768
s_nop 0
buffer_load_dwordx4 v48, s[96:99], s67 offen lds
s_add_u32 m0, s73, 36864
s_nop 0
buffer_load_dwordx4 v49, s[96:99], s67 offen lds
s_add_u32 m0, s73, 40960
s_nop 0
buffer_load_dwordx4 v50, s[96:99], s67 offen lds
s_add_u32 m0, s73, 45056
s_nop 0
buffer_load_dwordx4 v51, s[96:99], s67 offen lds
s_add_u32 s66, s66, 128
s_add_u32 s67, s67, s68
s_add_u32 s73, s73, 49152
s_cmp_ge_u32 s73, 147456
s_cselect_b32 s71, 147456, 0
s_sub_u32 s73, s73, s71
v_accvgpr_write_b32 a0, 0
v_accvgpr_write_b32 a1, 0
v_accvgpr_write_b32 a2, 0
v_accvgpr_write_b32 a3, 0
v_accvgpr_write_b32 a4, 0
v_accvgpr_write_b32 a5, 0
v_accvgpr_write_b32 a6, 0
v_accvgpr_write_b32 a7, 0
v_accvgpr_write_b32 a8, 0
v_accvgpr_write_b32 a9, 0
v_accvgpr_write_b32 a10, 0
v_accvgpr_write_b32 a11, 0
v_accvgpr_write_b32 a12, 0
v_accvgpr_write_b32 a13, 0
v_accvgpr_write_b32 a14, 0
v_accvgpr_write_b32 a15, 0
v_accvgpr_write_b32 a16, 0
v_accvgpr_write_b32 a17, 0
v_accvgpr_write_b32 a18, 0
v_accvgpr_write_b32 a19, 0
v_accvgpr_write_b32 a20, 0
v_accvgpr_write_b32 a21, 0
v_accvgpr_write_b32 a22, 0
v_accvgpr_write_b32 a23, 0
v_accvgpr_write_b32 a24, 0
v_accvgpr_write_b32 a25, 0
v_accvgpr_write_b32 a26, 0
v_accvgpr_write_b32 a27, 0
v_accvgpr_write_b32 a28, 0
v_accvgpr_write_b32 a29, 0
v_accvgpr_write_b32 a30, 0
v_accvgpr_write_b32 a31, 0
v_accvgpr_write_b32 a32, 0
v_accvgpr_write_b32 a33, 0
v_accvgpr_write_b32 a34, 0
v_accvgpr_write_b32 a35, 0
v_accvgpr_write_b32 a36, 0
v_accvgpr_write_b32 a37, 0
v_accvgpr_write_b32 a38, 0
v_accvgpr_write_b32 a39, 0
v_accvgpr_write_b32 a40, 0
v_accvgpr_write_b32 a41, 0
v_accvgpr_write_b32 a42, 0
v_accvgpr_write_b32 a43, 0
v_accvgpr_write_b32 a44, 0
v_accvgpr_write_b32 a45, 0
v_accvgpr_write_b32 a46, 0
v_accvgpr_write_b32 a47, 0
v_accvgpr_write_b32 a48, 0
v_accvgpr_write_b32 a49, 0
v_accvgpr_write_b32 a50, 0
v_accvgpr_write_b32 a51, 0
v_accvgpr_write_b32 a52, 0
v_accvgpr_write_b32 a53, 0
v_accvgpr_write_b32 a54, 0
v_accvgpr_write_b32 a55, 0
v_accvgpr_write_b32 a56, 0
v_accvgpr_write_b32 a57, 0
v_accvgpr_write_b32 a58, 0
v_accvgpr_write_b32 a59, 0
v_accvgpr_write_b32 a60, 0
v_accvgpr_write_b32 a61, 0
v_accvgpr_write_b32 a62, 0
v_accvgpr_write_b32 a63, 0
v_accvgpr_write_b32 a64, 0
v_accvgpr_write_b32 a65, 0
v_accvgpr_write_b32 a66, 0
v_accvgpr_write_b32 a67, 0
v_accvgpr_write_b32 a68, 0
v_accvgpr_write_b32 a69, 0
v_accvgpr_write_b32 a70, 0
v_accvgpr_write_b32 a71, 0
v_accvgpr_write_b32 a72, 0
v_accvgpr_write_b32 a73, 0
v_accvgpr_write_b32 a74, 0
v_accvgpr_write_b32 a75, 0
v_accvgpr_write_b32 a76, 0
v_accvgpr_write_b32 a77, 0
v_accvgpr_write_b32 a78, 0
v_accvgpr_write_b32 a79, 0
v_accvgpr_write_b32 a80, 0
v_accvgpr_write_b32 a81, 0
v_accvgpr_write_b32 a82, 0
v_accvgpr_write_b32 a83, 0
v_accvgpr_write_b32 a84, 0
v_accvgpr_write_b32 a85, 0
v_accvgpr_write_b32 a86, 0
v_accvgpr_write_b32 a87, 0
v_accvgpr_write_b32 a88, 0
v_accvgpr_write_b32 a89, 0
v_accvgpr_write_b32 a90, 0
v_accvgpr_write_b32 a91, 0
v_accvgpr_write_b32 a92, 0
v_accvgpr_write_b32 a93, 0
v_accvgpr_write_b32 a94, 0
v_accvgpr_write_b32 a95, 0
v_accvgpr_write_b32 a96, 0
v_accvgpr_write_b32 a97, 0
v_accvgpr_write_b32 a98, 0
v_accvgpr_write_b32 a99, 0
v_accvgpr_write_b32 a100, 0
v_accvgpr_write_b32 a101, 0
v_accvgpr_write_b32 a102, 0
v_accvgpr_write_b32 a103, 0
v_accvgpr_write_b32 a104, 0
v_accvgpr_write_b32 a105, 0
v_accvgpr_write_b32 a106, 0
v_accvgpr_write_b32 a107, 0
v_accvgpr_write_b32 a108, 0
v_accvgpr_write_b32 a109, 0
v_accvgpr_write_b32 a110, 0
v_accvgpr_write_b32 a111, 0
v_accvgpr_write_b32 a112, 0
v_accvgpr_write_b32 a113, 0
v_accvgpr_write_b32 a114, 0
v_accvgpr_write_b32 a115, 0
v_accvgpr_write_b32 a116, 0
v_accvgpr_write_b32 a117, 0
v_accvgpr_write_b32 a118, 0
v_accvgpr_write_b32 a119, 0
v_accvgpr_write_b32 a120, 0
v_accvgpr_write_b32 a121, 0
v_accvgpr_write_b32 a122, 0
v_accvgpr_write_b32 a123, 0
v_accvgpr_write_b32 a124, 0
v_accvgpr_write_b32 a125, 0
v_accvgpr_write_b32 a126, 0
v_accvgpr_write_b32 a127, 0
Lg_31:
s_waitcnt vmcnt(12)
s_barrier
ds_read_b128 v[64:67], v52 offset:0
ds_read_b128 v[68:71], v52 offset:4096
ds_read_b128 v[72:75], v52 offset:8192
ds_read_b128 v[76:79], v52 offset:12288
ds_read_b64_tr_b16 v[80:81], v56 offset:0
ds_read_b64_tr_b16 v[82:83], v56 offset:1024
ds_read_b64_tr_b16 v[84:85], v57 offset:0
ds_read_b64_tr_b16 v[86:87], v57 offset:1024
s_cmp_eq_u32 s91, -1
s_cbranch_scc1 Lfl_32
v_mov_b32 v9, 0
v_mov_b32 v10, s101
s_mov_b64 exec, 1
buffer_atomic_add v10, v9, s[56:59], s91 offen sc1
s_mov_b64 exec, -1
s_mov_b32 s91, -1
Lfl_32:
s_add_u32 s70, s70, 49152
s_cmp_ge_u32 s70, 147456
s_cselect_b32 s71, 147456, 0
s_sub_u32 s70, s70, s71
s_sub_u32 s74, 49152, s71
ds_read_b128 v[88:91], v53 offset:0
s_waitcnt lgkmcnt(1)
v_mfma_f32_32x32x16_bf16 a[0:15], v[64:67], v[80:83], a[0:15]
ds_read_b128 v[92:95], v53 offset:4096
ds_read_b128 v[96:99], v53 offset:8192
v_mfma_f32_32x32x16_bf16 a[16:31], v[64:67], v[84:87], a[16:31]
ds_read_b128 v[100:103], v53 offset:12288
ds_read_b64_tr_b16 v[104:105], v56 offset:4096
v_mfma_f32_32x32x16_bf16 a[32:47], v[68:71], v[80:83], a[32:47]
ds_read_b64_tr_b16 v[106:107], v56 offset:5120
v_mfma_f32_32x32x16_bf16 a[48:63], v[68:71], v[84:87], a[48:63]
ds_read_b64_tr_b16 v[108:109], v57 offset:4096
v_mfma_f32_32x32x16_bf16 a[64:79], v[72:75], v[80:83], a[64:79]
ds_read_b64_tr_b16 v[110:111], v57 offset:5120
v_mfma_f32_32x32x16_bf16 a[80:95], v[72:75], v[84:87], a[80:95]
s_add_u32 m0, s73, 0
s_nop 0
buffer_load_dwordx4 v40, s[92:95], s66 offen  lds
v_mfma_f32_32x32x16_bf16 a[96:111], v[76:79], v[80:83], a[96:111]
s_add_u32 m0, s73, 4096
s_nop 0
buffer_load_dwordx4 v41, s[92:95], s66 offen  lds
v_mfma_f32_32x32x16_bf16 a[112:127], v[76:79], v[84:87], a[112:127]
s_add_u32 m0, s73, 8192
s_nop 0
buffer_load_dwordx4 v42, s[92:95], s66 offen  lds
ds_read_b128 v[64:67], v54 offset:0
s_waitcnt lgkmcnt(1)
v_mfma_f32_32x32x16_bf16 a[0:15], v[88:91], v[104:107], a[0:15]
ds_read_b128 v[68:71], v54 offset:4096
ds_read_b128 v[72:75], v54 offset:8192
v_mfma_f32_32x32x16_bf16 a[16:31], v[88:91], v[108:111], a[16:31]
ds_read_b128 v[76:79], v54 offset:12288
ds_read_b64_tr_b16 v[80:81], v56 offset:8192
v_mfma_f32_32x32x16_bf16 a[32:47], v[92:95], v[104:107], a[32:47]
ds_read_b64_tr_b16 v[82:83], v56 offset:9216
v_mfma_f32_32x32x16_bf16 a[48:63], v[92:95], v[108:111], a[48:63]
ds_read_b64_tr_b16 v[84:85], v57 offset:8192
v_mfma_f32_32x32x16_bf16 a[64:79], v[96:99], v[104:107], a[64:79]
ds_read_b64_tr_b16 v[86:87], v57 offset:9216
v_mfma_f32_32x32x16_bf16 a[80:95], v[96:99], v[108:111], a[80:95]
s_add_u32 m0, s73, 12288
s_nop 0
buffer_load_dwordx4 v43, s[92:95], s66 offen  lds
v_mfma_f32_32x32x16_bf16 a[96:111], v[100:103], v[104:107], a[96:111]
s_add_u32 m0, s73, 16384
s_nop 0
buffer_load_dwordx4 v44, s[92:95], s66 offen  lds
v_mfma_f32_32x32x16_bf16 a[112:127], v[100:103], v[108:111], a[112:127]
s_add_u32 m0, s73, 20480
s_nop 0
buffer_load_dwordx4 v45, s[92:95], s66 offen  lds
ds_read_b128 v[88:91], v55 offset:0
s_waitcnt lgkmcnt(1)
v_mfma_f32_32x32x16_bf16 a[0:15], v[64:67], v[80:83], a[0:15]
ds_read_b128 v[92:95], v55 offset:4096
ds_read_b128 v[96:99], v55 offset:8192
v_mfma_f32_32x32x16_bf16 a[16:31], v[64:67], v[84:87], a[16:31]
ds_read_b128 v[100:103], v55 offset:12288
ds_read_b64_tr_b16 v[104:105], v56 offset:12288
v_mfma_f32_32x32x16_bf16 a[32:47], v[68:71], v[80:83], a[32:47]
ds_read_b64_tr_b16 v[106:107], v56 offset:13312
v_mfma_f32_32x32x16_bf16 a[48:63], v[68:71], v[84:87], a[48:63]
ds_read_b64_tr_b16 v[108:109], v57 offset:12288
v_mfma_f32_32x32x16_bf16 a[64:79], v[72:75], v[80:83], a[64:79]
ds_read_b64_tr_b16 v[110:111], v57 offset:13312
v_mfma_f32_32x32x16_bf16 a[80:95], v[72:75], v[84:87], a[80:95]
s_add_u32 m0, s73, 24576
s_nop 0
buffer_load_dwordx4 v46, s[92:95], s66 offen  lds
v_mfma_f32_32x32x16_bf16 a[96:111], v[76:79], v[80:83], a[96:111]
s_add_u32 m0, s73, 28672
s_nop 0
buffer_load_dwordx4 v47, s[92:95], s66 offen  lds
v_mfma_f32_32x32x16_bf16 a[112:127], v[76:79], v[84:87], a[112:127]
s_add_u32 m0, s73, 32768
s_nop 0
buffer_load_dwordx4 v48, s[96:99], s67 offen lds
s_waitcnt lgkmcnt(0)
v_mfma_f32_32x32x16_bf16 a[0:15], v[88:91], v[104:107], a[0:15]
s_add_u32 m0, s73, 36864
s_nop 0
buffer_load_dwordx4 v49, s[96:99], s67 offen lds
s_add_u32 m0, s73, 40960
s_nop 0
buffer_load_dwordx4 v50, s[96:99], s67 offen lds
v_mfma_f32_32x32x16_bf16 a[16:31], v[88:91], v[108:111], a[16:31]
s_add_u32 m0, s73, 45056
s_nop 0
buffer_load_dwordx4 v51, s[96:99], s67 offen lds
v_mfma_f32_32x32x16_bf16 a[32:47], v[92:95], v[104:107], a[32:47]
v_add_u32 v52, s74, v52
v_mfma_f32_32x32x16_bf16 a[48:63], v[92:95], v[108:111], a[48:63]
v_add_u32 v53, s74, v53
v_mfma_f32_32x32x16_bf16 a[64:79], v[96:99], v[104:107], a[64:79]
v_add_u32 v54, s74, v54
v_mfma_f32_32x32x16_bf16 a[80:95], v[96:99], v[108:111], a[80:95]
v_add_u32 v55, s74, v55
v_mfma_f32_32x32x16_bf16 a[96:111], v[100:103], v[104:107], a[96:111]
v_add_u32 v56, s74, v56
v_mfma_f32_32x32x16_bf16 a[112:127], v[100:103], v[108:111], a[112:127]
v_add_u32 v57, s74, v57
s_add_u32 s66, s66, 128
s_add_u32 s67, s67, s68
s_add_u32 s73, s73, 49152
s_cmp_ge_u32 s73, 147456
s_cselect_b32 s71, 147456, 0
s_sub_u32 s73, s73, s71
s_sub_u32 s69, s69, 1
s_cmp_lg_u32 s69, 0
s_cbranch_scc1 Lg_31
s_waitcnt vmcnt(0)
s_nop 7
s_branch L_epi
L_half1:
v_lshrrev_b32 v40, 3, v0
s_lshl_b32 s71, s65, 3
v_add_u32 v40, s71, v40
v_bfe_u32 v41, v40, 1, 3
v_and_b32 v42, 7, v0
v_xor_b32 v41, v41, v42
v_lshlrev_b32 v41, 4, v41
s_mov_b32 s71, 2048
v_mul_lo_u32 v40, v40, s71
v_add_u32 v40, v40, v41
s_lshl_b32 s71, s71, 5
v_add_u32 v41, s71, v40
v_add_u32 v42, s71, v41
v_add_u32 v43, s71, v42
v_lshrrev_b32 v48, 4, v0
v_and_b32 v50, 15, v0
v_lshlrev_b32 v49, 2, v48
v_xor_b32 v49, v49, v50
v_lshlrev_b32 v49, 4, v49
s_mul_i32 s71, s65, 4
v_add_u32 v48, s71, v48
s_mov_b32 s71, s3
v_mul_lo_u32 v48, v48, s71
v_add_u32 v48, v48, v49
s_lshl_b32 s68, s71, 6
s_mul_i32 s71, s71, 16
v_add_u32 v49, s71, v48
v_add_u32 v50, s71, v49
v_add_u32 v51, s71, v50
v_and_b32 v58, 31, v0
v_bfe_u32 v59, v0, 1, 3
v_lshrrev_b32 v60, 5, v0
v_xor_b32 v59, v59, v60
s_lshr_b32 s71, s65, 1
s_mul_i32 s71, s71, 8192
v_lshl_add_u32 v58, v58, 7, s71
v_xor_b32 v61, 0, v59
v_lshl_add_u32 v52, v61, 4, v58
v_xor_b32 v61, 2, v59
v_lshl_add_u32 v53, v61, 4, v58
v_xor_b32 v61, 4, v59
v_lshl_add_u32 v54, v61, 4, v58
v_xor_b32 v61, 6, v59
v_lshl_add_u32 v55, v61, 4, v58
v_bfe_u32 v58, v0, 2, 2
v_lshl_add_u32 v60, v60, 3, v58
v_mul_u32_u24 v60, 256, v60
v_bfe_u32 v61, v0, 4, 1
v_lshl_add_u32 v60, v61, 5, v60
v_and_b32 v61, 3, v0
v_lshl_add_u32 v60, v61, 3, v60
v_add_u32 v60, 16384, v60
s_and_b32 s71, s65, 1
s_mul_i32 s71, s71, 2
s_add_u32 s72, s71, 0
v_xor_b32 v61, s72, v58
v_lshl_add_u32 v56, v61, 6, v60
s_add_u32 s72, s71, 1
v_xor_b32 v61, s72, v58
v_lshl_add_u32 v57, v61, 6, v60
s_and_b32 s6, s76, 1
s_lshl_b32 s66, s6, 18
s_lshl_b32 s67, s86, 8
s_mov_b32 s69, 16
s_lshl_b32 s73, s65, 10
s_mov_b32 s70, 0
s_mov_b32 s75, 0
s_barrier
s_add_u32 m0, s73, 0
s_nop 0
buffer_load_dwordx4 v40, s[92:95], s66 offen  lds
s_add_u32 m0, s73, 4096
s_nop 0
buffer_load_dwordx4 v41, s[92:95], s66 offen  lds
s_add_u32 m0, s73, 8192
s_nop 0
buffer_load_dwordx4 v42, s[92:95], s66 offen  lds
s_add_u32 m0, s73, 12288
s_nop 0
buffer_load_dwordx4 v43, s[92:95], s66 offen  lds
s_add_u32 m0, s73, 16384
s_nop 0
buffer_load_dwordx4 v48, s[96:99], s67 offen lds
s_add_u32 m0, s73, 20480
s_nop 0
buffer_load_dwordx4 v49, s[96:99], s67 offen lds
s_add_u32 m0, s73, 24576
s_nop 0
buffer_load_dwordx4 v50, s[96:99], s67 offen lds
s_add_u32 m0, s73, 28672
s_nop 0
buffer_load_dwordx4 v51, s[96:99], s67 offen lds
s_add_u32 s66, s66, 128
s_add_u32 s67, s67, s68
s_add_u32 s73, s73, 32768
s_cmp_ge_u32 s73, 131072
s_cselect_b32 s71, 131072, 0
s_sub_u32 s73, s73, s71
s_add_u32 m0, s73, 0
s_nop 0
buffer_load_dwordx4 v40, s[92:95], s66 offen  lds
s_add_u32 m0, s73, 4096
s_nop 0
buffer_load_dwordx4 v41, s[92:95], s66 offen  lds
s_add_u32 m0, s73, 8192
s_nop 0
buffer_load_dwordx4 v42, s[92:95], s66 offen  lds
s_add_u32 m0, s73, 12288
s_nop 0
buffer_load_dwordx4 v43, s[92:95], s66 offen  lds
s_add_u32 m0, s73, 16384
s_nop 0
buffer_load_dwordx4 v48, s[96:99], s67 offen lds
s_add_u32 m0, s73, 20480
s_nop 0
buffer_load_dwordx4 v49, s[96:99], s67 offen lds
s_add_u32 m0, s73, 24576
s_nop 0
buffer_load_dwordx4 v50, s[96:99], s67 offen lds
s_add_u32 m0, s73, 28672
s_nop 0
buffer_load_dwordx4 v51, s[96:99], s67 offen lds
s_add_u32 s66, s66, 128
s_add_u32 s67, s67, s68
s_add_u32 s73, s73, 32768
s_cmp_ge_u32 s73, 131072
s_cselect_b32 s71, 131072, 0
s_sub_u32 s73, s73, s71
s_add_u32 m0, s73, 0
s_nop 0
buffer_load_dwordx4 v40, s[92:95], s66 offen  lds
s_add_u32 m0, s73, 4096
s_nop 0
buffer_load_dwordx4 v41, s[92:95], s66 offen  lds
s_add_u32 m0, s73, 8192
s_nop 0
buffer_load_dwordx4 v42, s[92:95], s66 offen  lds
s_add_u32 m0, s73, 12288
s_nop 0
buffer_load_dwordx4 v43, s[92:95], s66 offen  lds
s_add_u32 m0, s73, 16384
s_nop 0
buffer_load_dwordx4 v48, s[96:99], s67 offen lds
s_add_u32 m0, s73, 20480
s_nop 0
buffer_load_dwordx4 v49, s[96:99], s67 offen lds
s_add_u32 m0, s73, 24576
s_nop 0
buffer_load_dwordx4 v50, s[96:99], s67 offen lds
s_add_u32 m0, s73, 28672
s_nop 0
buffer_load_dwordx4 v51, s[96:99], s67 offen lds
s_add_u32 s66, s66, 128
s_add_u32 s67, s67, s68
s_add_u32 s73, s73, 32768
s_cmp_ge_u32 s73, 131072
s_cselect_b32 s71, 131072, 0
s_sub_u32 s73, s73, s71
v_accvgpr_write_b32 a0, 0
v_accvgpr_write_b32 a1, 0
v_accvgpr_write_b32 a2, 0
v_accvgpr_write_b32 a3, 0
v_accvgpr_write_b32 a4, 0
v_accvgpr_write_b32 a5, 0
v_accvgpr_write_b32 a6, 0
v_accvgpr_write_b32 a7, 0
v_accvgpr_write_b32 a8, 0
v_accvgpr_write_b32 a9, 0
v_accvgpr_write_b32 a10, 0
v_accvgpr_write_b32 a11, 0
v_accvgpr_write_b32 a12, 0
v_accvgpr_write_b32 a13, 0
v_accvgpr_write_b32 a14, 0
v_accvgpr_write_b32 a15, 0
v_accvgpr_write_b32 a16, 0
v_accvgpr_write_b32 a17, 0
v_accvgpr_write_b32 a18, 0
v_accvgpr_write_b32 a19, 0
v_accvgpr_write_b32 a20, 0
v_accvgpr_write_b32 a21, 0
v_accvgpr_write_b32 a22, 0
v_accvgpr_write_b32 a23, 0
v_accvgpr_write_b32 a24, 0
v_accvgpr_write_b32 a25, 0
v_accvgpr_write_b32 a26, 0
v_accvgpr_write_b32 a27, 0
v_accvgpr_write_b32 a28, 0
v_accvgpr_write_b32 a29, 0
v_accvgpr_write_b32 a30, 0
v_accvgpr_write_b32 a31, 0
v_accvgpr_write_b32 a32, 0
v_accvgpr_write_b32 a33, 0
v_accvgpr_write_b32 a34, 0
v_accvgpr_write_b32 a35, 0
v_accvgpr_write_b32 a36, 0
v_accvgpr_write_b32 a37, 0
v_accvgpr_write_b32 a38, 0
v_accvgpr_write_b32 a39, 0
v_accvgpr_write_b32 a40, 0
v_accvgpr_write_b32 a41, 0
v_accvgpr_write_b32 a42, 0
v_accvgpr_write_b32 a43, 0
v_accvgpr_write_b32 a44, 0
v_accvgpr_write_b32 a45, 0
v_accvgpr_write_b32 a46, 0
v_accvgpr_write_b32 a47, 0
v_accvgpr_write_b32 a48, 0
v_accvgpr_write_b32 a49, 0
v_accvgpr_write_b32 a50, 0
v_accvgpr_write_b32 a51, 0
v_accvgpr_write_b32 a52, 0
v_accvgpr_write_b32 a53, 0
v_accvgpr_write_b32 a54, 0
v_accvgpr_write_b32 a55, 0
v_accvgpr_write_b32 a56, 0
v_accvgpr_write_b32 a57, 0
v_accvgpr_write_b32 a58, 0
v_accvgpr_write_b32 a59, 0
v_accvgpr_write_b32 a60, 0
v_accvgpr_write_b32 a61, 0
v_accvgpr_write_b32 a62, 0
v_accvgpr_write_b32 a63, 0
Lg_33:
s_waitcnt vmcnt(16)
s_barrier
ds_read_b128 v[64:67], v52 offset:0
ds_read_b128 v[68:71], v52 offset:4096
ds_read_b64_tr_b16 v[80:81], v56 offset:0
ds_read_b64_tr_b16 v[82:83], v56 offset:1024
ds_read_b64_tr_b16 v[84:85], v57 offset:0
ds_read_b64_tr_b16 v[86:87], v57 offset:1024
s_add_u32 s70, s70, 32768
s_cmp_ge_u32 s70, 131072
s_cselect_b32 s71, 131072, 0
s_sub_u32 s70, s70, s71
s_sub_u32 s74, 32768, s71
ds_read_b128 v[88:91], v53 offset:0
s_waitcnt lgkmcnt(1)
v_mfma_f32_32x32x16_bf16 a[0:15], v[80:83], v[64:67], a[0:15]
ds_read_b128 v[92:95], v53 offset:4096
ds_read_b64_tr_b16 v[104:105], v56 offset:4096
v_mfma_f32_32x32x16_bf16 a[16:31], v[84:87], v[64:67], a[16:31]
ds_read_b64_tr_b16 v[106:107], v56 offset:5120
ds_read_b64_tr_b16 v[108:109], v57 offset:4096
v_mfma_f32_32x32x16_bf16 a[32:47], v[80:83], v[68:71], a[32:47]
ds_read_b64_tr_b16 v[110:111], v57 offset:5120
s_add_u32 m0, s73, 0
s_nop 0
buffer_load_dwordx4 v40, s[92:95], s66 offen  lds
v_mfma_f32_32x32x16_bf16 a[48:63], v[84:87], v[68:71], a[48:63]
s_add_u32 m0, s73, 4096
s_nop 0
buffer_load_dwordx4 v41, s[92:95], s66 offen  lds
ds_read_b128 v[64:67], v54 offset:0
s_waitcnt lgkmcnt(1)
v_mfma_f32_32x32x16_bf16 a[0:15], v[104:107], v[88:91], a[0:15]
ds_read_b128 v[68:71], v54 offset:4096
ds_read_b64_tr_b16 v[80:81], v56 offset:8192
v_mfma_f32_32x32x16_bf16 a[16:31], v[108:111], v[88:91], a[16:31]
ds_read_b64_tr_b16 v[82:83], v56 offset:9216
ds_read_b64_tr_b16 v[84:85], v57 offset:8192
v_mfma_f32_32x32x16_bf16 a[32:47], v[104:107], v[92:95], a[32:47]
ds_read_b64_tr_b16 v[86:87], v57 offset:9216
s_add_u32 m0, s73, 8192
s_nop 0
buffer_load_dwordx4 v42, s[92:95], s66 offen  lds
v_mfma_f32_32x32x16_bf16 a[48:63], v[108:111], v[92:95], a[48:63]
s_add_u32 m0, s73, 12288
s_nop 0
buffer_load_dwordx4 v43, s[92:95], s66 offen  lds
ds_read_b128 v[88:91], v55 offset:0
s_waitcnt lgkmcnt(1)
v_mfma_f32_32x32x16_bf16 a[0:15], v[80:83], v[64:67], a[0:15]
ds_read_b128 v[92:95], v55 offset:4096
ds_read_b64_tr_b16 v[104:105], v56 offset:12288
v_mfma_f32_32x32x16_bf16 a[16:31], v[84:87], v[64:67], a[16:31]
ds_read_b64_tr_b16 v[106:107], v56 offset:13312
ds_read_b64_tr_b16 v[108:109], v57 offset:12288
v_mfma_f32_32x32x16_bf16 a[32:47], v[80:83], v[68:71], a[32:47]
ds_read_b64_tr_b16 v[110:111], v57 offset:13312
s_add_u32 m0, s73, 16384
s_nop 0
buffer_load_dwordx4 v48, s[96:99], s67 offen lds
v_mfma_f32_32x32x16_bf16 a[48:63], v[84:87], v[68:71], a[48:63]
s_add_u32 m0, s73, 20480
s_nop 0
buffer_load_dwordx4 v49, s[96:99], s67 offen lds
s_waitcnt lgkmcnt(0)
v_mfma_f32_32x32x16_bf16 a[0:15], v[104:107], v[88:91], a[0:15]
s_add_u32 m0, s73, 24576
s_nop 0
buffer_load_dwordx4 v50, s[96:99], s67 offen lds
s_add_u32 m0, s73, 28672
s_nop 0
buffer_load_dwordx4 v51, s[96:99], s67 offen lds
v_mfma_f32_32x32x16_bf16 a[16:31], v[108:111], v[88:91], a[16:31]
v_add_u32 v52, s74, v52
v_add_u32 v53, s74, v53
v_mfma_f32_32x32x16_bf16 a[32:47], v[104:107], v[92:95], a[32:47]
v_add_u32 v54, s74, v54
v_add_u32 v55, s74, v55
v_mfma_f32_32x32x16_bf16 a[48:63], v[108:111], v[92:95], a[48:63]
v_add_u32 v56, s74, v56
v_add_u32 v57, s74, v57
s_add_u32 s66, s66, 128
s_add_u32 s67, s67, s68
s_add_u32 s73, s73, 32768
s_cmp_ge_u32 s73, 131072
s_cselect_b32 s71, 131072, 0
s_sub_u32 s73, s73, s71
s_sub_u32 s69, s69, 1
s_cmp_lg_u32 s69, 0
s_cbranch_scc1 Lg_33
s_waitcnt vmcnt(0)
s_nop 7
s_branch L_epi
L_half0:
v_lshrrev_b32 v40, 3, v0
s_lshl_b32 s71, s65, 3
v_add_u32 v40, s71, v40
v_bfe_u32 v41, v40, 1, 3
v_and_b32 v42, 7, v0
v_xor_b32 v41, v41, v42
v_lshlrev_b32 v41, 4, v41
s_mov_b32 s71, 2048
v_mul_lo_u32 v40, v40, s71
v_add_u32 v40, v40, v41
s_lshl_b32 s71, s71, 5
v_add_u32 v41, s71, v40
v_add_u32 v42, s71, v41
v_add_u32 v43, s71, v42
v_lshrrev_b32 v48, 4, v0
v_and_b32 v50, 15, v0
v_lshlrev_b32 v49, 2, v48
v_xor_b32 v49, v49, v50
v_lshlrev_b32 v49, 4, v49
s_mul_i32 s71, s65, 4
v_add_u32 v48, s71, v48
s_mov_b32 s71, s3
v_mul_lo_u32 v48, v48, s71
v_add_u32 v48, v48, v49
s_lshl_b32 s68, s71, 6
s_mul_i32 s71, s71, 16
v_add_u32 v49, s71, v48
v_add_u32 v50, s71, v49
v_add_u32 v51, s71, v50
v_and_b32 v58, 31, v0
v_bfe_u32 v59, v0, 1, 3
v_lshrrev_b32 v60, 5, v0
v_xor_b32 v59, v59, v60
s_lshr_b32 s71, s65, 1
s_mul_i32 s71, s71, 8192
v_lshl_add_u32 v58, v58, 7, s71
v_xor_b32 v61, 0, v59
v_lshl_add_u32 v52, v61, 4, v58
v_xor_b32 v61, 2, v59
v_lshl_add_u32 v53, v61, 4, v58
v_xor_b32 v61, 4, v59
v_lshl_add_u32 v54, v61, 4, v58
v_xor_b32 v61, 6, v59
v_lshl_add_u32 v55, v61, 4, v58
v_bfe_u32 v58, v0, 2, 2
v_lshl_add_u32 v60, v60, 3, v58
v_mul_u32_u24 v60, 256, v60
v_bfe_u32 v61, v0, 4, 1
v_lshl_add_u32 v60, v61, 5, v60
v_and_b32 v61, 3, v0
v_lshl_add_u32 v60, v61, 3, v60
v_add_u32 v60, 16384, v60
s_and_b32 s71, s65, 1
s_mul_i32 s71, s71, 2
s_add_u32 s72, s71, 0
v_xor_b32 v61, s72, v58
v_lshl_add_u32 v56, v61, 6, v60
s_add_u32 s72, s71, 1
v_xor_b32 v61, s72, v58
v_lshl_add_u32 v57, v61, 6, v60
s_and_b32 s6, s76, 1
s_lshl_b32 s66, s6, 18
s_lshl_b32 s67, s86, 8
s_mov_b32 s69, 16
s_lshl_b32 s73, s65, 10
s_mov_b32 s70, 0
s_mov_b32 s75, 0
s_barrier
s_add_u32 m0, s73, 0
s_nop 0
buffer_load_dwordx4 v40, s[92:95], s66 offen  lds
s_add_u32 m0, s73, 4096
s_nop 0
buffer_load_dwordx4 v41, s[92:95], s66 offen  lds
s_add_u32 m0, s73, 8192
s_nop 0
buffer_load_dwordx4 v42, s[92:95], s66 offen  lds
s_add_u32 m0, s73, 12288
s_nop 0
buffer_load_dwordx4 v43, s[92:95], s66 offen  lds
s_add_u32 m0, s73, 16384
s_nop 0
buffer_load_dwordx4 v48, s[96:99], s67 offen lds
s_add_u32 m0, s73, 20480
s_nop 0
buffer_load_dwordx4 v49, s[96:99], s67 offen lds
s_add_u32 m0, s73, 24576
s_nop 0
buffer_load_dwordx4 v50, s[96:99], s67 offen lds
s_add_u32 m0, s73, 28672
s_nop 0
buffer_load_dwordx4 v51, s[96:99], s67 offen lds
s_add_u32 s66, s66, 128
s_add_u32 s67, s67, s68
s_add_u32 s73, s73, 32768
s_cmp_ge_u32 s73, 131072
s_cselect_b32 s71, 131072, 0
s_sub_u32 s73, s73, s71
s_add_u32 m0, s73, 0
s_nop 0
buffer_load_dwordx4 v40, s[92:95], s66 offen  lds
s_add_u32 m0, s73, 4096
s_nop 0
buffer_load_dwordx4 v41, s[92:95], s66 offen  lds
s_add_u32 m0, s73, 8192
s_nop 0
buffer_load_dwordx4 v42, s[92:95], s66 offen  lds
s_add_u32 m0, s73, 12288
s_nop 0
buffer_load_dwordx4 v43, s[92:95], s66 offen  lds
s_add_u32 m0, s73, 16384
s_nop 0
buffer_load_dwordx4 v48, s[96:99], s67 offen lds
s_add_u32 m0, s73, 20480
s_nop 0
buffer_load_dwordx4 v49, s[96:99], s67 offen lds
s_add_u32 m0, s73, 24576
s_nop 0
buffer_load_dwordx4 v50, s[96:99], s67 offen lds
s_add_u32 m0, s73, 28672
s_nop 0
buffer_load_dwordx4 v51, s[96:99], s67 offen lds
s_add_u32 s66, s66, 128
s_add_u32 s67, s67, s68
s_add_u32 s73, s73, 32768
s_cmp_ge_u32 s73, 131072
s_cselect_b32 s71, 131072, 0
s_sub_u32 s73, s73, s71
s_add_u32 m0, s73, 0
s_nop 0
buffer_load_dwordx4 v40, s[92:95], s66 offen  lds
s_add_u32 m0, s73, 4096
s_nop 0
buffer_load_dwordx4 v41, s[92:95], s66 offen  lds
s_add_u32 m0, s73, 8192
s_nop 0
buffer_load_dwordx4 v42, s[92:95], s66 offen  lds
s_add_u32 m0, s73, 12288
s_nop 0
buffer_load_dwordx4 v43, s[92:95], s66 offen  lds
s_add_u32 m0, s73, 16384
s_nop 0
buffer_load_dwordx4 v48, s[96:99], s67 offen lds
s_add_u32 m0, s73, 20480
s_nop 0
buffer_load_dwordx4 v49, s[96:99], s67 offen lds
s_add_u32 m0, s73, 24576
s_nop 0
buffer_load_dwordx4 v50, s[96:99], s67 offen lds
s_add_u32 m0, s73, 28672
s_nop 0
buffer_load_dwordx4 v51, s[96:99], s67 offen lds
s_add_u32 s66, s66, 128
s_add_u32 s67, s67, s68
s_add_u32 s73, s73, 32768
s_cmp_ge_u32 s73, 131072
s_cselect_b32 s71, 131072, 0
s_sub_u32 s73, s73, s71
v_accvgpr_write_b32 a0, 0
v_accvgpr_write_b32 a1, 0
v_accvgpr_write_b32 a2, 0
v_accvgpr_write_b32 a3, 0
v_accvgpr_write_b32 a4, 0
v_accvgpr_write_b32 a5, 0
v_accvgpr_write_b32 a6, 0
v_accvgpr_write_b32 a7, 0
v_accvgpr_write_b32 a8, 0
v_accvgpr_write_b32 a9, 0
v_accvgpr_write_b32 a10, 0
v_accvgpr_write_b32 a11, 0
v_accvgpr_write_b32 a12, 0
v_accvgpr_write_b32 a13, 0
v_accvgpr_write_b32 a14, 0
v_accvgpr_write_b32 a15, 0
v_accvgpr_write_b32 a16, 0
v_accvgpr_write_b32 a17, 0
v_accvgpr_write_b32 a18, 0
v_accvgpr_write_b32 a19, 0
v_accvgpr_write_b32 a20, 0
v_accvgpr_write_b32 a21, 0
v_accvgpr_write_b32 a22, 0
v_accvgpr_write_b32 a23, 0
v_accvgpr_write_b32 a24, 0
v_accvgpr_write_b32 a25, 0
v_accvgpr_write_b32 a26, 0
v_accvgpr_write_b32 a27, 0
v_accvgpr_write_b32 a28, 0
v_accvgpr_write_b32 a29, 0
v_accvgpr_write_b32 a30, 0
v_accvgpr_write_b32 a31, 0
v_accvgpr_write_b32 a32, 0
v_accvgpr_write_b32 a33, 0
v_accvgpr_write_b32 a34, 0
v_accvgpr_write_b32 a35, 0
v_accvgpr_write_b32 a36, 0
v_accvgpr_write_b32 a37, 0
v_accvgpr_write_b32 a38, 0
v_accvgpr_write_b32 a39, 0
v_accvgpr_write_b32 a40, 0
v_accvgpr_write_b32 a41, 0
v_accvgpr_write_b32 a42, 0
v_accvgpr_write_b32 a43, 0
v_accvgpr_write_b32 a44, 0
v_accvgpr_write_b32 a45, 0
v_accvgpr_write_b32 a46, 0
v_accvgpr_write_b32 a47, 0
v_accvgpr_write_b32 a48, 0
v_accvgpr_write_b32 a49, 0
v_accvgpr_write_b32 a50, 0
v_accvgpr_write_b32 a51, 0
v_accvgpr_write_b32 a52, 0
v_accvgpr_write_b32 a53, 0
v_accvgpr_write_b32 a54, 0
v_accvgpr_write_b32 a55, 0
v_accvgpr_write_b32 a56, 0
v_accvgpr_write_b32 a57, 0
v_accvgpr_write_b32 a58, 0
v_accvgpr_write_b32 a59, 0
v_accvgpr_write_b32 a60, 0
v_accvgpr_write_b32 a61, 0
v_accvgpr_write_b32 a62, 0
v_accvgpr_write_b32 a63, 0
Lg_34:
s_waitcnt vmcnt(16)
s_barrier
ds_read_b128 v[64:67], v52 offset:0
ds_read_b128 v[68:71], v52 offset:4096
ds_read_b64_tr_b16 v[80:81], v56 offset:0
ds_read_b64_tr_b16 v[82:83], v56 offset:1024
ds_read_b64_tr_b16 v[84:85], v57 offset:0
ds_read_b64_tr_b16 v[86:87], v57 offset:1024
s_add_u32 s70, s70, 32768
s_cmp_ge_u32 s70, 131072
s_cselect_b32 s71, 131072, 0
s_sub_u32 s70, s70, s71
s_sub_u32 s74, 32768, s71
ds_read_b128 v[88:91], v53 offset:0
s_waitcnt lgkmcnt(1)
v_mfma_f32_32x32x16_bf16 a[0:15], v[64:67], v[80:83], a[0:15]
ds_read_b128 v[92:95], v53 offset:4096
ds_read_b64_tr_b16 v[104:105], v56 offset:4096
v_mfma_f32_32x32x16_bf16 a[16:31], v[64:67], v[84:87], a[16:31]
ds_read_b64_tr_b16 v[106:107], v56 offset:5120
ds_read_b64_tr_b16 v[108:109], v57 offset:4096
v_mfma_f32_32x32x16_bf16 a[32:47], v[68:71], v[80:83], a[32:47]
ds_read_b64_tr_b16 v[110:111], v57 offset:5120
s_add_u32 m0, s73, 0
s_nop 0
buffer_load_dwordx4 v40, s[92:95], s66 offen  lds
v_mfma_f32_32x32x16_bf16 a[48:63], v[68:71], v[84:87], a[48:63]
s_add_u32 m0, s73, 4096
s_nop 0
buffer_load_dwordx4 v41, s[92:95], s66 offen  lds
ds_read_b128 v[64:67], v54 offset:0
s_waitcnt lgkmcnt(1)
v_mfma_f32_32x32x16_bf16 a[0:15], v[88:91], v[104:107], a[0:15]
ds_read_b128 v[68:71], v54 offset:4096
ds_read_b64_tr_b16 v[80:81], v56 offset:8192
v_mfma_f32_32x32x16_bf16 a[16:31], v[88:91], v[108:111], a[16:31]
ds_read_b64_tr_b16 v[82:83], v56 offset:9216
ds_read_b64_tr_b16 v[84:85], v57 offset:8192
v_mfma_f32_32x32x16_bf16 a[32:47], v[92:95], v[104:107], a[32:47]
ds_read_b64_tr_b16 v[86:87], v57 offset:9216
s_add_u32 m0, s73, 8192
s_nop 0
buffer_load_dwordx4 v42, s[92:95], s66 offen  lds
v_mfma_f32_32x32x16_bf16 a[48:63], v[92:95], v[108:111], a[48:63]
s_add_u32 m0, s73, 12288
s_nop 0
buffer_load_dwordx4 v43, s[92:95], s66 offen  lds
ds_read_b128 v[88:91], v55 offset:0
s_waitcnt lgkmcnt(1)
v_mfma_f32_32x32x16_bf16 a[0:15], v[64:67], v[80:83], a[0:15]
ds_read_b128 v[92:95], v55 offset:4096
ds_read_b64_tr_b16 v[104:105], v56 offset:12288
v_mfma_f32_32x32x16_bf16 a[16:31], v[64:67], v[84:87], a[16:31]
ds_read_b64_tr_b16 v[106:107], v56 offset:13312
ds_read_b64_tr_b16 v[108:109], v57 offset:12288
v_mfma_f32_32x32x16_bf16 a[32:47], v[68:71], v[80:83], a[32:47]
ds_read_b64_tr_b16 v[110:111], v57 offset:13312
s_add_u32 m0, s73, 16384
s_nop 0
buffer_load_dwordx4 v48, s[96:99], s67 offen lds
v_mfma_f32_32x32x16_bf16 a[48:63], v[68:71], v[84:87], a[48:63]
s_add_u32 m0, s73, 20480
s_nop 0
buffer_load_dwordx4 v49, s[96:99], s67 offen lds
s_waitcnt lgkmcnt(0)
v_mfma_f32_32x32x16_bf16 a[0:15], v[88:91], v[104:107], a[0:15]
s_add_u32 m0, s73, 24576
s_nop 0
buffer_load_dwordx4 v50, s[96:99], s67 offen lds
s_add_u32 m0, s73, 28672
s_nop 0
buffer_load_dwordx4 v51, s[96:99], s67 offen lds
v_mfma_f32_32x32x16_bf16 a[16:31], v[88:91], v[108:111], a[16:31]
v_add_u32 v52, s74, v52
v_add_u32 v53, s74, v53
v_mfma_f32_32x32x16_bf16 a[32:47], v[92:95], v[104:107], a[32:47]
v_add_u32 v54, s74, v54
v_add_u32 v55, s74, v55
v_mfma_f32_32x32x16_bf16 a[48:63], v[92:95], v[108:111], a[48:63]
v_add_u32 v56, s74, v56
v_add_u32 v57, s74, v57
s_add_u32 s66, s66, 128
s_add_u32 s67, s67, s68
s_add_u32 s73, s73, 32768
s_cmp_ge_u32 s73, 131072
s_cselect_b32 s71, 131072, 0
s_sub_u32 s73, s73, s71
s_sub_u32 s69, s69, 1
s_cmp_lg_u32 s69, 0
s_cbranch_scc1 Lg_34
s_waitcnt vmcnt(0)
s_nop 7
L_epi:
s_cmp_lg_u32 s90, 2
s_cbranch_scc1 L_epi_v
s_mov_b32 s90, 3
s_branch L_role_all
L_epi_v:
s_and_b32 s6, s76, 1
s_cmp_eq_u32 s87, -1
s_cbranch_scc1 L_noclr
v_lshlrev_b32 v5, 4, v0
v_mov_b32 v8, -1
v_mov_b32 v9, -1
v_mov_b32 v10, -1
v_mov_b32 v11, -1
buffer_store_dwordx4 v[8:11], v5, s[60:63], s87 offen sc1
s_add_u32 s87, s87, 4096
buffer_store_dwordx4 v[8:11], v5, s[60:63], s87 offen sc1
s_add_u32 s87, s87, 4096
buffer_store_dwordx4 v[8:11], v5, s[60:63], s87 offen sc1
s_add_u32 s87, s87, 4096
buffer_store_dwordx4 v[8:11], v5, s[60:63], s87 offen sc1
s_add_u32 s87, s87, 4096
buffer_store_dwordx4 v[8:11], v5, s[60:63], s87 offen sc1
s_add_u32 s87, s87, 4096
buffer_store_dwordx4 v[8:11], v5, s[60:63], s87 offen sc1
s_add_u32 s87, s87, 4096
buffer_store_dwordx4 v[8:11], v5, s[60:63], s87 offen sc1
s_add_u32 s87, s87, 4096
s_cmp_lg_u32 s85, 7
s_cbranch_scc1 L_noclr
s_sub_u32 s87, s76, 512
s_lshl_b32 s87, s87, 13
s_lshl_b32 s71, s65, 11
s_add_u32 s87, s87, s71
s_add_u32 s87, s87, 58195968
buffer_store_dwordx4 v[8:11], v5, s[60:63], s87 offen offset:0 sc1
buffer_store_dwordx4 v[8:11], v5, s[60:63], s87 offen offset:1024 sc1
L_noclr:
s_cmp_ge_u32 s76, 128
s_cbranch_scc1 L_epi_full
v_accvgpr_read_b32 v120, a0
v_accvgpr_read_b32 v121, a1
v_accvgpr_read_b32 v122, a2
v_accvgpr_read_b32 v123, a3
v_accvgpr_read_b32 v124, a4
v_accvgpr_read_b32 v125, a5
v_accvgpr_read_b32 v126, a6
v_accvgpr_read_b32 v127, a7
v_accvgpr_read_b32 v128, a8
v_accvgpr_read_b32 v129, a9
v_accvgpr_read_b32 v130, a10
v_accvgpr_read_b32 v131, a11
v_accvgpr_read_b32 v132, a12
v_accvgpr_read_b32 v133, a13
v_accvgpr_read_b32 v134, a14
v_accvgpr_read_b32 v135, a15
v_pk_mul_f32 v[120:121], v[120:121], s[88:89]
v_pk_mul_f32 v[122:123], v[122:123], s[88:89]
v_pk_mul_f32 v[124:125], v[124:125], s[88:89]
v_pk_mul_f32 v[126:127], v[126:127], s[88:89]
v_pk_mul_f32 v[128:129], v[128:129], s[88:89]
v_pk_mul_f32 v[130:131], v[130:131], s[88:89]
v_pk_mul_f32 v[132:133], v[132:133], s[88:89]
v_pk_mul_f32 v[134:135], v[134:135], s[88:89]
v_cvt_pk_bf16_f32 v112, v120, v121
v_cvt_pk_bf16_f32 v113, v122, v123
v_cvt_pk_bf16_f32 v114, v124, v125
v_cvt_pk_bf16_f32 v115, v126, v127
v_cvt_pk_bf16_f32 v116, v128, v129
v_cvt_pk_bf16_f32 v117, v130, v131
v_cvt_pk_bf16_f32 v118, v132, v133
v_cvt_pk_bf16_f32 v119, v134, v135
s_nop 1
v_permlane32_swap_b32 v112, v114
v_permlane32_swap_b32 v113, v115
v_permlane32_swap_b32 v116, v118
v_permlane32_swap_b32 v117, v119
s_lshr_b32 s71, s65, 1
s_mul_i32 s71, s71, 2
s_mul_i32 s72, s6, 4
s_add_u32 s71, s71, s72
s_add_u32 s71, s71, 0
s_mul_i32 s66, s71, s79
s_add_u32 s66, s66, s77
s_and_b32 s71, s65, 1
s_lshl_b32 s71, s71, 1
s_lshl_b32 s72, s86, 2
s_add_u32 s71, s71, s72
s_add_u32 s71, s71, 0
s_lshr_b32 s72, s71, s80
s_mul_i32 s67, s72, s81
s_add_u32 s66, s66, s67
s_lshl_b32 s72, s72, s80
s_sub_u32 s71, s71, s72
s_mul_i32 s67, s71, s82
s_add_u32 s66, s66, s67
s_add_u32 s67, s66, s83
buffer_store_dwordx4 v[112:115], v62, s[60:63], s66 offen sc1
buffer_store_dwordx4 v[116:119], v62, s[60:63], s67 offen sc1
v_accvgpr_read_b32 v144, a16
v_accvgpr_read_b32 v145, a17
v_accvgpr_read_b32 v146, a18
v_accvgpr_read_b32 v147, a19
v_accvgpr_read_b32 v148, a20
v_accvgpr_read_b32 v149, a21
v_accvgpr_read_b32 v150, a22
v_accvgpr_read_b32 v151, a23
v_accvgpr_read_b32 v152, a24
v_accvgpr_read_b32 v153, a25
v_accvgpr_read_b32 v154, a26
v_accvgpr_read_b32 v155, a27
v_accvgpr_read_b32 v156, a28
v_accvgpr_read_b32 v157, a29
v_accvgpr_read_b32 v158, a30
v_accvgpr_read_b32 v159, a31
v_pk_mul_f32 v[144:145], v[144:145], s[88:89]
v_pk_mul_f32 v[146:147], v[146:147], s[88:89]
v_pk_mul_f32 v[148:149], v[148:149], s[88:89]
v_pk_mul_f32 v[150:151], v[150:151], s[88:89]
v_pk_mul_f32 v[152:153], v[152:153], s[88:89]
v_pk_mul_f32 v[154:155], v[154:155], s[88:89]
v_pk_mul_f32 v[156:157], v[156:157], s[88:89]
v_pk_mul_f32 v[158:159], v[158:159], s[88:89]
v_cvt_pk_bf16_f32 v136, v144, v145
v_cvt_pk_bf16_f32 v137, v146, v147
v_cvt_pk_bf16_f32 v138, v148, v149
v_cvt_pk_bf16_f32 v139, v150, v151
v_cvt_pk_bf16_f32 v140, v152, v153
v_cvt_pk_bf16_f32 v141, v154, v155
v_cvt_pk_bf16_f32 v142, v156, v157
v_cvt_pk_bf16_f32 v143, v158, v159
s_nop 1
v_permlane32_swap_b32 v136, v138
v_permlane32_swap_b32 v137, v139
v_permlane32_swap_b32 v140, v142
v_permlane32_swap_b32 v141, v143
s_lshr_b32 s71, s65, 1
s_mul_i32 s71, s71, 2
s_mul_i32 s72, s6, 4
s_add_u32 s71, s71, s72
s_add_u32 s71, s71, 0
s_mul_i32 s66, s71, s79
s_add_u32 s66, s66, s77
s_and_b32 s71, s65, 1
s_lshl_b32 s71, s71, 1
s_lshl_b32 s72, s86, 2
s_add_u32 s71, s71, s72
s_add_u32 s71, s71, 1
s_lshr_b32 s72, s71, s80
s_mul_i32 s67, s72, s81
s_add_u32 s66, s66, s67
s_lshl_b32 s72, s72, s80
s_sub_u32 s71, s71, s72
s_mul_i32 s67, s71, s82
s_add_u32 s66, s66, s67
s_add_u32 s67, s66, s83
buffer_store_dwordx4 v[136:139], v62, s[60:63], s66 offen sc1
buffer_store_dwordx4 v[140:143], v62, s[60:63], s67 offen sc1
v_accvgpr_read_b32 v120, a32
v_accvgpr_read_b32 v121, a33
v_accvgpr_read_b32 v122, a34
v_accvgpr_read_b32 v123, a35
v_accvgpr_read_b32 v124, a36
v_accvgpr_read_b32 v125, a37
v_accvgpr_read_b32 v126, a38
v_accvgpr_read_b32 v127, a39
v_accvgpr_read_b32 v128, a40
v_accvgpr_read_b32 v129, a41
v_accvgpr_read_b32 v130, a42
v_accvgpr_read_b32 v131, a43
v_accvgpr_read_b32 v132, a44
v_accvgpr_read_b32 v133, a45
v_accvgpr_read_b32 v134, a46
v_accvgpr_read_b32 v135, a47
v_pk_mul_f32 v[120:121], v[120:121], s[88:89]
v_pk_mul_f32 v[122:123], v[122:123], s[88:89]
v_pk_mul_f32 v[124:125], v[124:125], s[88:89]
v_pk_mul_f32 v[126:127], v[126:127], s[88:89]
v_pk_mul_f32 v[128:129], v[128:129], s[88:89]
v_pk_mul_f32 v[130:131], v[130:131], s[88:89]
v_pk_mul_f32 v[132:133], v[132:133], s[88:89]
v_pk_mul_f32 v[134:135], v[134:135], s[88:89]
v_cvt_pk_bf16_f32 v112, v120, v121
v_cvt_pk_bf16_f32 v113, v122, v123
v_cvt_pk_bf16_f32 v114, v124, v125
v_cvt_pk_bf16_f32 v115, v126, v127
v_cvt_pk_bf16_f32 v116, v128, v129
v_cvt_pk_bf16_f32 v117, v130, v131
v_cvt_pk_bf16_f32 v118, v132, v133
v_cvt_pk_bf16_f32 v119, v134, v135
s_nop 1
v_permlane32_swap_b32 v112, v114
v_permlane32_swap_b32 v113, v115
v_permlane32_swap_b32 v116, v118
v_permlane32_swap_b32 v117, v119
s_lshr_b32 s71, s65, 1
s_mul_i32 s71, s71, 2
s_mul_i32 s72, s6, 4
s_add_u32 s71, s71, s72
s_add_u32 s71, s71, 1
s_mul_i32 s66, s71, s79
s_add_u32 s66, s66, s77
s_and_b32 s71, s65, 1
s_lshl_b32 s71, s71, 1
s_lshl_b32 s72, s86, 2
s_add_u32 s71, s71, s72
s_add_u32 s71, s71, 0
s_lshr_b32 s72, s71, s80
s_mul_i32 s67, s72, s81
s_add_u32 s66, s66, s67
s_lshl_b32 s72, s72, s80
s_sub_u32 s71, s71, s72
s_mul_i32 s67, s71, s82
s_add_u32 s66, s66, s67
s_add_u32 s67, s66, s83
buffer_store_dwordx4 v[112:115], v62, s[60:63], s66 offen sc1
buffer_store_dwordx4 v[116:119], v62, s[60:63], s67 offen sc1
v_accvgpr_read_b32 v144, a48
v_accvgpr_read_b32 v145, a49
v_accvgpr_read_b32 v146, a50
v_accvgpr_read_b32 v147, a51
v_accvgpr_read_b32 v148, a52
v_accvgpr_read_b32 v149, a53
v_accvgpr_read_b32 v150, a54
v_accvgpr_read_b32 v151, a55
v_accvgpr_read_b32 v152, a56
v_accvgpr_read_b32 v153, a57
v_accvgpr_read_b32 v154, a58
v_accvgpr_read_b32 v155, a59
v_accvgpr_read_b32 v156, a60
v_accvgpr_read_b32 v157, a61
v_accvgpr_read_b32 v158, a62
v_accvgpr_read_b32 v159, a63
v_pk_mul_f32 v[144:145], v[144:145], s[88:89]
v_pk_mul_f32 v[146:147], v[146:147], s[88:89]
v_pk_mul_f32 v[148:149], v[148:149], s[88:89]
v_pk_mul_f32 v[150:151], v[150:151], s[88:89]
v_pk_mul_f32 v[152:153], v[152:153], s[88:89]
v_pk_mul_f32 v[154:155], v[154:155], s[88:89]
v_pk_mul_f32 v[156:157], v[156:157], s[88:89]
v_pk_mul_f32 v[158:159], v[158:159], s[88:89]
v_cvt_pk_bf16_f32 v136, v144, v145
v_cvt_pk_bf16_f32 v137, v146, v147
v_cvt_pk_bf16_f32 v138, v148, v149
v_cvt_pk_bf16_f32 v139, v150, v151
v_cvt_pk_bf16_f32 v140, v152, v153
v_cvt_pk_bf16_f32 v141, v154, v155
v_cvt_pk_bf16_f32 v142, v156, v157
v_cvt_pk_bf16_f32 v143, v158, v159
s_nop 1
v_permlane32_swap_b32 v136, v138
v_permlane32_swap_b32 v137, v139
v_permlane32_swap_b32 v140, v142
v_permlane32_swap_b32 v141, v143
s_lshr_b32 s71, s65, 1
s_mul_i32 s71, s71, 2
s_mul_i32 s72, s6, 4
s_add_u32 s71, s71, s72
s_add_u32 s71, s71, 1
s_mul_i32 s66, s71, s79
s_add_u32 s66, s66, s77
s_and_b32 s71, s65, 1
s_lshl_b32 s71, s71, 1
s_lshl_b32 s72, s86, 2
s_add_u32 s71, s71, s72
s_add_u32 s71, s71, 1
s_lshr_b32 s72, s71, s80
s_mul_i32 s67, s72, s81
s_add_u32 s66, s66, s67
s_lshl_b32 s72, s72, s80
s_sub_u32 s71, s71, s72
s_mul_i32 s67, s71, s82
s_add_u32 s66, s66, s67
s_add_u32 s67, s66, s83
buffer_store_dwordx4 v[136:139], v62, s[60:63], s66 offen sc1
buffer_store_dwordx4 v[140:143], v62, s[60:63], s67 offen sc1
s_branch L_epi_done
L_epi_full:
v_accvgpr_read_b32 v120, a0
v_accvgpr_read_b32 v121, a1
v_accvgpr_read_b32 v122, a2
v_accvgpr_read_b32 v123, a3
v_accvgpr_read_b32 v124, a4
v_accvgpr_read_b32 v125, a5
v_accvgpr_read_b32 v126, a6
v_accvgpr_read_b32 v127, a7
v_accvgpr_read_b32 v128, a8
v_accvgpr_read_b32 v129, a9
v_accvgpr_read_b32 v130, a10
v_accvgpr_read_b32 v131, a11
v_accvgpr_read_b32 v132, a12
v_accvgpr_read_b32 v133, a13
v_accvgpr_read_b32 v134, a14
v_accvgpr_read_b32 v135, a15
v_pk_mul_f32 v[120:121], v[120:121], s[88:89]
v_pk_mul_f32 v[122:123], v[122:123], s[88:89]
v_pk_mul_f32 v[124:125], v[124:125], s[88:89]
v_pk_mul_f32 v[126:127], v[126:127], s[88:89]
v_pk_mul_f32 v[128:129], v[128:129], s[88:89]
v_pk_mul_f32 v[130:131], v[130:131], s[88:89]
v_pk_mul_f32 v[132:133], v[132:133], s[88:89]
v_pk_mul_f32 v[134:135], v[134:135], s[88:89]
v_cvt_pk_bf16_f32 v112, v120, v121
v_cvt_pk_bf16_f32 v113, v122, v123
v_cvt_pk_bf16_f32 v114, v124, v125
v_cvt_pk_bf16_f32 v115, v126, v127
v_cvt_pk_bf16_f32 v116, v128, v129
v_cvt_pk_bf16_f32 v117, v130, v131
v_cvt_pk_bf16_f32 v118, v132, v133
v_cvt_pk_bf16_f32 v119, v134, v135
s_nop 1
v_permlane32_swap_b32 v112, v114
v_permlane32_swap_b32 v113, v115
v_permlane32_swap_b32 v116, v118
v_permlane32_swap_b32 v117, v119
s_lshr_b32 s71, s65, 1
s_mul_i32 s71, s71, 4
s_mul_i32 s72, s85, 8
s_add_u32 s71, s71, s72
s_add_u32 s71, s71, 0
s_mul_i32 s66, s71, s79
s_add_u32 s66, s66, s77
s_and_b32 s71, s65, 1
s_lshl_b32 s71, s71, 1
s_lshl_b32 s72, s86, 2
s_add_u32 s71, s71, s72
s_add_u32 s71, s71, 0
s_lshr_b32 s72, s71, s80
s_mul_i32 s67, s72, s81
s_add_u32 s66, s66, s67
s_lshl_b32 s72, s72, s80
s_sub_u32 s71, s71, s72
s_mul_i32 s67, s71, s82
s_add_u32 s66, s66, s67
s_add_u32 s67, s66, s83
buffer_store_dwordx4 v[112:115], v62, s[60:63], s66 offen sc1
buffer_store_dwordx4 v[116:119], v62, s[60:63], s67 offen sc1
v_accvgpr_read_b32 v144, a16
v_accvgpr_read_b32 v145, a17
v_accvgpr_read_b32 v146, a18
v_accvgpr_read_b32 v147, a19
v_accvgpr_read_b32 v148, a20
v_accvgpr_read_b32 v149, a21
v_accvgpr_read_b32 v150, a22
v_accvgpr_read_b32 v151, a23
v_accvgpr_read_b32 v152, a24
v_accvgpr_read_b32 v153, a25
v_accvgpr_read_b32 v154, a26
v_accvgpr_read_b32 v155, a27
v_accvgpr_read_b32 v156, a28
v_accvgpr_read_b32 v157, a29
v_accvgpr_read_b32 v158, a30
v_accvgpr_read_b32 v159, a31
v_pk_mul_f32 v[144:145], v[144:145], s[88:89]
v_pk_mul_f32 v[146:147], v[146:147], s[88:89]
v_pk_mul_f32 v[148:149], v[148:149], s[88:89]
v_pk_mul_f32 v[150:151], v[150:151], s[88:89]
v_pk_mul_f32 v[152:153], v[152:153], s[88:89]
v_pk_mul_f32 v[154:155], v[154:155], s[88:89]
v_pk_mul_f32 v[156:157], v[156:157], s[88:89]
v_pk_mul_f32 v[158:159], v[158:159], s[88:89]
v_cvt_pk_bf16_f32 v136, v144, v145
v_cvt_pk_bf16_f32 v137, v146, v147
v_cvt_pk_bf16_f32 v138, v148, v149
v_cvt_pk_bf16_f32 v139, v150, v151
v_cvt_pk_bf16_f32 v140, v152, v153
v_cvt_pk_bf16_f32 v141, v154, v155
v_cvt_pk_bf16_f32 v142, v156, v157
v_cvt_pk_bf16_f32 v143, v158, v159
s_nop 1
v_permlane32_swap_b32 v136, v138
v_permlane32_swap_b32 v137, v139
v_permlane32_swap_b32 v140, v142
v_permlane32_swap_b32 v141, v143
s_lshr_b32 s71, s65, 1
s_mul_i32 s71, s71, 4
s_mul_i32 s72, s85, 8
s_add_u32 s71, s71, s72
s_add_u32 s71, s71, 0
s_mul_i32 s66, s71, s79
s_add_u32 s66, s66, s77
s_and_b32 s71, s65, 1
s_lshl_b32 s71, s71, 1
s_lshl_b32 s72, s86, 2
s_add_u32 s71, s71, s72
s_add_u32 s71, s71, 1
s_lshr_b32 s72, s71, s80
s_mul_i32 s67, s72, s81
s_add_u32 s66, s66, s67
s_lshl_b32 s72, s72, s80
s_sub_u32 s71, s71, s72
s_mul_i32 s67, s71, s82
s_add_u32 s66, s66, s67
s_add_u32 s67, s66, s83
buffer_store_dwordx4 v[136:139], v62, s[60:63], s66 offen sc1
buffer_store_dwordx4 v[140:143], v62, s[60:63], s67 offen sc1
v_accvgpr_read_b32 v120, a32
v_accvgpr_read_b32 v121, a33
v_accvgpr_read_b32 v122, a34
v_accvgpr_read_b32 v123, a35
v_accvgpr_read_b32 v124, a36
v_accvgpr_read_b32 v125, a37
v_accvgpr_read_b32 v126, a38
v_accvgpr_read_b32 v127, a39
v_accvgpr_read_b32 v128, a40
v_accvgpr_read_b32 v129, a41
v_accvgpr_read_b32 v130, a42
v_accvgpr_read_b32 v131, a43
v_accvgpr_read_b32 v132, a44
v_accvgpr_read_b32 v133, a45
v_accvgpr_read_b32 v134, a46
v_accvgpr_read_b32 v135, a47
v_pk_mul_f32 v[120:121], v[120:121], s[88:89]
v_pk_mul_f32 v[122:123], v[122:123], s[88:89]
v_pk_mul_f32 v[124:125], v[124:125], s[88:89]
v_pk_mul_f32 v[126:127], v[126:127], s[88:89]
v_pk_mul_f32 v[128:129], v[128:129], s[88:89]
v_pk_mul_f32 v[130:131], v[130:131], s[88:89]
v_pk_mul_f32 v[132:133], v[132:133], s[88:89]
v_pk_mul_f32 v[134:135], v[134:135], s[88:89]
v_cvt_pk_bf16_f32 v112, v120, v121
v_cvt_pk_bf16_f32 v113, v122, v123
v_cvt_pk_bf16_f32 v114, v124, v125
v_cvt_pk_bf16_f32 v115, v126, v127
v_cvt_pk_bf16_f32 v116, v128, v129
v_cvt_pk_bf16_f32 v117, v130, v131
v_cvt_pk_bf16_f32 v118, v132, v133
v_cvt_pk_bf16_f32 v119, v134, v135
s_nop 1
v_permlane32_swap_b32 v112, v114
v_permlane32_swap_b32 v113, v115
v_permlane32_swap_b32 v116, v118
v_permlane32_swap_b32 v117, v119
s_lshr_b32 s71, s65, 1
s_mul_i32 s71, s71, 4
s_mul_i32 s72, s85, 8
s_add_u32 s71, s71, s72
s_add_u32 s71, s71, 1
s_mul_i32 s66, s71, s79
s_add_u32 s66, s66, s77
s_and_b32 s71, s65, 1
s_lshl_b32 s71, s71, 1
s_lshl_b32 s72, s86, 2
s_add_u32 s71, s71, s72
s_add_u32 s71, s71, 0
s_lshr_b32 s72, s71, s80
s_mul_i32 s67, s72, s81
s_add_u32 s66, s66, s67
s_lshl_b32 s72, s72, s80
s_sub_u32 s71, s71, s72
s_mul_i32 s67, s71, s82
s_add_u32 s66, s66, s67
s_add_u32 s67, s66, s83
buffer_store_dwordx4 v[112:115], v62, s[60:63], s66 offen sc1
buffer_store_dwordx4 v[116:119], v62, s[60:63], s67 offen sc1
v_accvgpr_read_b32 v144, a48
v_accvgpr_read_b32 v145, a49
v_accvgpr_read_b32 v146, a50
v_accvgpr_read_b32 v147, a51
v_accvgpr_read_b32 v148, a52
v_accvgpr_read_b32 v149, a53
v_accvgpr_read_b32 v150, a54
v_accvgpr_read_b32 v151, a55
v_accvgpr_read_b32 v152, a56
v_accvgpr_read_b32 v153, a57
v_accvgpr_read_b32 v154, a58
v_accvgpr_read_b32 v155, a59
v_accvgpr_read_b32 v156, a60
v_accvgpr_read_b32 v157, a61
v_accvgpr_read_b32 v158, a62
v_accvgpr_read_b32 v159, a63
v_pk_mul_f32 v[144:145], v[144:145], s[88:89]
v_pk_mul_f32 v[146:147], v[146:147], s[88:89]
v_pk_mul_f32 v[148:149], v[148:149], s[88:89]
v_pk_mul_f32 v[150:151], v[150:151], s[88:89]
v_pk_mul_f32 v[152:153], v[152:153], s[88:89]
v_pk_mul_f32 v[154:155], v[154:155], s[88:89]
v_pk_mul_f32 v[156:157], v[156:157], s[88:89]
v_pk_mul_f32 v[158:159], v[158:159], s[88:89]
v_cvt_pk_bf16_f32 v136, v144, v145
v_cvt_pk_bf16_f32 v137, v146, v147
v_cvt_pk_bf16_f32 v138, v148, v149
v_cvt_pk_bf16_f32 v139, v150, v151
v_cvt_pk_bf16_f32 v140, v152, v153
v_cvt_pk_bf16_f32 v141, v154, v155
v_cvt_pk_bf16_f32 v142, v156, v157
v_cvt_pk_bf16_f32 v143, v158, v159
s_nop 1
v_permlane32_swap_b32 v136, v138
v_permlane32_swap_b32 v137, v139
v_permlane32_swap_b32 v140, v142
v_permlane32_swap_b32 v141, v143
s_lshr_b32 s71, s65, 1
s_mul_i32 s71, s71, 4
s_mul_i32 s72, s85, 8
s_add_u32 s71, s71, s72
s_add_u32 s71, s71, 1
s_mul_i32 s66, s71, s79
s_add_u32 s66, s66, s77
s_and_b32 s71, s65, 1
s_lshl_b32 s71, s71, 1
s_lshl_b32 s72, s86, 2
s_add_u32 s71, s71, s72
s_add_u32 s71, s71, 1
s_lshr_b32 s72, s71, s80
s_mul_i32 s67, s72, s81
s_add_u32 s66, s66, s67
s_lshl_b32 s72, s72, s80
s_sub_u32 s71, s71, s72
s_mul_i32 s67, s71, s82
s_add_u32 s66, s66, s67
s_add_u32 s67, s66, s83
buffer_store_dwordx4 v[136:139], v62, s[60:63], s66 offen sc1
buffer_store_dwordx4 v[140:143], v62, s[60:63], s67 offen sc1
v_accvgpr_read_b32 v120, a64
v_accvgpr_read_b32 v121, a65
v_accvgpr_read_b32 v122, a66
v_accvgpr_read_b32 v123, a67
v_accvgpr_read_b32 v124, a68
v_accvgpr_read_b32 v125, a69
v_accvgpr_read_b32 v126, a70
v_accvgpr_read_b32 v127, a71
v_accvgpr_read_b32 v128, a72
v_accvgpr_read_b32 v129, a73
v_accvgpr_read_b32 v130, a74
v_accvgpr_read_b32 v131, a75
v_accvgpr_read_b32 v132, a76
v_accvgpr_read_b32 v133, a77
v_accvgpr_read_b32 v134, a78
v_accvgpr_read_b32 v135, a79
v_pk_mul_f32 v[120:121], v[120:121], s[88:89]
v_pk_mul_f32 v[122:123], v[122:123], s[88:89]
v_pk_mul_f32 v[124:125], v[124:125], s[88:89]
v_pk_mul_f32 v[126:127], v[126:127], s[88:89]
v_pk_mul_f32 v[128:129], v[128:129], s[88:89]
v_pk_mul_f32 v[130:131], v[130:131], s[88:89]
v_pk_mul_f32 v[132:133], v[132:133], s[88:89]
v_pk_mul_f32 v[134:135], v[134:135], s[88:89]
v_cvt_pk_bf16_f32 v112, v120, v121
v_cvt_pk_bf16_f32 v113, v122, v123
v_cvt_pk_bf16_f32 v114, v124, v125
v_cvt_pk_bf16_f32 v115, v126, v127
v_cvt_pk_bf16_f32 v116, v128, v129
v_cvt_pk_bf16_f32 v117, v130, v131
v_cvt_pk_bf16_f32 v118, v132, v133
v_cvt_pk_bf16_f32 v119, v134, v135
s_nop 1
v_permlane32_swap_b32 v112, v114
v_permlane32_swap_b32 v113, v115
v_permlane32_swap_b32 v116, v118
v_permlane32_swap_b32 v117, v119
s_lshr_b32 s71, s65, 1
s_mul_i32 s71, s71, 4
s_mul_i32 s72, s85, 8
s_add_u32 s71, s71, s72
s_add_u32 s71, s71, 2
s_mul_i32 s66, s71, s79
s_add_u32 s66, s66, s77
s_and_b32 s71, s65, 1
s_lshl_b32 s71, s71, 1
s_lshl_b32 s72, s86, 2
s_add_u32 s71, s71, s72
s_add_u32 s71, s71, 0
s_lshr_b32 s72, s71, s80
s_mul_i32 s67, s72, s81
s_add_u32 s66, s66, s67
s_lshl_b32 s72, s72, s80
s_sub_u32 s71, s71, s72
s_mul_i32 s67, s71, s82
s_add_u32 s66, s66, s67
s_add_u32 s67, s66, s83
buffer_store_dwordx4 v[112:115], v62, s[60:63], s66 offen sc1
buffer_store_dwordx4 v[116:119], v62, s[60:63], s67 offen sc1
v_accvgpr_read_b32 v144, a80
v_accvgpr_read_b32 v145, a81
v_accvgpr_read_b32 v146, a82
v_accvgpr_read_b32 v147, a83
v_accvgpr_read_b32 v148, a84
v_accvgpr_read_b32 v149, a85
v_accvgpr_read_b32 v150, a86
v_accvgpr_read_b32 v151, a87
v_accvgpr_read_b32 v152, a88
v_accvgpr_read_b32 v153, a89
v_accvgpr_read_b32 v154, a90
v_accvgpr_read_b32 v155, a91
v_accvgpr_read_b32 v156, a92
v_accvgpr_read_b32 v157, a93
v_accvgpr_read_b32 v158, a94
v_accvgpr_read_b32 v159, a95
v_pk_mul_f32 v[144:145], v[144:145], s[88:89]
v_pk_mul_f32 v[146:147], v[146:147], s[88:89]
v_pk_mul_f32 v[148:149], v[148:149], s[88:89]
v_pk_mul_f32 v[150:151], v[150:151], s[88:89]
v_pk_mul_f32 v[152:153], v[152:153], s[88:89]
v_pk_mul_f32 v[154:155], v[154:155], s[88:89]
v_pk_mul_f32 v[156:157], v[156:157], s[88:89]
v_pk_mul_f32 v[158:159], v[158:159], s[88:89]
v_cvt_pk_bf16_f32 v136, v144, v145
v_cvt_pk_bf16_f32 v137, v146, v147
v_cvt_pk_bf16_f32 v138, v148, v149
v_cvt_pk_bf16_f32 v139, v150, v151
v_cvt_pk_bf16_f32 v140, v152, v153
v_cvt_pk_bf16_f32 v141, v154, v155
v_cvt_pk_bf16_f32 v142, v156, v157
v_cvt_pk_bf16_f32 v143, v158, v159
s_nop 1
v_permlane32_swap_b32 v136, v138
v_permlane32_swap_b32 v137, v139
v_permlane32_swap_b32 v140, v142
v_permlane32_swap_b32 v141, v143
s_lshr_b32 s71, s65, 1
s_mul_i32 s71, s71, 4
s_mul_i32 s72, s85, 8
s_add_u32 s71, s71, s72
s_add_u32 s71, s71, 2
s_mul_i32 s66, s71, s79
s_add_u32 s66, s66, s77
s_and_b32 s71, s65, 1
s_lshl_b32 s71, s71, 1
s_lshl_b32 s72, s86, 2
s_add_u32 s71, s71, s72
s_add_u32 s71, s71, 1
s_lshr_b32 s72, s71, s80
s_mul_i32 s67, s72, s81
s_add_u32 s66, s66, s67
s_lshl_b32 s72, s72, s80
s_sub_u32 s71, s71, s72
s_mul_i32 s67, s71, s82
s_add_u32 s66, s66, s67
s_add_u32 s67, s66, s83
buffer_store_dwordx4 v[136:139], v62, s[60:63], s66 offen sc1
buffer_store_dwordx4 v[140:143], v62, s[60:63], s67 offen sc1
v_accvgpr_read_b32 v120, a96
v_accvgpr_read_b32 v121, a97
v_accvgpr_read_b32 v122, a98
v_accvgpr_read_b32 v123, a99
v_accvgpr_read_b32 v124, a100
v_accvgpr_read_b32 v125, a101
v_accvgpr_read_b32 v126, a102
v_accvgpr_read_b32 v127, a103
v_accvgpr_read_b32 v128, a104
v_accvgpr_read_b32 v129, a105
v_accvgpr_read_b32 v130, a106
v_accvgpr_read_b32 v131, a107
v_accvgpr_read_b32 v132, a108
v_accvgpr_read_b32 v133, a109
v_accvgpr_read_b32 v134, a110
v_accvgpr_read_b32 v135, a111
v_pk_mul_f32 v[120:121], v[120:121], s[88:89]
v_pk_mul_f32 v[122:123], v[122:123], s[88:89]
v_pk_mul_f32 v[124:125], v[124:125], s[88:89]
v_pk_mul_f32 v[126:127], v[126:127], s[88:89]
v_pk_mul_f32 v[128:129], v[128:129], s[88:89]
v_pk_mul_f32 v[130:131], v[130:131], s[88:89]
v_pk_mul_f32 v[132:133], v[132:133], s[88:89]
v_pk_mul_f32 v[134:135], v[134:135], s[88:89]
v_cvt_pk_bf16_f32 v112, v120, v121
v_cvt_pk_bf16_f32 v113, v122, v123
v_cvt_pk_bf16_f32 v114, v124, v125
v_cvt_pk_bf16_f32 v115, v126, v127
v_cvt_pk_bf16_f32 v116, v128, v129
v_cvt_pk_bf16_f32 v117, v130, v131
v_cvt_pk_bf16_f32 v118, v132, v133
v_cvt_pk_bf16_f32 v119, v134, v135
s_nop 1
v_permlane32_swap_b32 v112, v114
v_permlane32_swap_b32 v113, v115
v_permlane32_swap_b32 v116, v118
v_permlane32_swap_b32 v117, v119
s_lshr_b32 s71, s65, 1
s_mul_i32 s71, s71, 4
s_mul_i32 s72, s85, 8
s_add_u32 s71, s71, s72
s_add_u32 s71, s71, 3
s_mul_i32 s66, s71, s79
s_add_u32 s66, s66, s77
s_and_b32 s71, s65, 1
s_lshl_b32 s71, s71, 1
s_lshl_b32 s72, s86, 2
s_add_u32 s71, s71, s72
s_add_u32 s71, s71, 0
s_lshr_b32 s72, s71, s80
s_mul_i32 s67, s72, s81
s_add_u32 s66, s66, s67
s_lshl_b32 s72, s72, s80
s_sub_u32 s71, s71, s72
s_mul_i32 s67, s71, s82
s_add_u32 s66, s66, s67
s_add_u32 s67, s66, s83
buffer_store_dwordx4 v[112:115], v62, s[60:63], s66 offen sc1
buffer_store_dwordx4 v[116:119], v62, s[60:63], s67 offen sc1
v_accvgpr_read_b32 v144, a112
v_accvgpr_read_b32 v145, a113
v_accvgpr_read_b32 v146, a114
v_accvgpr_read_b32 v147, a115
v_accvgpr_read_b32 v148, a116
v_accvgpr_read_b32 v149, a117
v_accvgpr_read_b32 v150, a118
v_accvgpr_read_b32 v151, a119
v_accvgpr_read_b32 v152, a120
v_accvgpr_read_b32 v153, a121
v_accvgpr_read_b32 v154, a122
v_accvgpr_read_b32 v155, a123
v_accvgpr_read_b32 v156, a124
v_accvgpr_read_b32 v157, a125
v_accvgpr_read_b32 v158, a126
v_accvgpr_read_b32 v159, a127
v_pk_mul_f32 v[144:145], v[144:145], s[88:89]
v_pk_mul_f32 v[146:147], v[146:147], s[88:89]
v_pk_mul_f32 v[148:149], v[148:149], s[88:89]
v_pk_mul_f32 v[150:151], v[150:151], s[88:89]
v_pk_mul_f32 v[152:153], v[152:153], s[88:89]
v_pk_mul_f32 v[154:155], v[154:155], s[88:89]
v_pk_mul_f32 v[156:157], v[156:157], s[88:89]
v_pk_mul_f32 v[158:159], v[158:159], s[88:89]
v_cvt_pk_bf16_f32 v136, v144, v145
v_cvt_pk_bf16_f32 v137, v146, v147
v_cvt_pk_bf16_f32 v138, v148, v149
v_cvt_pk_bf16_f32 v139, v150, v151
v_cvt_pk_bf16_f32 v140, v152, v153
v_cvt_pk_bf16_f32 v141, v154, v155
v_cvt_pk_bf16_f32 v142, v156, v157
v_cvt_pk_bf16_f32 v143, v158, v159
s_nop 1
v_permlane32_swap_b32 v136, v138
v_permlane32_swap_b32 v137, v139
v_permlane32_swap_b32 v140, v142
v_permlane32_swap_b32 v141, v143
s_lshr_b32 s71, s65, 1
s_mul_i32 s71, s71, 4
s_mul_i32 s72, s85, 8
s_add_u32 s71, s71, s72
s_add_u32 s71, s71, 3
s_mul_i32 s66, s71, s79
s_add_u32 s66, s66, s77
s_and_b32 s71, s65, 1
s_lshl_b32 s71, s71, 1
s_lshl_b32 s72, s86, 2
s_add_u32 s71, s71, s72
s_add_u32 s71, s71, 1
s_lshr_b32 s72, s71, s80
s_mul_i32 s67, s72, s81
s_add_u32 s66, s66, s67
s_lshl_b32 s72, s72, s80
s_sub_u32 s71, s71, s72
s_mul_i32 s67, s71, s82
s_add_u32 s66, s66, s67
s_add_u32 s67, s66, s83
buffer_store_dwordx4 v[136:139], v62, s[60:63], s66 offen sc1
buffer_store_dwordx4 v[140:143], v62, s[60:63], s67 offen sc1
L_epi_done:
s_mov_b32 s101, s100
s_cmp_eq_u32 s65, 0
s_cselect_b32 s91, s84, -1
s_cmp_ge_u32 s76, 192
s_cbranch_scc1 L_next
s_waitcnt vmcnt(0)
s_barrier
s_cmp_eq_u32 s91, -1
s_cbranch_scc1 Lfl_35
v_mov_b32 v9, 0
v_mov_b32 v10, s101
s_mov_b64 exec, 1
buffer_atomic_add v10, v9, s[56:59], s91 offen sc1
s_mov_b64 exec, -1
s_mov_b32 s91, -1
Lfl_35:
s_branch L_next
L_t_attn:
s_waitcnt vmcnt(0)
s_barrier
s_cmp_eq_u32 s91, -1
s_cbranch_scc1 Lfl_36
v_mov_b32 v9, 0
v_mov_b32 v10, s101
s_mov_b64 exec, 1
buffer_atomic_add v10, v9, s[56:59], s91 offen sc1
s_mov_b64 exec, -1
s_mov_b32 s91, -1
Lfl_36:
s_cmp_ge_u32 s76, 1168
s_cbranch_scc1 L_stream
s_sub_u32 s71, s76, 912
s_lshr_b32 s85, s71, 2
s_and_b32 s86, s71, 3
s_lshr_b32 s66, s85, 3
s_lshl_b32 s66, s66, 2
v_mov_b32 v9, 0
s_mov_b32 s78, 0
Lz_37:
buffer_load_dwordx2 v[4:5], v9, s[56:59], 0 offen offset:96 sc1
buffer_load_dword v6, v9, s[56:59], s66 offen offset:128 sc1
s_waitcnt vmcnt(0)
s_add_u32 s78, s78, 1
s_cmp_gt_u32 s78, 0x40000
s_cbranch_scc1 Lz_38
v_readfirstlane_b32 s72, v4
s_cmp_lt_u32 s72, 192
s_cbranch_scc1 Lb_39
v_readfirstlane_b32 s72, v5
s_cmp_lt_u32 s72, 16
s_cbranch_scc1 Lb_39
v_readfirstlane_b32 s72, v6
s_cmp_lt_u32 s72, 8
s_cbranch_scc1 Lb_39
s_branch Lz_38
Lb_39:
s_sleep 12
s_branch Lz_37
Lz_38:
s_barrier
v_lshlrev_b32 v1, 4, v0
s_lshl_b32 s71, s85, 2
s_add_u32 s71, s71, s86
s_lshl_b32 s71, s71, 2
s_add_u32 s71, s71, s65
s_lshl_b32 s71, s71, 12
s_add_u32 s71, s71, 58720256
buffer_load_dwordx4 v[12:15], v1, s[60:63], s71 offen offset:0
buffer_load_dwordx4 v[16:19], v1, s[60:63], s71 offen offset:1024
buffer_load_dwordx4 v[20:23], v1, s[60:63], s71 offen offset:2048
buffer_load_dwordx4 v[24:27], v1, s[60:63], s71 offen offset:3072
v_and_b32 v2, 31, v0
v_lshlrev_b32 v3, 2, v2
s_lshl_b32 s71, s85, 7
s_add_u32 s71, s71, 63176704
buffer_load_dword v4, v3, s[60:63], s71 offen sc1
s_lshl_b32 s72, s65, 10
s_mov_b32 m0, s72
s_add_u32 s66, s72, 62914560
buffer_load_dwordx4 v1, s[60:63], s66 offen lds
s_add_u32 m0, m0, 4096
s_add_u32 s66, s66, 4096
buffer_load_dwordx4 v1, s[60:63], s66 offen lds
s_add_u32 m0, m0, 4096
s_add_u32 s66, s66, 4096
buffer_load_dwordx4 v1, s[60:63], s66 offen lds
s_add_u32 m0, m0, 4096
s_add_u32 s66, s66, 4096
buffer_load_dwordx4 v1, s[60:63], s66 offen lds
s_add_u32 m0, m0, 4096
s_add_u32 s66, s66, 4096
buffer_load_dwordx4 v1, s[60:63], s66 offen lds
s_add_u32 m0, m0, 4096
s_add_u32 s66, s66, 4096
buffer_load_dwordx4 v1, s[60:63], s66 offen lds
s_add_u32 m0, m0, 4096
s_add_u32 s66, s66, 4096
buffer_load_dwordx4 v1, s[60:63], s66 offen lds
s_add_u32 m0, m0, 4096
s_add_u32 s66, s66, 4096
buffer_load_dwordx4 v1, s[60:63], s66 offen lds
s_add_u32 m0, m0, 4096
s_add_u32 s66, s66, 4096
buffer_load_dwordx4 v1, s[60:63], s66 offen lds
s_add_u32 m0, m0, 4096
s_add_u32 s66, s66, 4096
buffer_load_dwordx4 v1, s[60:63], s66 offen lds
s_add_u32 m0, m0, 4096
s_add_u32 s66, s66, 4096
buffer_load_dwordx4 v1, s[60:63], s66 offen lds
s_add_u32 m0, m0, 4096
s_add_u32 s66, s66, 4096
buffer_load_dwordx4 v1, s[60:63], s66 offen lds
s_add_u32 m0, m0, 4096
s_add_u32 s66, s66, 4096
buffer_load_dwordx4 v1, s[60:63], s66 offen lds
s_add_u32 m0, m0, 4096
s_add_u32 s66, s66, 4096
buffer_load_dwordx4 v1, s[60:63], s66 offen lds
s_add_u32 m0, m0, 4096
s_add_u32 s66, s66, 4096
buffer_load_dwordx4 v1, s[60:63], s66 offen lds
s_add_u32 m0, m0, 4096
s_add_u32 s66, s66, 4096
buffer_load_dwordx4 v1, s[60:63], s66 offen lds
s_add_u32 m0, m0, 4096
s_add_u32 s66, s66, 4096
buffer_load_dwordx4 v1, s[60:63], s66 offen lds
s_add_u32 m0, m0, 4096
s_add_u32 s66, s66, 4096
buffer_load_dwordx4 v1, s[60:63], s66 offen lds
s_add_u32 m0, m0, 4096
s_add_u32 s66, s66, 4096
buffer_load_dwordx4 v1, s[60:63], s66 offen lds
s_add_u32 m0, m0, 4096
s_add_u32 s66, s66, 4096
buffer_load_dwordx4 v1, s[60:63], s66 offen lds
s_add_u32 m0, m0, 4096
s_add_u32 s66, s66, 4096
buffer_load_dwordx4 v1, s[60:63], s66 offen lds
s_add_u32 m0, m0, 4096
s_add_u32 s66, s66, 4096
buffer_load_dwordx4 v1, s[60:63], s66 offen lds
s_add_u32 m0, m0, 4096
s_add_u32 s66, s66, 4096
buffer_load_dwordx4 v1, s[60:63], s66 offen lds
s_add_u32 m0, m0, 4096
s_add_u32 s66, s66, 4096
buffer_load_dwordx4 v1, s[60:63], s66 offen lds
s_add_u32 m0, m0, 4096
s_add_u32 s66, s66, 4096
buffer_load_dwordx4 v1, s[60:63], s66 offen lds
s_add_u32 m0, m0, 4096
s_add_u32 s66, s66, 4096
buffer_load_dwordx4 v1, s[60:63], s66 offen lds
s_add_u32 m0, m0, 4096
s_add_u32 s66, s66, 4096
buffer_load_dwordx4 v1, s[60:63], s66 offen lds
s_add_u32 m0, m0, 4096
s_add_u32 s66, s66, 4096
buffer_load_dwordx4 v1, s[60:63], s66 offen lds
s_add_u32 m0, m0, 4096
s_add_u32 s66, s66, 4096
buffer_load_dwordx4 v1, s[60:63], s66 offen lds
s_add_u32 m0, m0, 4096
s_add_u32 s66, s66, 4096
buffer_load_dwordx4 v1, s[60:63], s66 offen lds
s_add_u32 m0, m0, 4096
s_add_u32 s66, s66, 4096
buffer_load_dwordx4 v1, s[60:63], s66 offen lds
s_add_u32 m0, m0, 4096
s_add_u32 s66, s66, 4096
buffer_load_dwordx4 v1, s[60:63], s66 offen lds
s_add_u32 m0, m0, 4096
s_add_u32 s66, s66, 4096
v_mov_b32 v5, 0xff7fffff
v_mov_b32 v6, 0xff7fffff
v_mov_b32 v92, v1
v_mov_b32 v128, 0xff7fffff
v_mov_b32 v129, 0xff7fffff
v_mov_b32 v130, 0xff7fffff
v_mov_b32 v131, 0xff7fffff
v_mov_b32 v132, 0xff7fffff
v_mov_b32 v133, 0xff7fffff
v_mov_b32 v134, 0xff7fffff
v_mov_b32 v135, 0xff7fffff
v_mov_b32 v136, 0xff7fffff
v_mov_b32 v137, 0xff7fffff
v_mov_b32 v138, 0xff7fffff
v_mov_b32 v139, 0xff7fffff
v_mov_b32 v140, 0xff7fffff
v_mov_b32 v141, 0xff7fffff
v_mov_b32 v142, 0xff7fffff
v_mov_b32 v143, 0xff7fffff
v_mov_b32 v144, 0xff7fffff
v_mov_b32 v145, 0xff7fffff
v_mov_b32 v146, 0xff7fffff
v_mov_b32 v147, 0xff7fffff
v_mov_b32 v148, 0xff7fffff
v_mov_b32 v149, 0xff7fffff
v_mov_b32 v150, 0xff7fffff
v_mov_b32 v151, 0xff7fffff
v_mov_b32 v152, 0xff7fffff
v_mov_b32 v153, 0xff7fffff
v_mov_b32 v154, 0xff7fffff
v_mov_b32 v155, 0xff7fffff
v_mov_b32 v156, 0xff7fffff
v_mov_b32 v157, 0xff7fffff
v_mov_b32 v158, 0xff7fffff
v_mov_b32 v159, 0xff7fffff
s_waitcnt vmcnt(24)
s_barrier
ds_read_b128 v[28:31], v92 offset:0
ds_read_b128 v[32:35], v92 offset:1024
ds_read_b128 v[44:47], v92 offset:2048
ds_read_b128 v[48:51], v92 offset:3072
s_mov_b32 s69, 4
Lb_40:
ds_read_b128 v[60:63], v92 offset:4096
ds_read_b128 v[64:67], v92 offset:5120
s_waitcnt lgkmcnt(4)
v_mfma_f32_32x32x16_bf16 v[96:111], v[28:31], v[12:15], 0
v_max3_f32 v5, v5, v128, v129
v_max3_f32 v5, v5, v130, v131
v_max3_f32 v5, v5, v132, v133
v_max3_f32 v5, v5, v134, v135
v_mfma_f32_32x32x16_bf16 v[112:127], v[28:31], v[20:23], 0
v_max3_f32 v6, v6, v144, v145
v_max3_f32 v6, v6, v146, v147
v_max3_f32 v6, v6, v148, v149
v_max3_f32 v6, v6, v150, v151
v_mfma_f32_32x32x16_bf16 v[96:111], v[32:35], v[16:19], v[96:111]
v_max3_f32 v5, v5, v136, v137
v_max3_f32 v5, v5, v138, v139
v_max3_f32 v5, v5, v140, v141
v_max3_f32 v5, v5, v142, v143
v_mfma_f32_32x32x16_bf16 v[112:127], v[32:35], v[24:27], v[112:127]
v_max3_f32 v6, v6, v152, v153
v_max3_f32 v6, v6, v154, v155
v_max3_f32 v6, v6, v156, v157
v_max3_f32 v6, v6, v158, v159
ds_read_b128 v[76:79], v92 offset:6144
ds_read_b128 v[80:83], v92 offset:7168
s_waitcnt lgkmcnt(4)
v_mfma_f32_32x32x16_bf16 v[128:143], v[44:47], v[12:15], 0
v_max3_f32 v5, v5, v96, v97
v_max3_f32 v5, v5, v98, v99
v_max3_f32 v5, v5, v100, v101
v_max3_f32 v5, v5, v102, v103
v_mfma_f32_32x32x16_bf16 v[144:159], v[44:47], v[20:23], 0
v_max3_f32 v6, v6, v112, v113
v_max3_f32 v6, v6, v114, v115
v_max3_f32 v6, v6, v116, v117
v_max3_f32 v6, v6, v118, v119
v_mfma_f32_32x32x16_bf16 v[128:143], v[48:51], v[16:19], v[128:143]
v_max3_f32 v5, v5, v104, v105
v_max3_f32 v5, v5, v106, v107
v_max3_f32 v5, v5, v108, v109
v_max3_f32 v5, v5, v110, v111
v_mfma_f32_32x32x16_bf16 v[144:159], v[48:51], v[24:27], v[144:159]
v_max3_f32 v6, v6, v120, v121
v_max3_f32 v6, v6, v122, v123
v_max3_f32 v6, v6, v124, v125
v_max3_f32 v6, v6, v126, v127
ds_read_b128 v[28:31], v92 offset:8192
ds_read_b128 v[32:35], v92 offset:9216
s_waitcnt lgkmcnt(4)
v_mfma_f32_32x32x16_bf16 v[96:111], v[60:63], v[12:15], 0
v_max3_f32 v5, v5, v128, v129
v_max3_f32 v5, v5, v130, v131
v_max3_f32 v5, v5, v132, v133
v_max3_f32 v5, v5, v134, v135
v_mfma_f32_32x32x16_bf16 v[112:127], v[60:63], v[20:23], 0
v_max3_f32 v6, v6, v144, v145
v_max3_f32 v6, v6, v146, v147
v_max3_f32 v6, v6, v148, v149
v_max3_f32 v6, v6, v150, v151
v_mfma_f32_32x32x16_bf16 v[96:111], v[64:67], v[16:19], v[96:111]
v_max3_f32 v5, v5, v136, v137
v_max3_f32 v5, v5, v138, v139
v_max3_f32 v5, v5, v140, v141
v_max3_f32 v5, v5, v142, v143
v_mfma_f32_32x32x16_bf16 v[112:127], v[64:67], v[24:27], v[112:127]
v_max3_f32 v6, v6, v152, v153
v_max3_f32 v6, v6, v154, v155
v_max3_f32 v6, v6, v156, v157
v_max3_f32 v6, v6, v158, v159
ds_read_b128 v[44:47], v92 offset:10240
ds_read_b128 v[48:51], v92 offset:11264
s_waitcnt lgkmcnt(4)
v_mfma_f32_32x32x16_bf16 v[128:143], v[76:79], v[12:15], 0
v_max3_f32 v5, v5, v96, v97
v_max3_f32 v5, v5, v98, v99
v_max3_f32 v5, v5, v100, v101
v_max3_f32 v5, v5, v102, v103
v_mfma_f32_32x32x16_bf16 v[144:159], v[76:79], v[20:23], 0
v_max3_f32 v6, v6, v112, v113
v_max3_f32 v6, v6, v114, v115
v_max3_f32 v6, v6, v116, v117
v_max3_f32 v6, v6, v118, v119
v_mfma_f32_32x32x16_bf16 v[128:143], v[80:83], v[16:19], v[128:143]
v_max3_f32 v5, v5, v104, v105
v_max3_f32 v5, v5, v106, v107
v_max3_f32 v5, v5, v108, v109
v_max3_f32 v5, v5, v110, v111
v_mfma_f32_32x32x16_bf16 v[144:159], v[80:83], v[24:27], v[144:159]
v_max3_f32 v6, v6, v120, v121
v_max3_f32 v6, v6, v122, v123
v_max3_f32 v6, v6, v124, v125
v_max3_f32 v6, v6, v126, v127
v_add_u32 v92, 8192, v92
s_sub_u32 s69, s69, 1
s_cmp_lg_u32 s69, 0
s_cbranch_scc1 Lb_40
s_waitcnt lgkmcnt(0)
s_waitcnt vmcnt(16)
s_barrier
ds_read_b128 v[28:31], v92 offset:0
ds_read_b128 v[32:35], v92 offset:1024
ds_read_b128 v[44:47], v92 offset:2048
ds_read_b128 v[48:51], v92 offset:3072
s_mov_b32 s69, 4
Lb_41:
ds_read_b128 v[60:63], v92 offset:4096
ds_read_b128 v[64:67], v92 offset:5120
s_waitcnt lgkmcnt(4)
v_mfma_f32_32x32x16_bf16 v[96:111], v[28:31], v[12:15], 0
v_max3_f32 v5, v5, v128, v129
v_max3_f32 v5, v5, v130, v131
v_max3_f32 v5, v5, v132, v133
v_max3_f32 v5, v5, v134, v135
v_mfma_f32_32x32x16_bf16 v[112:127], v[28:31], v[20:23], 0
v_max3_f32 v6, v6, v144, v145
v_max3_f32 v6, v6, v146, v147
v_max3_f32 v6, v6, v148, v149
v_max3_f32 v6, v6, v150, v151
v_mfma_f32_32x32x16_bf16 v[96:111], v[32:35], v[16:19], v[96:111]
v_max3_f32 v5, v5, v136, v137
v_max3_f32 v5, v5, v138, v139
v_max3_f32 v5, v5, v140, v141
v_max3_f32 v5, v5, v142, v143
v_mfma_f32_32x32x16_bf16 v[112:127], v[32:35], v[24:27], v[112:127]
v_max3_f32 v6, v6, v152, v153
v_max3_f32 v6, v6, v154, v155
v_max3_f32 v6, v6, v156, v157
v_max3_f32 v6, v6, v158, v159
ds_read_b128 v[76:79], v92 offset:6144
ds_read_b128 v[80:83], v92 offset:7168
s_waitcnt lgkmcnt(4)
v_mfma_f32_32x32x16_bf16 v[128:143], v[44:47], v[12:15], 0
v_max3_f32 v5, v5, v96, v97
v_max3_f32 v5, v5, v98, v99
v_max3_f32 v5, v5, v100, v101
v_max3_f32 v5, v5, v102, v103
v_mfma_f32_32x32x16_bf16 v[144:159], v[44:47], v[20:23], 0
v_max3_f32 v6, v6, v112, v113
v_max3_f32 v6, v6, v114, v115
v_max3_f32 v6, v6, v116, v117
v_max3_f32 v6, v6, v118, v119
v_mfma_f32_32x32x16_bf16 v[128:143], v[48:51], v[16:19], v[128:143]
v_max3_f32 v5, v5, v104, v105
v_max3_f32 v5, v5, v106, v107
v_max3_f32 v5, v5, v108, v109
v_max3_f32 v5, v5, v110, v111
v_mfma_f32_32x32x16_bf16 v[144:159], v[48:51], v[24:27], v[144:159]
v_max3_f32 v6, v6, v120, v121
v_max3_f32 v6, v6, v122, v123
v_max3_f32 v6, v6, v124, v125
v_max3_f32 v6, v6, v126, v127
ds_read_b128 v[28:31], v92 offset:8192
ds_read_b128 v[32:35], v92 offset:9216
s_waitcnt lgkmcnt(4)
v_mfma_f32_32x32x16_bf16 v[96:111], v[60:63], v[12:15], 0
v_max3_f32 v5, v5, v128, v129
v_max3_f32 v5, v5, v130, v131
v_max3_f32 v5, v5, v132, v133
v_max3_f32 v5, v5, v134, v135
v_mfma_f32_32x32x16_bf16 v[112:127], v[60:63], v[20:23], 0
v_max3_f32 v6, v6, v144, v145
v_max3_f32 v6, v6, v146, v147
v_max3_f32 v6, v6, v148, v149
v_max3_f32 v6, v6, v150, v151
v_mfma_f32_32x32x16_bf16 v[96:111], v[64:67], v[16:19], v[96:111]
v_max3_f32 v5, v5, v136, v137
v_max3_f32 v5, v5, v138, v139
v_max3_f32 v5, v5, v140, v141
v_max3_f32 v5, v5, v142, v143
v_mfma_f32_32x32x16_bf16 v[112:127], v[64:67], v[24:27], v[112:127]
v_max3_f32 v6, v6, v152, v153
v_max3_f32 v6, v6, v154, v155
v_max3_f32 v6, v6, v156, v157
v_max3_f32 v6, v6, v158, v159
ds_read_b128 v[44:47], v92 offset:10240
ds_read_b128 v[48:51], v92 offset:11264
s_waitcnt lgkmcnt(4)
v_mfma_f32_32x32x16_bf16 v[128:143], v[76:79], v[12:15], 0
v_max3_f32 v5, v5, v96, v97
v_max3_f32 v5, v5, v98, v99
v_max3_f32 v5, v5, v100, v101
v_max3_f32 v5, v5, v102, v103
v_mfma_f32_32x32x16_bf16 v[144:159], v[76:79], v[20:23], 0
v_max3_f32 v6, v6, v112, v113
v_max3_f32 v6, v6, v114, v115
v_max3_f32 v6, v6, v116, v117
v_max3_f32 v6, v6, v118, v119
v_mfma_f32_32x32x16_bf16 v[128:143], v[80:83], v[16:19], v[128:143]
v_max3_f32 v5, v5, v104, v105
v_max3_f32 v5, v5, v106, v107
v_max3_f32 v5, v5, v108, v109
v_max3_f32 v5, v5, v110, v111
v_mfma_f32_32x32x16_bf16 v[144:159], v[80:83], v[24:27], v[144:159]
v_max3_f32 v6, v6, v120, v121
v_max3_f32 v6, v6, v122, v123
v_max3_f32 v6, v6, v124, v125
v_max3_f32 v6, v6, v126, v127
v_add_u32 v92, 8192, v92
s_sub_u32 s69, s69, 1
s_cmp_lg_u32 s69, 0
s_cbranch_scc1 Lb_41
s_waitcnt lgkmcnt(0)
s_waitcnt vmcnt(8)
s_barrier
ds_read_b128 v[28:31], v92 offset:0
ds_read_b128 v[32:35], v92 offset:1024
ds_read_b128 v[44:47], v92 offset:2048
ds_read_b128 v[48:51], v92 offset:3072
s_mov_b32 s69, 4
Lb_42:
ds_read_b128 v[60:63], v92 offset:4096
ds_read_b128 v[64:67], v92 offset:5120
s_waitcnt lgkmcnt(4)
v_mfma_f32_32x32x16_bf16 v[96:111], v[28:31], v[12:15], 0
v_max3_f32 v5, v5, v128, v129
v_max3_f32 v5, v5, v130, v131
v_max3_f32 v5, v5, v132, v133
v_max3_f32 v5, v5, v134, v135
v_mfma_f32_32x32x16_bf16 v[112:127], v[28:31], v[20:23], 0
v_max3_f32 v6, v6, v144, v145
v_max3_f32 v6, v6, v146, v147
v_max3_f32 v6, v6, v148, v149
v_max3_f32 v6, v6, v150, v151
v_mfma_f32_32x32x16_bf16 v[96:111], v[32:35], v[16:19], v[96:111]
v_max3_f32 v5, v5, v136, v137
v_max3_f32 v5, v5, v138, v139
v_max3_f32 v5, v5, v140, v141
v_max3_f32 v5, v5, v142, v143
v_mfma_f32_32x32x16_bf16 v[112:127], v[32:35], v[24:27], v[112:127]
v_max3_f32 v6, v6, v152, v153
v_max3_f32 v6, v6, v154, v155
v_max3_f32 v6, v6, v156, v157
v_max3_f32 v6, v6, v158, v159
ds_read_b128 v[76:79], v92 offset:6144
ds_read_b128 v[80:83], v92 offset:7168
s_waitcnt lgkmcnt(4)
v_mfma_f32_32x32x16_bf16 v[128:143], v[44:47], v[12:15], 0
v_max3_f32 v5, v5, v96, v97
v_max3_f32 v5, v5, v98, v99
v_max3_f32 v5, v5, v100, v101
v_max3_f32 v5, v5, v102, v103
v_mfma_f32_32x32x16_bf16 v[144:159], v[44:47], v[20:23], 0
v_max3_f32 v6, v6, v112, v113
v_max3_f32 v6, v6, v114, v115
v_max3_f32 v6, v6, v116, v117
v_max3_f32 v6, v6, v118, v119
v_mfma_f32_32x32x16_bf16 v[128:143], v[48:51], v[16:19], v[128:143]
v_max3_f32 v5, v5, v104, v105
v_max3_f32 v5, v5, v106, v107
v_max3_f32 v5, v5, v108, v109
v_max3_f32 v5, v5, v110, v111
v_mfma_f32_32x32x16_bf16 v[144:159], v[48:51], v[24:27], v[144:159]
v_max3_f32 v6, v6, v120, v121
v_max3_f32 v6, v6, v122, v123
v_max3_f32 v6, v6, v124, v125
v_max3_f32 v6, v6, v126, v127
ds_read_b128 v[28:31], v92 offset:8192
ds_read_b128 v[32:35], v92 offset:9216
s_waitcnt lgkmcnt(4)
v_mfma_f32_32x32x16_bf16 v[96:111], v[60:63], v[12:15], 0
v_max3_f32 v5, v5, v128, v129
v_max3_f32 v5, v5, v130, v131
v_max3_f32 v5, v5, v132, v133
v_max3_f32 v5, v5, v134, v135
v_mfma_f32_32x32x16_bf16 v[112:127], v[60:63], v[20:23], 0
v_max3_f32 v6, v6, v144, v145
v_max3_f32 v6, v6, v146, v147
v_max3_f32 v6, v6, v148, v149
v_max3_f32 v6, v6, v150, v151
v_mfma_f32_32x32x16_bf16 v[96:111], v[64:67], v[16:19], v[96:111]
v_max3_f32 v5, v5, v136, v137
v_max3_f32 v5, v5, v138, v139
v_max3_f32 v5, v5, v140, v141
v_max3_f32 v5, v5, v142, v143
v_mfma_f32_32x32x16_bf16 v[112:127], v[64:67], v[24:27], v[112:127]
v_max3_f32 v6, v6, v152, v153
v_max3_f32 v6, v6, v154, v155
v_max3_f32 v6, v6, v156, v157
v_max3_f32 v6, v6, v158, v159
ds_read_b128 v[44:47], v92 offset:10240
ds_read_b128 v[48:51], v92 offset:11264
s_waitcnt lgkmcnt(4)
v_mfma_f32_32x32x16_bf16 v[128:143], v[76:79], v[12:15], 0
v_max3_f32 v5, v5, v96, v97
v_max3_f32 v5, v5, v98, v99
v_max3_f32 v5, v5, v100, v101
v_max3_f32 v5, v5, v102, v103
v_mfma_f32_32x32x16_bf16 v[144:159], v[76:79], v[20:23], 0
v_max3_f32 v6, v6, v112, v113
v_max3_f32 v6, v6, v114, v115
v_max3_f32 v6, v6, v116, v117
v_max3_f32 v6, v6, v118, v119
v_mfma_f32_32x32x16_bf16 v[128:143], v[80:83], v[16:19], v[128:143]
v_max3_f32 v5, v5, v104, v105
v_max3_f32 v5, v5, v106, v107
v_max3_f32 v5, v5, v108, v109
v_max3_f32 v5, v5, v110, v111
v_mfma_f32_32x32x16_bf16 v[144:159], v[80:83], v[24:27], v[144:159]
v_max3_f32 v6, v6, v120, v121
v_max3_f32 v6, v6, v122, v123
v_max3_f32 v6, v6, v124, v125
v_max3_f32 v6, v6, v126, v127
v_add_u32 v92, 8192, v92
s_sub_u32 s69, s69, 1
s_cmp_lg_u32 s69, 0
s_cbranch_scc1 Lb_42
s_waitcnt lgkmcnt(0)
s_waitcnt vmcnt(0)
s_barrier
ds_read_b128 v[28:31], v92 offset:0
ds_read_b128 v[32:35], v92 offset:1024
ds_read_b128 v[44:47], v92 offset:2048
ds_read_b128 v[48:51], v92 offset:3072
s_mov_b32 s69, 4
Lb_43:
ds_read_b128 v[60:63], v92 offset:4096
ds_read_b128 v[64:67], v92 offset:5120
s_waitcnt lgkmcnt(4)
v_mfma_f32_32x32x16_bf16 v[96:111], v[28:31], v[12:15], 0
v_max3_f32 v5, v5, v128, v129
v_max3_f32 v5, v5, v130, v131
v_max3_f32 v5, v5, v132, v133
v_max3_f32 v5, v5, v134, v135
v_mfma_f32_32x32x16_bf16 v[112:127], v[28:31], v[20:23], 0
v_max3_f32 v6, v6, v144, v145
v_max3_f32 v6, v6, v146, v147
v_max3_f32 v6, v6, v148, v149
v_max3_f32 v6, v6, v150, v151
v_mfma_f32_32x32x16_bf16 v[96:111], v[32:35], v[16:19], v[96:111]
v_max3_f32 v5, v5, v136, v137
v_max3_f32 v5, v5, v138, v139
v_max3_f32 v5, v5, v140, v141
v_max3_f32 v5, v5, v142, v143
v_mfma_f32_32x32x16_bf16 v[112:127], v[32:35], v[24:27], v[112:127]
v_max3_f32 v6, v6, v152, v153
v_max3_f32 v6, v6, v154, v155
v_max3_f32 v6, v6, v156, v157
v_max3_f32 v6, v6, v158, v159
ds_read_b128 v[76:79], v92 offset:6144
ds_read_b128 v[80:83], v92 offset:7168
s_waitcnt lgkmcnt(4)
v_mfma_f32_32x32x16_bf16 v[128:143], v[44:47], v[12:15], 0
v_max3_f32 v5, v5, v96, v97
v_max3_f32 v5, v5, v98, v99
v_max3_f32 v5, v5, v100, v101
v_max3_f32 v5, v5, v102, v103
v_mfma_f32_32x32x16_bf16 v[144:159], v[44:47], v[20:23], 0
v_max3_f32 v6, v6, v112, v113
v_max3_f32 v6, v6, v114, v115
v_max3_f32 v6, v6, v116, v117
v_max3_f32 v6, v6, v118, v119
v_mfma_f32_32x32x16_bf16 v[128:143], v[48:51], v[16:19], v[128:143]
v_max3_f32 v5, v5, v104, v105
v_max3_f32 v5, v5, v106, v107
v_max3_f32 v5, v5, v108, v109
v_max3_f32 v5, v5, v110, v111
v_mfma_f32_32x32x16_bf16 v[144:159], v[48:51], v[24:27], v[144:159]
v_max3_f32 v6, v6, v120, v121
v_max3_f32 v6, v6, v122, v123
v_max3_f32 v6, v6, v124, v125
v_max3_f32 v6, v6, v126, v127
ds_read_b128 v[28:31], v92 offset:8192
ds_read_b128 v[32:35], v92 offset:9216
s_waitcnt lgkmcnt(4)
v_mfma_f32_32x32x16_bf16 v[96:111], v[60:63], v[12:15], 0
v_max3_f32 v5, v5, v128, v129
v_max3_f32 v5, v5, v130, v131
v_max3_f32 v5, v5, v132, v133
v_max3_f32 v5, v5, v134, v135
v_mfma_f32_32x32x16_bf16 v[112:127], v[60:63], v[20:23], 0
v_max3_f32 v6, v6, v144, v145
v_max3_f32 v6, v6, v146, v147
v_max3_f32 v6, v6, v148, v149
v_max3_f32 v6, v6, v150, v151
v_mfma_f32_32x32x16_bf16 v[96:111], v[64:67], v[16:19], v[96:111]
v_max3_f32 v5, v5, v136, v137
v_max3_f32 v5, v5, v138, v139
v_max3_f32 v5, v5, v140, v141
v_max3_f32 v5, v5, v142, v143
v_mfma_f32_32x32x16_bf16 v[112:127], v[64:67], v[24:27], v[112:127]
v_max3_f32 v6, v6, v152, v153
v_max3_f32 v6, v6, v154, v155
v_max3_f32 v6, v6, v156, v157
v_max3_f32 v6, v6, v158, v159
ds_read_b128 v[44:47], v92 offset:10240
ds_read_b128 v[48:51], v92 offset:11264
s_waitcnt lgkmcnt(4)
v_mfma_f32_32x32x16_bf16 v[128:143], v[76:79], v[12:15], 0
v_max3_f32 v5, v5, v96, v97
v_max3_f32 v5, v5, v98, v99
v_max3_f32 v5, v5, v100, v101
v_max3_f32 v5, v5, v102, v103
v_mfma_f32_32x32x16_bf16 v[144:159], v[76:79], v[20:23], 0
v_max3_f32 v6, v6, v112, v113
v_max3_f32 v6, v6, v114, v115
v_max3_f32 v6, v6, v116, v117
v_max3_f32 v6, v6, v118, v119
v_mfma_f32_32x32x16_bf16 v[128:143], v[80:83], v[16:19], v[128:143]
v_max3_f32 v5, v5, v104, v105
v_max3_f32 v5, v5, v106, v107
v_max3_f32 v5, v5, v108, v109
v_max3_f32 v5, v5, v110, v111
v_mfma_f32_32x32x16_bf16 v[144:159], v[80:83], v[24:27], v[144:159]
v_max3_f32 v6, v6, v120, v121
v_max3_f32 v6, v6, v122, v123
v_max3_f32 v6, v6, v124, v125
v_max3_f32 v6, v6, v126, v127
v_add_u32 v92, 8192, v92
s_sub_u32 s69, s69, 1
s_cmp_lg_u32 s69, 0
s_cbranch_scc1 Lb_43
s_waitcnt lgkmcnt(0)
s_mov_b32 s66, 63045632
v_mov_b32 v92, v1
s_nop 7
ds_read_b128 v[28:31], v92 offset:0
ds_read_b128 v[32:35], v92 offset:1024
buffer_load_dwordx4 v[36:39], v1, s[60:63], s66 offen offset:0
buffer_load_dwordx4 v[40:43], v1, s[60:63], s66 offen offset:1024
s_add_u32 s66, s66, 2048
ds_read_b128 v[44:47], v92 offset:2048
ds_read_b128 v[48:51], v92 offset:3072
buffer_load_dwordx4 v[52:55], v1, s[60:63], s66 offen offset:0
buffer_load_dwordx4 v[56:59], v1, s[60:63], s66 offen offset:1024
s_add_u32 s66, s66, 2048
ds_read_b128 v[60:63], v92 offset:4096
ds_read_b128 v[64:67], v92 offset:5120
buffer_load_dwordx4 v[68:71], v1, s[60:63], s66 offen offset:0
buffer_load_dwordx4 v[72:75], v1, s[60:63], s66 offen offset:1024
s_add_u32 s66, s66, 2048
v_max3_f32 v5, v5, v128, v129
v_max3_f32 v5, v5, v130, v131
v_max3_f32 v5, v5, v132, v133
v_max3_f32 v5, v5, v134, v135
v_max3_f32 v5, v5, v136, v137
v_max3_f32 v5, v5, v138, v139
v_max3_f32 v5, v5, v140, v141
v_max3_f32 v5, v5, v142, v143
v_mov_b32 v7, v5
s_nop 1
v_permlane32_swap_b32 v5, v7
v_max_f32 v7, v5, v7
v_sub_f32 v128, 0, v7
v_sub_f32 v129, 0, v7
v_sub_f32 v130, 0, v7
v_sub_f32 v131, 0, v7
v_sub_f32 v132, 0, v7
v_sub_f32 v133, 0, v7
v_sub_f32 v134, 0, v7
v_sub_f32 v135, 0, v7
v_sub_f32 v136, 0, v7
v_sub_f32 v137, 0, v7
v_sub_f32 v138, 0, v7
v_sub_f32 v139, 0, v7
v_sub_f32 v140, 0, v7
v_sub_f32 v141, 0, v7
v_sub_f32 v142, 0, v7
v_sub_f32 v143, 0, v7
v_max3_f32 v6, v6, v144, v145
v_max3_f32 v6, v6, v146, v147
v_max3_f32 v6, v6, v148, v149
v_max3_f32 v6, v6, v150, v151
v_max3_f32 v6, v6, v152, v153
v_max3_f32 v6, v6, v154, v155
v_max3_f32 v6, v6, v156, v157
v_max3_f32 v6, v6, v158, v159
v_mov_b32 v7, v6
s_nop 1
v_permlane32_swap_b32 v6, v7
v_max_f32 v7, v6, v7
v_sub_f32 v144, 0, v7
v_sub_f32 v145, 0, v7
v_sub_f32 v146, 0, v7
v_sub_f32 v147, 0, v7
v_sub_f32 v148, 0, v7
v_sub_f32 v149, 0, v7
v_sub_f32 v150, 0, v7
v_sub_f32 v151, 0, v7
v_sub_f32 v152, 0, v7
v_sub_f32 v153, 0, v7
v_sub_f32 v154, 0, v7
v_sub_f32 v155, 0, v7
v_sub_f32 v156, 0, v7
v_sub_f32 v157, 0, v7
v_sub_f32 v158, 0, v7
v_sub_f32 v159, 0, v7
v_accvgpr_write_b32 a0, 0
v_accvgpr_write_b32 a1, 0
v_accvgpr_write_b32 a2, 0
v_accvgpr_write_b32 a3, 0
v_accvgpr_write_b32 a4, 0
v_accvgpr_write_b32 a5, 0
v_accvgpr_write_b32 a6, 0
v_accvgpr_write_b32 a7, 0
v_accvgpr_write_b32 a8, 0
v_accvgpr_write_b32 a9, 0
v_accvgpr_write_b32 a10, 0
v_accvgpr_write_b32 a11, 0
v_accvgpr_write_b32 a12, 0
v_accvgpr_write_b32 a13, 0
v_accvgpr_write_b32 a14, 0
v_accvgpr_write_b32 a15, 0
v_accvgpr_write_b32 a16, 0
v_accvgpr_write_b32 a17, 0
v_accvgpr_write_b32 a18, 0
v_accvgpr_write_b32 a19, 0
v_accvgpr_write_b32 a20, 0
v_accvgpr_write_b32 a21, 0
v_accvgpr_write_b32 a22, 0
v_accvgpr_write_b32 a23, 0
v_accvgpr_write_b32 a24, 0
v_accvgpr_write_b32 a25, 0
v_accvgpr_write_b32 a26, 0
v_accvgpr_write_b32 a27, 0
v_accvgpr_write_b32 a28, 0
v_accvgpr_write_b32 a29, 0
v_accvgpr_write_b32 a30, 0
v_accvgpr_write_b32 a31, 0
v_accvgpr_write_b32 a32, 0
v_accvgpr_write_b32 a33, 0
v_accvgpr_write_b32 a34, 0
v_accvgpr_write_b32 a35, 0
v_accvgpr_write_b32 a36, 0
v_accvgpr_write_b32 a37, 0
v_accvgpr_write_b32 a38, 0
v_accvgpr_write_b32 a39, 0
v_accvgpr_write_b32 a40, 0
v_accvgpr_write_b32 a41, 0
v_accvgpr_write_b32 a42, 0
v_accvgpr_write_b32 a43, 0
v_accvgpr_write_b32 a44, 0
v_accvgpr_write_b32 a45, 0
v_accvgpr_write_b32 a46, 0
v_accvgpr_write_b32 a47, 0
v_accvgpr_write_b32 a48, 0
v_accvgpr_write_b32 a49, 0
v_accvgpr_write_b32 a50, 0
v_accvgpr_write_b32 a51, 0
v_accvgpr_write_b32 a52, 0
v_accvgpr_write_b32 a53, 0
v_accvgpr_write_b32 a54, 0
v_accvgpr_write_b32 a55, 0
v_accvgpr_write_b32 a56, 0
v_accvgpr_write_b32 a57, 0
v_accvgpr_write_b32 a58, 0
v_accvgpr_write_b32 a59, 0
v_accvgpr_write_b32 a60, 0
v_accvgpr_write_b32 a61, 0
v_accvgpr_write_b32 a62, 0
v_accvgpr_write_b32 a63, 0
v_mov_b32 v8, 0x3f803f80
v_mov_b32 v9, 0x3f803f80
v_mov_b32 v10, 0x3f803f80
v_mov_b32 v11, 0x3f803f80
v_mov_b32 v168, 0
v_mov_b32 v169, 0
v_mov_b32 v170, 0
v_mov_b32 v171, 0
v_mov_b32 v172, 0
v_mov_b32 v173, 0
v_mov_b32 v174, 0
v_mov_b32 v175, 0
s_waitcnt lgkmcnt(4)
v_mfma_f32_32x32x16_bf16 v[96:111], v[28:31], v[12:15], v[128:143]
v_mfma_f32_32x32x16_bf16 v[96:111], v[32:35], v[16:19], v[96:111]
v_mov_b32 v84, 0
v_mov_b32 v88, 0
v_mov_b32 v85, 0
v_mov_b32 v89, 0
v_mov_b32 v86, 0
v_mov_b32 v90, 0
v_mov_b32 v87, 0
v_mov_b32 v91, 0
s_mov_b32 s69, 16
s_nop 7
Lb_44:
v_mfma_f32_32x32x16_bf16 v[112:127], v[28:31], v[20:23], v[144:159]
v_exp_f32 v96, v96
v_exp_f32 v97, v97
v_exp_f32 v98, v98
v_mfma_f32_32x32x16_bf16 v[112:127], v[32:35], v[24:27], v[112:127]
v_exp_f32 v99, v99
v_exp_f32 v100, v100
v_exp_f32 v101, v101
v_mfma_f32_32x32x16_bf16 a[32:47], v[84:87], v[168:171], a[32:47]
v_exp_f32 v102, v102
v_exp_f32 v103, v103
v_exp_f32 v104, v104
v_mfma_f32_32x32x16_bf16 a[32:47], v[88:91], v[172:175], a[32:47]
v_exp_f32 v105, v105
v_exp_f32 v106, v106
v_exp_f32 v107, v107
v_mfma_f32_32x32x16_bf16 a[48:63], v[8:11], v[168:171], a[48:63]
v_exp_f32 v108, v108
v_exp_f32 v109, v109
v_exp_f32 v110, v110
v_exp_f32 v111, v111
v_mfma_f32_32x32x16_bf16 a[48:63], v[8:11], v[172:175], a[48:63]
v_cvt_pk_bf16_f32 v160, v96, v97
v_cvt_pk_bf16_f32 v161, v98, v99
v_cvt_pk_bf16_f32 v162, v100, v101
v_cvt_pk_bf16_f32 v163, v102, v103
v_cvt_pk_bf16_f32 v164, v104, v105
v_cvt_pk_bf16_f32 v165, v106, v107
v_cvt_pk_bf16_f32 v166, v108, v109
v_cvt_pk_bf16_f32 v167, v110, v111
ds_read_b128 v[76:79], v92 offset:6144
ds_read_b128 v[80:83], v92 offset:7168
buffer_load_dwordx4 v[84:87], v1, s[60:63], s66 offen offset:0
buffer_load_dwordx4 v[88:91], v1, s[60:63], s66 offen offset:1024
s_add_u32 s66, s66, 2048
s_waitcnt vmcnt(6) lgkmcnt(4)
v_mfma_f32_32x32x16_bf16 v[96:111], v[44:47], v[12:15], v[128:143]
v_exp_f32 v112, v112
v_exp_f32 v113, v113
v_exp_f32 v114, v114
v_mfma_f32_32x32x16_bf16 v[96:111], v[48:51], v[16:19], v[96:111]
v_exp_f32 v115, v115
v_exp_f32 v116, v116
v_exp_f32 v117, v117
v_mfma_f32_32x32x16_bf16 a[0:15], v[36:39], v[160:163], a[0:15]
v_exp_f32 v118, v118
v_exp_f32 v119, v119
v_exp_f32 v120, v120
v_mfma_f32_32x32x16_bf16 a[0:15], v[40:43], v[164:167], a[0:15]
v_exp_f32 v121, v121
v_exp_f32 v122, v122
v_exp_f32 v123, v123
v_mfma_f32_32x32x16_bf16 a[16:31], v[8:11], v[160:163], a[16:31]
v_exp_f32 v124, v124
v_exp_f32 v125, v125
v_exp_f32 v126, v126
v_exp_f32 v127, v127
v_mfma_f32_32x32x16_bf16 a[16:31], v[8:11], v[164:167], a[16:31]
v_cvt_pk_bf16_f32 v168, v112, v113
v_cvt_pk_bf16_f32 v169, v114, v115
v_cvt_pk_bf16_f32 v170, v116, v117
v_cvt_pk_bf16_f32 v171, v118, v119
v_cvt_pk_bf16_f32 v172, v120, v121
v_cvt_pk_bf16_f32 v173, v122, v123
v_cvt_pk_bf16_f32 v174, v124, v125
v_cvt_pk_bf16_f32 v175, v126, v127
v_mfma_f32_32x32x16_bf16 v[112:127], v[44:47], v[20:23], v[144:159]
v_exp_f32 v96, v96
v_exp_f32 v97, v97
v_exp_f32 v98, v98
v_mfma_f32_32x32x16_bf16 v[112:127], v[48:51], v[24:27], v[112:127]
v_exp_f32 v99, v99
v_exp_f32 v100, v100
v_exp_f32 v101, v101
v_mfma_f32_32x32x16_bf16 a[32:47], v[36:39], v[168:171], a[32:47]
v_exp_f32 v102, v102
v_exp_f32 v103, v103
v_exp_f32 v104, v104
v_mfma_f32_32x32x16_bf16 a[32:47], v[40:43], v[172:175], a[32:47]
v_exp_f32 v105, v105
v_exp_f32 v106, v106
v_exp_f32 v107, v107
v_mfma_f32_32x32x16_bf16 a[48:63], v[8:11], v[168:171], a[48:63]
v_exp_f32 v108, v108
v_exp_f32 v109, v109
v_exp_f32 v110, v110
v_exp_f32 v111, v111
v_mfma_f32_32x32x16_bf16 a[48:63], v[8:11], v[172:175], a[48:63]
v_cvt_pk_bf16_f32 v160, v96, v97
v_cvt_pk_bf16_f32 v161, v98, v99
v_cvt_pk_bf16_f32 v162, v100, v101
v_cvt_pk_bf16_f32 v163, v102, v103
v_cvt_pk_bf16_f32 v164, v104, v105
v_cvt_pk_bf16_f32 v165, v106, v107
v_cvt_pk_bf16_f32 v166, v108, v109
v_cvt_pk_bf16_f32 v167, v110, v111
ds_read_b128 v[28:31], v92 offset:8192
ds_read_b128 v[32:35], v92 offset:9216
buffer_load_dwordx4 v[36:39], v1, s[60:63], s66 offen offset:0
buffer_load_dwordx4 v[40:43], v1, s[60:63], s66 offen offset:1024
s_add_u32 s66, s66, 2048
s_waitcnt vmcnt(6) lgkmcnt(4)
v_mfma_f32_32x32x16_bf16 v[96:111], v[60:63], v[12:15], v[128:143]
v_exp_f32 v112, v112
v_exp_f32 v113, v113
v_exp_f32 v114, v114
v_mfma_f32_32x32x16_bf16 v[96:111], v[64:67], v[16:19], v[96:111]
v_exp_f32 v115, v115
v_exp_f32 v116, v116
v_exp_f32 v117, v117
v_mfma_f32_32x32x16_bf16 a[0:15], v[52:55], v[160:163], a[0:15]
v_exp_f32 v118, v118
v_exp_f32 v119, v119
v_exp_f32 v120, v120
v_mfma_f32_32x32x16_bf16 a[0:15], v[56:59], v[164:167], a[0:15]
v_exp_f32 v121, v121
v_exp_f32 v122, v122
v_exp_f32 v123, v123
v_mfma_f32_32x32x16_bf16 a[16:31], v[8:11], v[160:163], a[16:31]
v_exp_f32 v124, v124
v_exp_f32 v125, v125
v_exp_f32 v126, v126
v_exp_f32 v127, v127
v_mfma_f32_32x32x16_bf16 a[16:31], v[8:11], v[164:167], a[16:31]
v_cvt_pk_bf16_f32 v168, v112, v113
v_cvt_pk_bf16_f32 v169, v114, v115
v_cvt_pk_bf16_f32 v170, v116, v117
v_cvt_pk_bf16_f32 v171, v118, v119
v_cvt_pk_bf16_f32 v172, v120, v121
v_cvt_pk_bf16_f32 v173, v122, v123
v_cvt_pk_bf16_f32 v174, v124, v125
v_cvt_pk_bf16_f32 v175, v126, v127
v_mfma_f32_32x32x16_bf16 v[112:127], v[60:63], v[20:23], v[144:159]
v_exp_f32 v96, v96
v_exp_f32 v97, v97
v_exp_f32 v98, v98
v_mfma_f32_32x32x16_bf16 v[112:127], v[64:67], v[24:27], v[112:127]
v_exp_f32 v99, v99
v_exp_f32 v100, v100
v_exp_f32 v101, v101
v_mfma_f32_32x32x16_bf16 a[32:47], v[52:55], v[168:171], a[32:47]
v_exp_f32 v102, v102
v_exp_f32 v103, v103
v_exp_f32 v104, v104
v_mfma_f32_32x32x16_bf16 a[32:47], v[56:59], v[172:175], a[32:47]
v_exp_f32 v105, v105
v_exp_f32 v106, v106
v_exp_f32 v107, v107
v_mfma_f32_32x32x16_bf16 a[48:63], v[8:11], v[168:171], a[48:63]
v_exp_f32 v108, v108
v_exp_f32 v109, v109
v_exp_f32 v110, v110
v_exp_f32 v111, v111
v_mfma_f32_32x32x16_bf16 a[48:63], v[8:11], v[172:175], a[48:63]
v_cvt_pk_bf16_f32 v160, v96, v97
v_cvt_pk_bf16_f32 v161, v98, v99
v_cvt_pk_bf16_f32 v162, v100, v101
v_cvt_pk_bf16_f32 v163, v102, v103
v_cvt_pk_bf16_f32 v164, v104, v105
v_cvt_pk_bf16_f32 v165, v106, v107
v_cvt_pk_bf16_f32 v166, v108, v109
v_cvt_pk_bf16_f32 v167, v110, v111
ds_read_b128 v[44:47], v92 offset:10240
ds_read_b128 v[48:51], v92 offset:11264
buffer_load_dwordx4 v[52:55], v1, s[60:63], s66 offen offset:0
buffer_load_dwordx4 v[56:59], v1, s[60:63], s66 offen offset:1024
s_add_u32 s66, s66, 2048
s_waitcnt vmcnt(6) lgkmcnt(4)
v_mfma_f32_32x32x16_bf16 v[96:111], v[76:79], v[12:15], v[128:143]
v_exp_f32 v112, v112
v_exp_f32 v113, v113
v_exp_f32 v114, v114
v_mfma_f32_32x32x16_bf16 v[96:111], v[80:83], v[16:19], v[96:111]
v_exp_f32 v115, v115
v_exp_f32 v116, v116
v_exp_f32 v117, v117
v_mfma_f32_32x32x16_bf16 a[0:15], v[68:71], v[160:163], a[0:15]
v_exp_f32 v118, v118
v_exp_f32 v119, v119
v_exp_f32 v120, v120
v_mfma_f32_32x32x16_bf16 a[0:15], v[72:75], v[164:167], a[0:15]
v_exp_f32 v121, v121
v_exp_f32 v122, v122
v_exp_f32 v123, v123
v_mfma_f32_32x32x16_bf16 a[16:31], v[8:11], v[160:163], a[16:31]
v_exp_f32 v124, v124
v_exp_f32 v125, v125
v_exp_f32 v126, v126
v_exp_f32 v127, v127
v_mfma_f32_32x32x16_bf16 a[16:31], v[8:11], v[164:167], a[16:31]
v_cvt_pk_bf16_f32 v168, v112, v113
v_cvt_pk_bf16_f32 v169, v114, v115
v_cvt_pk_bf16_f32 v170, v116, v117
v_cvt_pk_bf16_f32 v171, v118, v119
v_cvt_pk_bf16_f32 v172, v120, v121
v_cvt_pk_bf16_f32 v173, v122, v123
v_cvt_pk_bf16_f32 v174, v124, v125
v_cvt_pk_bf16_f32 v175, v126, v127
v_mfma_f32_32x32x16_bf16 v[112:127], v[76:79], v[20:23], v[144:159]
v_exp_f32 v96, v96
v_exp_f32 v97, v97
v_exp_f32 v98, v98
v_mfma_f32_32x32x16_bf16 v[112:127], v[80:83], v[24:27], v[112:127]
v_exp_f32 v99, v99
v_exp_f32 v100, v100
v_exp_f32 v101, v101
v_mfma_f32_32x32x16_bf16 a[32:47], v[68:71], v[168:171], a[32:47]
v_exp_f32 v102, v102
v_exp_f32 v103, v103
v_exp_f32 v104, v104
v_mfma_f32_32x32x16_bf16 a[32:47], v[72:75], v[172:175], a[32:47]
v_exp_f32 v105, v105
v_exp_f32 v106, v106
v_exp_f32 v107, v107
v_mfma_f32_32x32x16_bf16 a[48:63], v[8:11], v[168:171], a[48:63]
v_exp_f32 v108, v108
v_exp_f32 v109, v109
v_exp_f32 v110, v110
v_exp_f32 v111, v111
v_mfma_f32_32x32x16_bf16 a[48:63], v[8:11], v[172:175], a[48:63]
v_cvt_pk_bf16_f32 v160, v96, v97
v_cvt_pk_bf16_f32 v161, v98, v99
v_cvt_pk_bf16_f32 v162, v100, v101
v_cvt_pk_bf16_f32 v163, v102, v103
v_cvt_pk_bf16_f32 v164, v104, v105
v_cvt_pk_bf16_f32 v165, v106, v107
v_cvt_pk_bf16_f32 v166, v108, v109
v_cvt_pk_bf16_f32 v167, v110, v111
ds_read_b128 v[60:63], v92 offset:12288
ds_read_b128 v[64:67], v92 offset:13312
buffer_load_dwordx4 v[68:71], v1, s[60:63], s66 offen offset:0
buffer_load_dwordx4 v[72:75], v1, s[60:63], s66 offen offset:1024
s_add_u32 s66, s66, 2048
s_waitcnt vmcnt(6) lgkmcnt(4)
v_mfma_f32_32x32x16_bf16 v[96:111], v[28:31], v[12:15], v[128:143]
v_exp_f32 v112, v112
v_exp_f32 v113, v113
v_exp_f32 v114, v114
v_mfma_f32_32x32x16_bf16 v[96:111], v[32:35], v[16:19], v[96:111]
v_exp_f32 v115, v115
v_exp_f32 v116, v116
v_exp_f32 v117, v117
v_mfma_f32_32x32x16_bf16 a[0:15], v[84:87], v[160:163], a[0:15]
v_exp_f32 v118, v118
v_exp_f32 v119, v119
v_exp_f32 v120, v120
v_mfma_f32_32x32x16_bf16 a[0:15], v[88:91], v[164:167], a[0:15]
v_exp_f32 v121, v121
v_exp_f32 v122, v122
v_exp_f32 v123, v123
v_mfma_f32_32x32x16_bf16 a[16:31], v[8:11], v[160:163], a[16:31]
v_exp_f32 v124, v124
v_exp_f32 v125, v125
v_exp_f32 v126, v126
v_exp_f32 v127, v127
v_mfma_f32_32x32x16_bf16 a[16:31], v[8:11], v[164:167], a[16:31]
v_cvt_pk_bf16_f32 v168, v112, v113
v_cvt_pk_bf16_f32 v169, v114, v115
v_cvt_pk_bf16_f32 v170, v116, v117
v_cvt_pk_bf16_f32 v171, v118, v119
v_cvt_pk_bf16_f32 v172, v120, v121
v_cvt_pk_bf16_f32 v173, v122, v123
v_cvt_pk_bf16_f32 v174, v124, v125
v_cvt_pk_bf16_f32 v175, v126, v127
v_add_u32 v92, 8192, v92
s_sub_u32 s69, s69, 1
s_cmp_lg_u32 s69, 0
s_cbranch_scc1 Lb_44
s_nop 1
v_mfma_f32_32x32x16_bf16 a[32:47], v[84:87], v[168:171], a[32:47]
v_mfma_f32_32x32x16_bf16 a[32:47], v[88:91], v[172:175], a[32:47]
v_mfma_f32_32x32x16_bf16 a[48:63], v[8:11], v[168:171], a[48:63]
v_mfma_f32_32x32x16_bf16 a[48:63], v[8:11], v[172:175], a[48:63]
v_sub_f32 v4, 1.0, v4
v_mul_u32_u24 v2, 10240, v2
v_lshrrev_b32 v3, 5, v0
v_lshl_add_u32 v2, v3, 4, v2
s_mul_i32 s71, s85, 327680
s_lshl_b32 s72, s86, 2
s_add_u32 s72, s72, s65
s_lshl_b32 s72, s72, 7
s_add_u32 s71, s71, s72
s_add_u32 s71, s71, 67117056
s_waitcnt vmcnt(0)
s_nop 7
v_accvgpr_read_b32 v6, a16
s_nop 0
v_rcp_f32 v6, v6
s_nop 0
v_mul_f32 v6, v6, v4
v_mov_b32 v7, v6
v_accvgpr_read_b32 v120, a0
v_accvgpr_read_b32 v121, a1
v_accvgpr_read_b32 v122, a2
v_accvgpr_read_b32 v123, a3
v_accvgpr_read_b32 v124, a4
v_accvgpr_read_b32 v125, a5
v_accvgpr_read_b32 v126, a6
v_accvgpr_read_b32 v127, a7
v_accvgpr_read_b32 v128, a8
v_accvgpr_read_b32 v129, a9
v_accvgpr_read_b32 v130, a10
v_accvgpr_read_b32 v131, a11
v_accvgpr_read_b32 v132, a12
v_accvgpr_read_b32 v133, a13
v_accvgpr_read_b32 v134, a14
v_accvgpr_read_b32 v135, a15
v_pk_mul_f32 v[120:121], v[120:121], v[6:7]
v_pk_mul_f32 v[122:123], v[122:123], v[6:7]
v_pk_mul_f32 v[124:125], v[124:125], v[6:7]
v_pk_mul_f32 v[126:127], v[126:127], v[6:7]
v_pk_mul_f32 v[128:129], v[128:129], v[6:7]
v_pk_mul_f32 v[130:131], v[130:131], v[6:7]
v_pk_mul_f32 v[132:133], v[132:133], v[6:7]
v_pk_mul_f32 v[134:135], v[134:135], v[6:7]
v_cvt_pk_bf16_f32 v112, v120, v121
v_cvt_pk_bf16_f32 v113, v122, v123
v_cvt_pk_bf16_f32 v114, v124, v125
v_cvt_pk_bf16_f32 v115, v126, v127
v_cvt_pk_bf16_f32 v116, v128, v129
v_cvt_pk_bf16_f32 v117, v130, v131
v_cvt_pk_bf16_f32 v118, v132, v133
v_cvt_pk_bf16_f32 v119, v134, v135
s_nop 1
v_permlane32_swap_b32 v112, v114
v_permlane32_swap_b32 v113, v115
v_permlane32_swap_b32 v116, v118
v_permlane32_swap_b32 v117, v119
buffer_store_dwordx4 v[112:115], v2, s[60:63], s71 offen offset:0 sc1
buffer_store_dwordx4 v[116:119], v2, s[60:63], s71 offen offset:32 sc1
v_accvgpr_read_b32 v6, a48
s_nop 0
v_rcp_f32 v6, v6
s_nop 0
v_mul_f32 v6, v6, v4
v_mov_b32 v7, v6
v_accvgpr_read_b32 v144, a32
v_accvgpr_read_b32 v145, a33
v_accvgpr_read_b32 v146, a34
v_accvgpr_read_b32 v147, a35
v_accvgpr_read_b32 v148, a36
v_accvgpr_read_b32 v149, a37
v_accvgpr_read_b32 v150, a38
v_accvgpr_read_b32 v151, a39
v_accvgpr_read_b32 v152, a40
v_accvgpr_read_b32 v153, a41
v_accvgpr_read_b32 v154, a42
v_accvgpr_read_b32 v155, a43
v_accvgpr_read_b32 v156, a44
v_accvgpr_read_b32 v157, a45
v_accvgpr_read_b32 v158, a46
v_accvgpr_read_b32 v159, a47
v_pk_mul_f32 v[144:145], v[144:145], v[6:7]
v_pk_mul_f32 v[146:147], v[146:147], v[6:7]
v_pk_mul_f32 v[148:149], v[148:149], v[6:7]
v_pk_mul_f32 v[150:151], v[150:151], v[6:7]
v_pk_mul_f32 v[152:153], v[152:153], v[6:7]
v_pk_mul_f32 v[154:155], v[154:155], v[6:7]
v_pk_mul_f32 v[156:157], v[156:157], v[6:7]
v_pk_mul_f32 v[158:159], v[158:159], v[6:7]
v_cvt_pk_bf16_f32 v136, v144, v145
v_cvt_pk_bf16_f32 v137, v146, v147
v_cvt_pk_bf16_f32 v138, v148, v149
v_cvt_pk_bf16_f32 v139, v150, v151
v_cvt_pk_bf16_f32 v140, v152, v153
v_cvt_pk_bf16_f32 v141, v154, v155
v_cvt_pk_bf16_f32 v142, v156, v157
v_cvt_pk_bf16_f32 v143, v158, v159
s_nop 1
v_permlane32_swap_b32 v136, v138
v_permlane32_swap_b32 v137, v139
v_permlane32_swap_b32 v140, v142
v_permlane32_swap_b32 v141, v143
buffer_store_dwordx4 v[136:139], v2, s[60:63], s71 offen offset:64 sc1
buffer_store_dwordx4 v[140:143], v2, s[60:63], s71 offen offset:96 sc1
s_lshl_b32 s84, s85, 2
s_add_u32 s84, s84, 63243264
s_waitcnt vmcnt(0)
s_barrier
s_cmp_lg_u32 s65, 0
s_cbranch_scc1 Lsg_45
v_mov_b32 v9, 0
v_mov_b32 v10, 1
s_mov_b64 exec, 1
buffer_atomic_add v10, v9, s[60:63], s84 offen sc1
s_mov_b64 exec, -1
Lsg_45:
L_next:
s_cmp_ge_u32 s76, 192
s_cbranch_scc1 L_nogate
v_lshlrev_b32 v1, 4, v0
buffer_load_dwordx4 v[12:15], v1, s[48:51], 0 offen
buffer_load_dwordx4 v[16:19], v1, s[48:51], 0 offen offset:1024
s_lshl_b32 s71, s76, 2
s_add_u32 s71, s71, s65
s_add_u32 s72, s71, 0
s_lshl_b32 s72, s72, 11
buffer_load_dwordx4 v[20:23], v1, s[8:11], s72 offen
buffer_load_dwordx4 v[24:27], v1, s[8:11], s72 offen offset:1024
s_add_u32 s72, s71, 768
s_lshl_b32 s72, s72, 11
buffer_load_dwordx4 v[28:31], v1, s[8:11], s72 offen
buffer_load_dwordx4 v[32:35], v1, s[8:11], s72 offen offset:1024
s_add_u32 s72, s71, 1536
s_lshl_b32 s72, s72, 11
buffer_load_dwordx4 v[36:39], v1, s[8:11], s72 offen
buffer_load_dwordx4 v[40:43], v1, s[8:11], s72 offen offset:1024
s_waitcnt vmcnt(0)
v_lshlrev_b32 v44, 16, v12
v_and_b32 v45, 0xffff0000, v12
v_lshlrev_b32 v46, 16, v13
v_and_b32 v47, 0xffff0000, v13
v_lshlrev_b32 v48, 16, v14
v_and_b32 v49, 0xffff0000, v14
v_lshlrev_b32 v50, 16, v15
v_and_b32 v51, 0xffff0000, v15
v_lshlrev_b32 v52, 16, v16
v_and_b32 v53, 0xffff0000, v16
v_lshlrev_b32 v54, 16, v17
v_and_b32 v55, 0xffff0000, v17
v_lshlrev_b32 v56, 16, v18
v_and_b32 v57, 0xffff0000, v18
v_lshlrev_b32 v58, 16, v19
v_and_b32 v59, 0xffff0000, v19
v_mov_b32 v2, 0
v_lshlrev_b32 v3, 16, v20
v_and_b32 v4, 0xffff0000, v20
v_fmac_f32 v2, v3, v44
v_fmac_f32 v2, v4, v45
v_lshlrev_b32 v3, 16, v21
v_and_b32 v4, 0xffff0000, v21
v_fmac_f32 v2, v3, v46
v_fmac_f32 v2, v4, v47
v_lshlrev_b32 v3, 16, v22
v_and_b32 v4, 0xffff0000, v22
v_fmac_f32 v2, v3, v48
v_fmac_f32 v2, v4, v49
v_lshlrev_b32 v3, 16, v23
v_and_b32 v4, 0xffff0000, v23
v_fmac_f32 v2, v3, v50
v_fmac_f32 v2, v4, v51
v_lshlrev_b32 v3, 16, v24
v_and_b32 v4, 0xffff0000, v24
v_fmac_f32 v2, v3, v52
v_fmac_f32 v2, v4, v53
v_lshlrev_b32 v3, 16, v25
v_and_b32 v4, 0xffff0000, v25
v_fmac_f32 v2, v3, v54
v_fmac_f32 v2, v4, v55
v_lshlrev_b32 v3, 16, v26
v_and_b32 v4, 0xffff0000, v26
v_fmac_f32 v2, v3, v56
v_fmac_f32 v2, v4, v57
v_lshlrev_b32 v3, 16, v27
v_and_b32 v4, 0xffff0000, v27
v_fmac_f32 v2, v3, v58
v_fmac_f32 v2, v4, v59
s_nop 1
v_add_f32_dpp v2, v2, v2 row_ror:1 row_mask:0xf bank_mask:0xf
s_nop 1
v_add_f32_dpp v2, v2, v2 row_ror:2 row_mask:0xf bank_mask:0xf
s_nop 1
v_add_f32_dpp v2, v2, v2 row_ror:4 row_mask:0xf bank_mask:0xf
s_nop 1
v_add_f32_dpp v2, v2, v2 row_ror:8 row_mask:0xf bank_mask:0xf
v_mov_b32 v3, v2
s_nop 1
v_permlane16_swap_b32 v2, v3
v_add_f32 v2, v2, v3
v_mov_b32 v3, v2
s_nop 1
v_permlane32_swap_b32 v2, v3
v_add_f32 v2, v2, v3
v_mul_f32 v2, 0xbfb8aa3b, v2
v_exp_f32 v2, v2
s_add_u32 s72, s71, 0
v_add_f32 v2, 1.0, v2
v_rcp_f32 v2, v2
s_cmp_lt_u32 s72, 2048
s_cselect_b32 s72, s72, 0x4000000
s_lshl_b32 s72, s72, 2
s_add_u32 s72, s72, 63176704
v_mov_b32 v3, 0
s_mov_b64 exec, 1
buffer_store_dword v2, v3, s[60:63], s72 offen sc1
s_mov_b64 exec, -1
v_mov_b32 v2, 0
v_lshlrev_b32 v3, 16, v28
v_and_b32 v4, 0xffff0000, v28
v_fmac_f32 v2, v3, v44
v_fmac_f32 v2, v4, v45
v_lshlrev_b32 v3, 16, v29
v_and_b32 v4, 0xffff0000, v29
v_fmac_f32 v2, v3, v46
v_fmac_f32 v2, v4, v47
v_lshlrev_b32 v3, 16, v30
v_and_b32 v4, 0xffff0000, v30
v_fmac_f32 v2, v3, v48
v_fmac_f32 v2, v4, v49
v_lshlrev_b32 v3, 16, v31
v_and_b32 v4, 0xffff0000, v31
v_fmac_f32 v2, v3, v50
v_fmac_f32 v2, v4, v51
v_lshlrev_b32 v3, 16, v32
v_and_b32 v4, 0xffff0000, v32
v_fmac_f32 v2, v3, v52
v_fmac_f32 v2, v4, v53
v_lshlrev_b32 v3, 16, v33
v_and_b32 v4, 0xffff0000, v33
v_fmac_f32 v2, v3, v54
v_fmac_f32 v2, v4, v55
v_lshlrev_b32 v3, 16, v34
v_and_b32 v4, 0xffff0000, v34
v_fmac_f32 v2, v3, v56
v_fmac_f32 v2, v4, v57
v_lshlrev_b32 v3, 16, v35
v_and_b32 v4, 0xffff0000, v35
v_fmac_f32 v2, v3, v58
v_fmac_f32 v2, v4, v59
s_nop 1
v_add_f32_dpp v2, v2, v2 row_ror:1 row_mask:0xf bank_mask:0xf
s_nop 1
v_add_f32_dpp v2, v2, v2 row_ror:2 row_mask:0xf bank_mask:0xf
s_nop 1
v_add_f32_dpp v2, v2, v2 row_ror:4 row_mask:0xf bank_mask:0xf
s_nop 1
v_add_f32_dpp v2, v2, v2 row_ror:8 row_mask:0xf bank_mask:0xf
v_mov_b32 v3, v2
s_nop 1
v_permlane16_swap_b32 v2, v3
v_add_f32 v2, v2, v3
v_mov_b32 v3, v2
s_nop 1
v_permlane32_swap_b32 v2, v3
v_add_f32 v2, v2, v3
v_mul_f32 v2, 0xbfb8aa3b, v2
v_exp_f32 v2, v2
s_add_u32 s72, s71, 768
v_add_f32 v2, 1.0, v2
v_rcp_f32 v2, v2
s_cmp_lt_u32 s72, 2048
s_cselect_b32 s72, s72, 0x4000000
s_lshl_b32 s72, s72, 2
s_add_u32 s72, s72, 63176704
v_mov_b32 v3, 0
s_mov_b64 exec, 1
buffer_store_dword v2, v3, s[60:63], s72 offen sc1
s_mov_b64 exec, -1
v_mov_b32 v2, 0
v_lshlrev_b32 v3, 16, v36
v_and_b32 v4, 0xffff0000, v36
v_fmac_f32 v2, v3, v44
v_fmac_f32 v2, v4, v45
v_lshlrev_b32 v3, 16, v37
v_and_b32 v4, 0xffff0000, v37
v_fmac_f32 v2, v3, v46
v_fmac_f32 v2, v4, v47
v_lshlrev_b32 v3, 16, v38
v_and_b32 v4, 0xffff0000, v38
v_fmac_f32 v2, v3, v48
v_fmac_f32 v2, v4, v49
v_lshlrev_b32 v3, 16, v39
v_and_b32 v4, 0xffff0000, v39
v_fmac_f32 v2, v3, v50
v_fmac_f32 v2, v4, v51
v_lshlrev_b32 v3, 16, v40
v_and_b32 v4, 0xffff0000, v40
v_fmac_f32 v2, v3, v52
v_fmac_f32 v2, v4, v53
v_lshlrev_b32 v3, 16, v41
v_and_b32 v4, 0xffff0000, v41
v_fmac_f32 v2, v3, v54
v_fmac_f32 v2, v4, v55
v_lshlrev_b32 v3, 16, v42
v_and_b32 v4, 0xffff0000, v42
v_fmac_f32 v2, v3, v56
v_fmac_f32 v2, v4, v57
v_lshlrev_b32 v3, 16, v43
v_and_b32 v4, 0xffff0000, v43
v_fmac_f32 v2, v3, v58
v_fmac_f32 v2, v4, v59
s_nop 1
v_add_f32_dpp v2, v2, v2 row_ror:1 row_mask:0xf bank_mask:0xf
s_nop 1
v_add_f32_dpp v2, v2, v2 row_ror:2 row_mask:0xf bank_mask:0xf
s_nop 1
v_add_f32_dpp v2, v2, v2 row_ror:4 row_mask:0xf bank_mask:0xf
s_nop 1
v_add_f32_dpp v2, v2, v2 row_ror:8 row_mask:0xf bank_mask:0xf
v_mov_b32 v3, v2
s_nop 1
v_permlane16_swap_b32 v2, v3
v_add_f32 v2, v2, v3
v_mov_b32 v3, v2
s_nop 1
v_permlane32_swap_b32 v2, v3
v_add_f32 v2, v2, v3
v_mul_f32 v2, 0xbfb8aa3b, v2
v_exp_f32 v2, v2
s_add_u32 s72, s71, 1536
v_add_f32 v2, 1.0, v2
v_rcp_f32 v2, v2
s_cmp_lt_u32 s72, 2048
s_cselect_b32 s72, s72, 0x4000000
s_lshl_b32 s72, s72, 2
s_add_u32 s72, s72, 63176704
v_mov_b32 v3, 0
s_mov_b64 exec, 1
buffer_store_dword v2, v3, s[60:63], s72 offen sc1
s_mov_b64 exec, -1
s_cmp_lg_u32 s76, 0
s_cbranch_scc1 L_nozero
s_lshl_b32 s71, s65, 10
s_add_u32 s71, s71, 63242240
v_mov_b32 v8, 0
v_mov_b32 v9, 0
v_mov_b32 v10, 0
v_mov_b32 v11, 0
buffer_store_dwordx4 v[8:11], v1, s[60:63], s71 offen sc1
L_nozero:
s_mov_b32 s84, 96
s_waitcnt vmcnt(0)
s_barrier
s_cmp_lg_u32 s65, 0
s_cbranch_scc1 Lsg_46
v_mov_b32 v9, 0
v_mov_b32 v10, 1
s_mov_b64 exec, 1
buffer_atomic_add v10, v9, s[56:59], s84 offen sc1
s_mov_b64 exec, -1
Lsg_46:
L_nogate:
s_add_u32 s76, s76, 192
s_branch L_task
L_stream:
s_sub_u32 s71, s64, 64
s_lshr_b32 s66, s71, 5
s_and_b32 s68, s71, 3
s_bfe_u32 s69, s71, 0x30002
s_lshl_b32 s67, s69, 2
s_add_u32 s67, s67, s65
v_mov_b32 v188, 0
v_lshlrev_b32 v189, 4, v0
v_lshrrev_b32 v1, 5, v0
v_and_b32 v2, 31, v0
v_lshlrev_b32 v2, 4, v2
v_lshl_add_u32 v1, v1, 11, v2
v_lshrrev_b32 v2, 2, v0
v_and_b32 v3, 3, v0
v_lshlrev_b32 v3, 3, v3
v_lshl_add_u32 v2, v2, 9, v3
s_barrier
s_mul_i32 s81, s65, 40960
v_add_u32 v2, s81, v2
s_lshl_b32 s80, s67, 18
s_lshl_b32 s82, s68, 9
s_add_u32 s80, s80, s82
s_add_u32 m0, s81, 0
s_nop 0
buffer_load_dwordx4 v1, s[28:31], s80 offen lds
s_add_u32 m0, m0, 1024
s_add_u32 s80, s80, 4096
buffer_load_dwordx4 v1, s[28:31], s80 offen lds
s_add_u32 m0, m0, 1024
s_add_u32 s80, s80, 4096
buffer_load_dwordx4 v1, s[28:31], s80 offen lds
s_add_u32 m0, m0, 1024
s_add_u32 s80, s80, 4096
buffer_load_dwordx4 v1, s[28:31], s80 offen lds
s_add_u32 m0, m0, 1024
s_add_u32 s80, s80, 4096
buffer_load_dwordx4 v1, s[28:31], s80 offen lds
s_add_u32 m0, m0, 1024
s_add_u32 s80, s80, 4096
buffer_load_dwordx4 v1, s[28:31], s80 offen lds
s_add_u32 m0, m0, 1024
s_add_u32 s80, s80, 4096
buffer_load_dwordx4 v1, s[28:31], s80 offen lds
s_add_u32 m0, m0, 1024
s_add_u32 s80, s80, 4096
buffer_load_dwordx4 v1, s[28:31], s80 offen lds
s_add_u32 m0, m0, 1024
s_add_u32 s80, s80, 4096
s_add_u32 m0, s81, 8192
s_nop 0
buffer_load_dwordx4 v1, s[28:31], s80 offen lds
s_add_u32 m0, m0, 1024
s_add_u32 s80, s80, 4096
buffer_load_dwordx4 v1, s[28:31], s80 offen lds
s_add_u32 m0, m0, 1024
s_add_u32 s80, s80, 4096
buffer_load_dwordx4 v1, s[28:31], s80 offen lds
s_add_u32 m0, m0, 1024
s_add_u32 s80, s80, 4096
buffer_load_dwordx4 v1, s[28:31], s80 offen lds
s_add_u32 m0, m0, 1024
s_add_u32 s80, s80, 4096
buffer_load_dwordx4 v1, s[28:31], s80 offen lds
s_add_u32 m0, m0, 1024
s_add_u32 s80, s80, 4096
buffer_load_dwordx4 v1, s[28:31], s80 offen lds
s_add_u32 m0, m0, 1024
s_add_u32 s80, s80, 4096
buffer_load_dwordx4 v1, s[28:31], s80 offen lds
s_add_u32 m0, m0, 1024
s_add_u32 s80, s80, 4096
buffer_load_dwordx4 v1, s[28:31], s80 offen lds
s_add_u32 m0, m0, 1024
s_add_u32 s80, s80, 4096
s_add_u32 m0, s81, 16384
s_nop 0
buffer_load_dwordx4 v1, s[28:31], s80 offen lds
s_add_u32 m0, m0, 1024
s_add_u32 s80, s80, 4096
buffer_load_dwordx4 v1, s[28:31], s80 offen lds
s_add_u32 m0, m0, 1024
s_add_u32 s80, s80, 4096
buffer_load_dwordx4 v1, s[28:31], s80 offen lds
s_add_u32 m0, m0, 1024
s_add_u32 s80, s80, 4096
buffer_load_dwordx4 v1, s[28:31], s80 offen lds
s_add_u32 m0, m0, 1024
s_add_u32 s80, s80, 4096
buffer_load_dwordx4 v1, s[28:31], s80 offen lds
s_add_u32 m0, m0, 1024
s_add_u32 s80, s80, 4096
buffer_load_dwordx4 v1, s[28:31], s80 offen lds
s_add_u32 m0, m0, 1024
s_add_u32 s80, s80, 4096
buffer_load_dwordx4 v1, s[28:31], s80 offen lds
s_add_u32 m0, m0, 1024
s_add_u32 s80, s80, 4096
buffer_load_dwordx4 v1, s[28:31], s80 offen lds
s_add_u32 m0, m0, 1024
s_add_u32 s80, s80, 4096
s_add_u32 m0, s81, 24576
s_nop 0
buffer_load_dwordx4 v1, s[28:31], s80 offen lds
s_add_u32 m0, m0, 1024
s_add_u32 s80, s80, 4096
buffer_load_dwordx4 v1, s[28:31], s80 offen lds
s_add_u32 m0, m0, 1024
s_add_u32 s80, s80, 4096
buffer_load_dwordx4 v1, s[28:31], s80 offen lds
s_add_u32 m0, m0, 1024
s_add_u32 s80, s80, 4096
buffer_load_dwordx4 v1, s[28:31], s80 offen lds
s_add_u32 m0, m0, 1024
s_add_u32 s80, s80, 4096
buffer_load_dwordx4 v1, s[28:31], s80 offen lds
s_add_u32 m0, m0, 1024
s_add_u32 s80, s80, 4096
buffer_load_dwordx4 v1, s[28:31], s80 offen lds
s_add_u32 m0, m0, 1024
s_add_u32 s80, s80, 4096
buffer_load_dwordx4 v1, s[28:31], s80 offen lds
s_add_u32 m0, m0, 1024
s_add_u32 s80, s80, 4096
buffer_load_dwordx4 v1, s[28:31], s80 offen lds
s_add_u32 m0, m0, 1024
s_add_u32 s80, s80, 4096
s_add_u32 m0, s81, 32768
s_nop 0
buffer_load_dwordx4 v1, s[28:31], s80 offen lds
s_add_u32 m0, m0, 1024
s_add_u32 s80, s80, 4096
buffer_load_dwordx4 v1, s[28:31], s80 offen lds
s_add_u32 m0, m0, 1024
s_add_u32 s80, s80, 4096
buffer_load_dwordx4 v1, s[28:31], s80 offen lds
s_add_u32 m0, m0, 1024
s_add_u32 s80, s80, 4096
buffer_load_dwordx4 v1, s[28:31], s80 offen lds
s_add_u32 m0, m0, 1024
s_add_u32 s80, s80, 4096
buffer_load_dwordx4 v1, s[28:31], s80 offen lds
s_add_u32 m0, m0, 1024
s_add_u32 s80, s80, 4096
buffer_load_dwordx4 v1, s[28:31], s80 offen lds
s_add_u32 m0, m0, 1024
s_add_u32 s80, s80, 4096
buffer_load_dwordx4 v1, s[28:31], s80 offen lds
s_add_u32 m0, m0, 1024
s_add_u32 s80, s80, 4096
buffer_load_dwordx4 v1, s[28:31], s80 offen lds
s_add_u32 m0, m0, 1024
s_add_u32 s80, s80, 4096
s_waitcnt vmcnt(32)
ds_read_b64_tr_b16 a[0:1], v2 offset:0
ds_read_b64_tr_b16 a[16:17], v2 offset:32
ds_read_b64_tr_b16 a[32:33], v2 offset:64
ds_read_b64_tr_b16 a[48:49], v2 offset:96
ds_read_b64_tr_b16 a[64:65], v2 offset:128
ds_read_b64_tr_b16 a[80:81], v2 offset:160
ds_read_b64_tr_b16 a[96:97], v2 offset:192
ds_read_b64_tr_b16 a[112:113], v2 offset:224
ds_read_b64_tr_b16 a[128:129], v2 offset:256
ds_read_b64_tr_b16 a[144:145], v2 offset:288
ds_read_b64_tr_b16 a[160:161], v2 offset:320
ds_read_b64_tr_b16 a[176:177], v2 offset:352
ds_read_b64_tr_b16 a[192:193], v2 offset:384
ds_read_b64_tr_b16 a[208:209], v2 offset:416
ds_read_b64_tr_b16 a[224:225], v2 offset:448
ds_read_b64_tr_b16 a[240:241], v2 offset:480
s_waitcnt lgkmcnt(0)
s_add_u32 m0, s81, 0
s_nop 0
buffer_load_dwordx4 v1, s[28:31], s80 offen lds
s_add_u32 m0, m0, 1024
s_add_u32 s80, s80, 4096
buffer_load_dwordx4 v1, s[28:31], s80 offen lds
s_add_u32 m0, m0, 1024
s_add_u32 s80, s80, 4096
buffer_load_dwordx4 v1, s[28:31], s80 offen lds
s_add_u32 m0, m0, 1024
s_add_u32 s80, s80, 4096
buffer_load_dwordx4 v1, s[28:31], s80 offen lds
s_add_u32 m0, m0, 1024
s_add_u32 s80, s80, 4096
buffer_load_dwordx4 v1, s[28:31], s80 offen lds
s_add_u32 m0, m0, 1024
s_add_u32 s80, s80, 4096
buffer_load_dwordx4 v1, s[28:31], s80 offen lds
s_add_u32 m0, m0, 1024
s_add_u32 s80, s80, 4096
buffer_load_dwordx4 v1, s[28:31], s80 offen lds
s_add_u32 m0, m0, 1024
s_add_u32 s80, s80, 4096
buffer_load_dwordx4 v1, s[28:31], s80 offen lds
s_add_u32 m0, m0, 1024
s_add_u32 s80, s80, 4096
s_waitcnt vmcnt(32)
ds_read_b64_tr_b16 a[2:3], v2 offset:8192
ds_read_b64_tr_b16 a[18:19], v2 offset:8224
ds_read_b64_tr_b16 a[34:35], v2 offset:8256
ds_read_b64_tr_b16 a[50:51], v2 offset:8288
ds_read_b64_tr_b16 a[66:67], v2 offset:8320
ds_read_b64_tr_b16 a[82:83], v2 offset:8352
ds_read_b64_tr_b16 a[98:99], v2 offset:8384
ds_read_b64_tr_b16 a[114:115], v2 offset:8416
ds_read_b64_tr_b16 a[130:131], v2 offset:8448
ds_read_b64_tr_b16 a[146:147], v2 offset:8480
ds_read_b64_tr_b16 a[162:163], v2 offset:8512
ds_read_b64_tr_b16 a[178:179], v2 offset:8544
ds_read_b64_tr_b16 a[194:195], v2 offset:8576
ds_read_b64_tr_b16 a[210:211], v2 offset:8608
ds_read_b64_tr_b16 a[226:227], v2 offset:8640
ds_read_b64_tr_b16 a[242:243], v2 offset:8672
s_waitcnt lgkmcnt(0)
s_add_u32 m0, s81, 8192
s_nop 0
buffer_load_dwordx4 v1, s[28:31], s80 offen lds
s_add_u32 m0, m0, 1024
s_add_u32 s80, s80, 4096
buffer_load_dwordx4 v1, s[28:31], s80 offen lds
s_add_u32 m0, m0, 1024
s_add_u32 s80, s80, 4096
buffer_load_dwordx4 v1, s[28:31], s80 offen lds
s_add_u32 m0, m0, 1024
s_add_u32 s80, s80, 4096
buffer_load_dwordx4 v1, s[28:31], s80 offen lds
s_add_u32 m0, m0, 1024
s_add_u32 s80, s80, 4096
buffer_load_dwordx4 v1, s[28:31], s80 offen lds
s_add_u32 m0, m0, 1024
s_add_u32 s80, s80, 4096
buffer_load_dwordx4 v1, s[28:31], s80 offen lds
s_add_u32 m0, m0, 1024
s_add_u32 s80, s80, 4096
buffer_load_dwordx4 v1, s[28:31], s80 offen lds
s_add_u32 m0, m0, 1024
s_add_u32 s80, s80, 4096
buffer_load_dwordx4 v1, s[28:31], s80 offen lds
s_add_u32 m0, m0, 1024
s_add_u32 s80, s80, 4096
s_waitcnt vmcnt(32)
ds_read_b64_tr_b16 a[4:5], v2 offset:16384
ds_read_b64_tr_b16 a[20:21], v2 offset:16416
ds_read_b64_tr_b16 a[36:37], v2 offset:16448
ds_read_b64_tr_b16 a[52:53], v2 offset:16480
ds_read_b64_tr_b16 a[68:69], v2 offset:16512
ds_read_b64_tr_b16 a[84:85], v2 offset:16544
ds_read_b64_tr_b16 a[100:101], v2 offset:16576
ds_read_b64_tr_b16 a[116:117], v2 offset:16608
ds_read_b64_tr_b16 a[132:133], v2 offset:16640
ds_read_b64_tr_b16 a[148:149], v2 offset:16672
ds_read_b64_tr_b16 a[164:165], v2 offset:16704
ds_read_b64_tr_b16 a[180:181], v2 offset:16736
ds_read_b64_tr_b16 a[196:197], v2 offset:16768
ds_read_b64_tr_b16 a[212:213], v2 offset:16800
ds_read_b64_tr_b16 a[228:229], v2 offset:16832
ds_read_b64_tr_b16 a[244:245], v2 offset:16864
s_waitcnt lgkmcnt(0)
s_add_u32 m0, s81, 16384
s_nop 0
buffer_load_dwordx4 v1, s[28:31], s80 offen lds
s_add_u32 m0, m0, 1024
s_add_u32 s80, s80, 4096
buffer_load_dwordx4 v1, s[28:31], s80 offen lds
s_add_u32 m0, m0, 1024
s_add_u32 s80, s80, 4096
buffer_load_dwordx4 v1, s[28:31], s80 offen lds
s_add_u32 m0, m0, 1024
s_add_u32 s80, s80, 4096
buffer_load_dwordx4 v1, s[28:31], s80 offen lds
s_add_u32 m0, m0, 1024
s_add_u32 s80, s80, 4096
buffer_load_dwordx4 v1, s[28:31], s80 offen lds
s_add_u32 m0, m0, 1024
s_add_u32 s80, s80, 4096
buffer_load_dwordx4 v1, s[28:31], s80 offen lds
s_add_u32 m0, m0, 1024
s_add_u32 s80, s80, 4096
buffer_load_dwordx4 v1, s[28:31], s80 offen lds
s_add_u32 m0, m0, 1024
s_add_u32 s80, s80, 4096
buffer_load_dwordx4 v1, s[28:31], s80 offen lds
s_add_u32 m0, m0, 1024
s_add_u32 s80, s80, 4096
s_waitcnt vmcnt(32)
ds_read_b64_tr_b16 a[6:7], v2 offset:24576
ds_read_b64_tr_b16 a[22:23], v2 offset:24608
ds_read_b64_tr_b16 a[38:39], v2 offset:24640
ds_read_b64_tr_b16 a[54:55], v2 offset:24672
ds_read_b64_tr_b16 a[70:71], v2 offset:24704
ds_read_b64_tr_b16 a[86:87], v2 offset:24736
ds_read_b64_tr_b16 a[102:103], v2 offset:24768
ds_read_b64_tr_b16 a[118:119], v2 offset:24800
ds_read_b64_tr_b16 a[134:135], v2 offset:24832
ds_read_b64_tr_b16 a[150:151], v2 offset:24864
ds_read_b64_tr_b16 a[166:167], v2 offset:24896
ds_read_b64_tr_b16 a[182:183], v2 offset:24928
ds_read_b64_tr_b16 a[198:199], v2 offset:24960
ds_read_b64_tr_b16 a[214:215], v2 offset:24992
ds_read_b64_tr_b16 a[230:231], v2 offset:25024
ds_read_b64_tr_b16 a[246:247], v2 offset:25056
s_waitcnt lgkmcnt(0)
s_lshl_b32 s80, s67, 16
s_add_u32 s80, s80, s82
s_add_u32 m0, s81, 24576
s_nop 0
buffer_load_dwordx4 v1, s[44:47], s80 offen lds
s_add_u32 m0, m0, 1024
s_add_u32 s80, s80, 4096
buffer_load_dwordx4 v1, s[44:47], s80 offen lds
s_add_u32 m0, m0, 1024
s_add_u32 s80, s80, 4096
buffer_load_dwordx4 v1, s[44:47], s80 offen lds
s_add_u32 m0, m0, 1024
s_add_u32 s80, s80, 4096
buffer_load_dwordx4 v1, s[44:47], s80 offen lds
s_add_u32 m0, m0, 1024
s_add_u32 s80, s80, 4096
buffer_load_dwordx4 v1, s[44:47], s80 offen lds
s_add_u32 m0, m0, 1024
s_add_u32 s80, s80, 4096
buffer_load_dwordx4 v1, s[44:47], s80 offen lds
s_add_u32 m0, m0, 1024
s_add_u32 s80, s80, 4096
buffer_load_dwordx4 v1, s[44:47], s80 offen lds
s_add_u32 m0, m0, 1024
s_add_u32 s80, s80, 4096
buffer_load_dwordx4 v1, s[44:47], s80 offen lds
s_add_u32 m0, m0, 1024
s_add_u32 s80, s80, 4096
s_waitcnt vmcnt(32)
ds_read_b64_tr_b16 a[8:9], v2 offset:32768
ds_read_b64_tr_b16 a[24:25], v2 offset:32800
ds_read_b64_tr_b16 a[40:41], v2 offset:32832
ds_read_b64_tr_b16 a[56:57], v2 offset:32864
ds_read_b64_tr_b16 a[72:73], v2 offset:32896
ds_read_b64_tr_b16 a[88:89], v2 offset:32928
ds_read_b64_tr_b16 a[104:105], v2 offset:32960
ds_read_b64_tr_b16 a[120:121], v2 offset:32992
ds_read_b64_tr_b16 a[136:137], v2 offset:33024
ds_read_b64_tr_b16 a[152:153], v2 offset:33056
ds_read_b64_tr_b16 a[168:169], v2 offset:33088
ds_read_b64_tr_b16 a[184:185], v2 offset:33120
ds_read_b64_tr_b16 a[200:201], v2 offset:33152
ds_read_b64_tr_b16 a[216:217], v2 offset:33184
ds_read_b64_tr_b16 a[232:233], v2 offset:33216
ds_read_b64_tr_b16 a[248:249], v2 offset:33248
s_waitcnt lgkmcnt(0)
s_add_u32 m0, s81, 32768
s_nop 0
buffer_load_dwordx4 v1, s[44:47], s80 offen lds
s_add_u32 m0, m0, 1024
s_add_u32 s80, s80, 4096
buffer_load_dwordx4 v1, s[44:47], s80 offen lds
s_add_u32 m0, m0, 1024
s_add_u32 s80, s80, 4096
buffer_load_dwordx4 v1, s[44:47], s80 offen lds
s_add_u32 m0, m0, 1024
s_add_u32 s80, s80, 4096
buffer_load_dwordx4 v1, s[44:47], s80 offen lds
s_add_u32 m0, m0, 1024
s_add_u32 s80, s80, 4096
buffer_load_dwordx4 v1, s[44:47], s80 offen lds
s_add_u32 m0, m0, 1024
s_add_u32 s80, s80, 4096
buffer_load_dwordx4 v1, s[44:47], s80 offen lds
s_add_u32 m0, m0, 1024
s_add_u32 s80, s80, 4096
buffer_load_dwordx4 v1, s[44:47], s80 offen lds
s_add_u32 m0, m0, 1024
s_add_u32 s80, s80, 4096
buffer_load_dwordx4 v1, s[44:47], s80 offen lds
s_add_u32 m0, m0, 1024
s_add_u32 s80, s80, 4096
s_waitcnt vmcnt(32)
ds_read_b64_tr_b16 a[10:11], v2 offset:0
ds_read_b64_tr_b16 a[26:27], v2 offset:32
ds_read_b64_tr_b16 a[42:43], v2 offset:64
ds_read_b64_tr_b16 a[58:59], v2 offset:96
ds_read_b64_tr_b16 a[74:75], v2 offset:128
ds_read_b64_tr_b16 a[90:91], v2 offset:160
ds_read_b64_tr_b16 a[106:107], v2 offset:192
ds_read_b64_tr_b16 a[122:123], v2 offset:224
ds_read_b64_tr_b16 a[138:139], v2 offset:256
ds_read_b64_tr_b16 a[154:155], v2 offset:288
ds_read_b64_tr_b16 a[170:171], v2 offset:320
ds_read_b64_tr_b16 a[186:187], v2 offset:352
ds_read_b64_tr_b16 a[202:203], v2 offset:384
ds_read_b64_tr_b16 a[218:219], v2 offset:416
ds_read_b64_tr_b16 a[234:235], v2 offset:448
ds_read_b64_tr_b16 a[250:251], v2 offset:480
s_waitcnt lgkmcnt(0)
s_waitcnt vmcnt(24)
ds_read_b64_tr_b16 a[12:13], v2 offset:8192
ds_read_b64_tr_b16 a[28:29], v2 offset:8224
ds_read_b64_tr_b16 a[44:45], v2 offset:8256
ds_read_b64_tr_b16 a[60:61], v2 offset:8288
ds_read_b64_tr_b16 a[76:77], v2 offset:8320
ds_read_b64_tr_b16 a[92:93], v2 offset:8352
ds_read_b64_tr_b16 a[108:109], v2 offset:8384
ds_read_b64_tr_b16 a[124:125], v2 offset:8416
ds_read_b64_tr_b16 a[140:141], v2 offset:8448
ds_read_b64_tr_b16 a[156:157], v2 offset:8480
ds_read_b64_tr_b16 a[172:173], v2 offset:8512
ds_read_b64_tr_b16 a[188:189], v2 offset:8544
ds_read_b64_tr_b16 a[204:205], v2 offset:8576
ds_read_b64_tr_b16 a[220:221], v2 offset:8608
ds_read_b64_tr_b16 a[236:237], v2 offset:8640
ds_read_b64_tr_b16 a[252:253], v2 offset:8672
s_waitcnt lgkmcnt(0)
s_waitcnt vmcnt(16)
ds_read_b64_tr_b16 a[14:15], v2 offset:16384
ds_read_b64_tr_b16 a[30:31], v2 offset:16416
ds_read_b64_tr_b16 a[46:47], v2 offset:16448
ds_read_b64_tr_b16 a[62:63], v2 offset:16480
ds_read_b64_tr_b16 a[78:79], v2 offset:16512
ds_read_b64_tr_b16 a[94:95], v2 offset:16544
ds_read_b64_tr_b16 a[110:111], v2 offset:16576
ds_read_b64_tr_b16 a[126:127], v2 offset:16608
ds_read_b64_tr_b16 a[142:143], v2 offset:16640
ds_read_b64_tr_b16 a[158:159], v2 offset:16672
ds_read_b64_tr_b16 a[174:175], v2 offset:16704
ds_read_b64_tr_b16 a[190:191], v2 offset:16736
ds_read_b64_tr_b16 a[206:207], v2 offset:16768
ds_read_b64_tr_b16 a[222:223], v2 offset:16800
ds_read_b64_tr_b16 a[238:239], v2 offset:16832
ds_read_b64_tr_b16 a[254:255], v2 offset:16864
s_waitcnt lgkmcnt(0)
s_waitcnt vmcnt(8)
ds_read_b64_tr_b16 v[192:193], v2 offset:24576
ds_read_b64_tr_b16 v[196:197], v2 offset:24608
ds_read_b64_tr_b16 v[200:201], v2 offset:24640
ds_read_b64_tr_b16 v[204:205], v2 offset:24672
ds_read_b64_tr_b16 v[208:209], v2 offset:24704
ds_read_b64_tr_b16 v[212:213], v2 offset:24736
ds_read_b64_tr_b16 v[216:217], v2 offset:24768
ds_read_b64_tr_b16 v[220:221], v2 offset:24800
ds_read_b64_tr_b16 v[224:225], v2 offset:24832
ds_read_b64_tr_b16 v[228:229], v2 offset:24864
ds_read_b64_tr_b16 v[232:233], v2 offset:24896
ds_read_b64_tr_b16 v[236:237], v2 offset:24928
ds_read_b64_tr_b16 v[240:241], v2 offset:24960
ds_read_b64_tr_b16 v[244:245], v2 offset:24992
ds_read_b64_tr_b16 v[248:249], v2 offset:25024
ds_read_b64_tr_b16 v[252:253], v2 offset:25056
s_waitcnt lgkmcnt(0)
s_waitcnt vmcnt(0)
ds_read_b64_tr_b16 v[194:195], v2 offset:32768
ds_read_b64_tr_b16 v[198:199], v2 offset:32800
ds_read_b64_tr_b16 v[202:203], v2 offset:32832
ds_read_b64_tr_b16 v[206:207], v2 offset:32864
ds_read_b64_tr_b16 v[210:211], v2 offset:32896
ds_read_b64_tr_b16 v[214:215], v2 offset:32928
ds_read_b64_tr_b16 v[218:219], v2 offset:32960
ds_read_b64_tr_b16 v[222:223], v2 offset:32992
ds_read_b64_tr_b16 v[226:227], v2 offset:33024
ds_read_b64_tr_b16 v[230:231], v2 offset:33056
ds_read_b64_tr_b16 v[234:235], v2 offset:33088
ds_read_b64_tr_b16 v[238:239], v2 offset:33120
ds_read_b64_tr_b16 v[242:243], v2 offset:33152
ds_read_b64_tr_b16 v[246:247], v2 offset:33184
ds_read_b64_tr_b16 v[250:251], v2 offset:33216
ds_read_b64_tr_b16 v[254:255], v2 offset:33248
s_waitcnt lgkmcnt(0)
s_cmp_eq_u32 s66, 0
s_cselect_b32 s76, 545390592, s76
s_cselect_b32 s77, 136348168, s77
s_cmp_eq_u32 s66, 1
s_cselect_b32 s76, 68174409, s76
s_cselect_b32 s77, 1090785345, s77
s_cmp_eq_u32 s66, 2
s_cselect_b32 s76, 136348818, s76
s_cselect_b32 s77, 2181570690, s77
s_cmp_eq_u32 s66, 3
s_cselect_b32 s76, 272697636, s76
s_cselect_b32 s77, 68174084, s77
s_cmp_eq_u32 s66, 4
s_cselect_b32 s76, 1090785280, s76
s_cselect_b32 s77, 272696336, s77
s_cmp_eq_u32 s66, 5
s_cselect_b32 s76, 2181570560, s76
s_cselect_b32 s77, 545392672, s77
s_flbit_i32_b64 s80, s[76:77]
s_sub_u32 s80, 63, s80
s_lshl_b32 s80, s80, 2
s_add_u32 s80, s80, s68
s_lshl_b32 s80, s80, 5
s_add_u32 s80, s80, s67
s_lshl_b32 s80, s80, 13
s_add_u32 s80, s80, 150994944
v_mov_b32 v4, -1
v_mov_b32 v5, -1
v_mov_b32 v6, -1
v_mov_b32 v7, -1
buffer_store_dwordx4 v[4:7], v189, s[60:63], s80 offen sc1
s_add_u32 s80, s80, 1024
buffer_store_dwordx4 v[4:7], v189, s[60:63], s80 offen sc1
s_add_u32 s80, s80, 1024
buffer_store_dwordx4 v[4:7], v189, s[60:63], s80 offen sc1
s_add_u32 s80, s80, 1024
buffer_store_dwordx4 v[4:7], v189, s[60:63], s80 offen sc1
s_add_u32 s80, s80, 1024
buffer_store_dwordx4 v[4:7], v189, s[60:63], s80 offen sc1
s_add_u32 s80, s80, 1024
buffer_store_dwordx4 v[4:7], v189, s[60:63], s80 offen sc1
s_add_u32 s80, s80, 1024
buffer_store_dwordx4 v[4:7], v189, s[60:63], s80 offen sc1
s_add_u32 s80, s80, 1024
buffer_store_dwordx4 v[4:7], v189, s[60:63], s80 offen sc1
s_add_u32 s80, s80, 1024
s_ff1_i32_b64 s66, s[76:77]
s_bitset0_b64 s[76:77], s66
v_and_b32 v191, 15, v0
v_lshlrev_b32 v191, 11, v191
v_lshrrev_b32 v2, 4, v0
v_lshl_add_u32 v191, v2, 3, v191
v_lshlrev_b32 v190, 3, v0
s_lshl_b32 s71, s65, 11
s_add_u32 s71, s71, 131072
v_add_u32 v190, s71, v190
s_mov_b32 s78, 0
Lz_47:
buffer_load_dwordx4 v[4:7], v188, s[56:59], 0 offen offset:192 sc1
buffer_load_dwordx4 v[8:11], v188, s[56:59], 0 offen offset:208 sc1
s_waitcnt vmcnt(0)
s_add_u32 s78, s78, 1
s_cmp_gt_u32 s78, 0x40000
s_cbranch_scc1 Lz_48
v_min3_u32 v4, v4, v5, v6
v_min3_u32 v8, v8, v9, v10
v_min3_u32 v4, v4, v7, v8
v_min_u32 v4, v4, v11
s_nop 0
v_readfirstlane_b32 s71, v4
s_cmp_ge_u32 s71, 32
s_cbranch_scc1 Lz_48
s_sleep 12
s_branch Lz_47
Lz_48:
s_mov_b32 s78, 0
Lz_49:
buffer_load_dwordx4 v[4:7], v188, s[56:59], 0 offen offset:64 sc1
buffer_load_dwordx4 v[8:11], v188, s[56:59], 0 offen offset:80 sc1
s_waitcnt vmcnt(0)
s_add_u32 s78, s78, 1
s_cmp_gt_u32 s78, 0x40000
s_cbranch_scc1 Lz_50
v_min3_u32 v4, v4, v5, v6
v_min3_u32 v8, v8, v9, v10
v_min3_u32 v4, v4, v7, v8
v_min_u32 v4, v4, v11
s_nop 0
v_readfirstlane_b32 s71, v4
s_cmp_ge_u32 s71, 128
s_cbranch_scc1 Lz_50
s_sleep 12
s_branch Lz_49
Lz_50:
s_barrier
s_mov_b32 s86, -1
s_mov_b32 s91, 0
L_z_seg:
v_lshlrev_b32 v1, 4, v0
v_and_b32 v2, 15, v0
v_lshrrev_b32 v3, 4, v0
v_and_b32 v4, 7, v0
v_lshlrev_b32 v4, 4, v4
v_lshl_add_u32 v4, v3, 7, v4
v_and_b32 v5, 31, v0
v_lshlrev_b32 v5, 3, v5
s_lshl_b32 s80, s66, 5
s_add_u32 s80, s80, s67
s_lshl_b32 s81, s80, 14
s_lshl_b32 s82, s80, 12
s_add_u32 s82, s82, 50331648
s_lshl_b32 s80, s80, 13
s_add_u32 s80, s80, 33554432
s_lshl_b32 s83, s66, 7
s_add_u32 s83, s83, 63176704
v_lshlrev_b32 v6, 2, v2
buffer_load_dwordx4 v[12:15], v1, s[60:63], s80 offen offset:0
buffer_load_dwordx4 v[16:19], v1, s[60:63], s80 offen offset:1024
buffer_load_dwordx4 v[20:23], v1, s[60:63], s80 offen offset:2048
buffer_load_dwordx4 v[24:27], v1, s[60:63], s80 offen offset:3072
s_add_u32 s80, s80, 4096
buffer_load_dwordx4 v[28:31], v1, s[60:63], s80 offen offset:0
buffer_load_dwordx4 v[32:35], v1, s[60:63], s80 offen offset:1024
buffer_load_dwordx4 v[36:39], v1, s[60:63], s80 offen offset:2048
buffer_load_dwordx4 v[40:43], v1, s[60:63], s80 offen offset:3072
s_add_u32 s80, s80, 4096
buffer_load_dwordx4 v[44:47], v1, s[60:63], s81 offen offset:0
buffer_load_dwordx4 v[48:51], v1, s[60:63], s81 offen offset:1024
buffer_load_dwordx4 v[60:63], v1, s[60:63], s81 offen offset:2048
buffer_load_dwordx4 v[64:67], v1, s[60:63], s81 offen offset:3072
s_add_u32 s81, s81, 8192
buffer_load_dwordx4 v[52:55], v1, s[60:63], s81 offen offset:0
buffer_load_dwordx4 v[56:59], v1, s[60:63], s81 offen offset:1024
buffer_load_dwordx4 v[68:71], v1, s[60:63], s81 offen offset:2048
buffer_load_dwordx4 v[72:75], v1, s[60:63], s81 offen offset:3072
s_add_u32 s81, s81, -4096
buffer_load_dword v10, v6, s[60:63], s83 offen offset:0 sc1
buffer_load_dword v11, v6, s[60:63], s83 offen offset:64 sc1
buffer_load_dwordx4 v[92:95], v1, s[60:63], s81 offen offset:0
buffer_load_dwordx4 v[96:99], v1, s[60:63], s81 offen offset:1024
buffer_load_dwordx4 v[100:103], v1, s[60:63], s81 offen offset:2048
buffer_load_dwordx4 v[104:107], v1, s[60:63], s81 offen offset:3072
s_add_u32 s81, s81, 8192
buffer_load_dwordx4 v[108:111], v1, s[60:63], s81 offen offset:0
buffer_load_dwordx4 v[112:115], v1, s[60:63], s81 offen offset:1024
buffer_load_dwordx4 v[116:119], v1, s[60:63], s81 offen offset:2048
buffer_load_dwordx4 v[120:123], v1, s[60:63], s81 offen offset:3072
s_mov_b32 s79, s86
s_cmp_lg_u32 s91, 0
s_cbranch_scc1 Lz_51
s_cmp_eq_u32 s86, -1
s_cbranch_scc1 Lz_52
s_waitcnt vmcnt(0)
s_barrier
s_cmp_lg_u32 s65, 0
s_cbranch_scc1 Lz_53
s_lshl_b32 s71, s86, 2
s_add_u32 s71, s71, s68
s_lshl_b32 s71, s71, 2
s_add_u32 s71, s71, 63242240
v_mov_b32 v3, 1
s_mov_b64 exec, 1
buffer_atomic_add v3, v188, s[60:63], s71 offen sc1
s_mov_b64 exec, -1
Lz_53:
s_lshl_b32 s87, s86, 2
s_add_u32 s87, s87, s68
s_lshl_b32 s87, s87, 2
s_add_u32 s87, s87, 63242240
s_mov_b32 s78, 0
Lz_54:
buffer_load_dword v3, v188, s[60:63], s87 offen sc1
s_waitcnt vmcnt(0)
s_add_u32 s78, s78, 1
s_cmp_gt_u32 s78, 0x40000
s_cbranch_scc1 Lz_55
v_readfirstlane_b32 s71, v3
s_cmp_ge_u32 s71, 8
s_cbranch_scc1 Lz_55
s_sleep 12
s_branch Lz_54
Lz_55:
s_mov_b32 s79, s82
s_lshl_b32 s80, s86, 2
s_add_u32 s80, s80, s68
s_lshl_b32 s80, s80, 18
s_lshl_b32 s81, s69, 2
s_add_u32 s81, s81, s65
s_lshl_b32 s82, s81, 10
s_add_u32 s80, s80, s82
s_add_u32 s80, s80, 150994944
buffer_load_dwordx4 v[140:143], v189, s[60:63], s80 offen sc1
s_add_u32 s80, s80, 32768
buffer_load_dwordx4 v[144:147], v189, s[60:63], s80 offen sc1
s_add_u32 s80, s80, 32768
buffer_load_dwordx4 v[148:151], v189, s[60:63], s80 offen sc1
s_add_u32 s80, s80, 32768
buffer_load_dwordx4 v[152:155], v189, s[60:63], s80 offen sc1
s_add_u32 s80, s80, 32768
buffer_load_dwordx4 v[156:159], v189, s[60:63], s80 offen sc1
s_add_u32 s80, s80, 32768
buffer_load_dwordx4 v[160:163], v189, s[60:63], s80 offen sc1
s_add_u32 s80, s80, 32768
buffer_load_dwordx4 v[164:167], v189, s[60:63], s80 offen sc1
s_add_u32 s80, s80, 32768
buffer_load_dwordx4 v[168:171], v189, s[60:63], s80 offen sc1
s_add_u32 s80, s80, 32768
s_lshl_b32 s87, s86, 16
s_and_b32 s82, s81, 1
s_lshl_b32 s82, s82, 15
s_add_u32 s87, s87, s82
s_lshr_b32 s81, s81, 1
s_lshl_b32 s81, s81, 5
s_add_u32 s87, s87, s81
s_lshl_b32 s81, s68, 9
s_add_u32 s87, s87, s81
s_mov_b32 s82, s79
s_waitcnt vmcnt(0)
v_pk_add_f32 v[140:141], v[140:141], v[144:145]
v_pk_add_f32 v[142:143], v[142:143], v[146:147]
v_pk_add_f32 v[148:149], v[148:149], v[152:153]
v_pk_add_f32 v[150:151], v[150:151], v[154:155]
v_pk_add_f32 v[156:157], v[156:157], v[160:161]
v_pk_add_f32 v[158:159], v[158:159], v[162:163]
v_pk_add_f32 v[164:165], v[164:165], v[168:169]
v_pk_add_f32 v[166:167], v[166:167], v[170:171]
v_pk_add_f32 v[140:141], v[140:141], v[148:149]
v_pk_add_f32 v[142:143], v[142:143], v[150:151]
v_pk_add_f32 v[156:157], v[156:157], v[164:165]
v_pk_add_f32 v[158:159], v[158:159], v[166:167]
v_pk_add_f32 v[140:141], v[140:141], v[156:157]
v_pk_add_f32 v[142:143], v[142:143], v[158:159]
v_cvt_pk_bf16_f32 v140, v140, v141
v_cvt_pk_bf16_f32 v141, v142, v143
buffer_store_dwordx2 v[140:141], v191, s[52:55], s87 offen
s_mov_b32 s86, -1
Lz_52:
s_mov_b32 s79, -1
s_lshl_b32 s87, s66, 2
s_add_u32 s87, s87, 63243264
s_mov_b32 s78, 0
Lz_56:
buffer_load_dword v3, v188, s[60:63], s87 offen sc1
s_waitcnt vmcnt(0)
s_add_u32 s78, s78, 1
s_cmp_gt_u32 s78, 0x40000
s_cbranch_scc1 Lz_57
v_readfirstlane_b32 s71, v3
s_cmp_ge_u32 s71, 4
s_cbranch_scc1 Lz_57
s_sleep 12
s_branch Lz_56
Lz_57:
s_cmp_lt_u32 s66, 60
s_cselect_b32 s87, 2, -1
s_add_u32 s87, s87, s66
s_mov_b32 s78, 0
Lz_58:
buffer_load_dwordx2 v[8:9], v188, s[56:59], 0 offen offset:160 sc1
s_waitcnt vmcnt(0)
s_add_u32 s78, s78, 1
s_cmp_gt_u32 s78, 0x40000
s_cbranch_scc1 Lz_59
v_readfirstlane_b32 s71, v8
s_cmp_ge_u32 s71, s87
s_cbranch_scc1 Lz_59
s_sleep 12
s_branch Lz_58
Lz_59:
Lz_51:
v_mul_u32_u24 v7, 10240, v2
v_lshrrev_b32 v3, 4, v0
v_lshl_add_u32 v7, v3, 3, v7
s_mul_i32 s87, s66, 327680
s_lshl_b32 s72, s67, 6
s_add_u32 s87, s87, s72
s_add_u32 s87, s87, 67117056
s_add_u32 s72, s87, 163840
buffer_load_dwordx2 v[164:165], v7, s[60:63], s87 offen offset:0 sc1
buffer_load_dwordx2 v[166:167], v7, s[60:63], s87 offen offset:32 sc1
buffer_load_dwordx2 v[168:169], v7, s[60:63], s72 offen offset:0 sc1
buffer_load_dwordx2 v[170:171], v7, s[60:63], s72 offen offset:32 sc1
s_mov_b32 s78, 0
Lkm_60:
buffer_load_dwordx4 v[76:79], v4, s[60:63], s82 offen offset:0 sc1
buffer_load_dwordx4 v[80:83], v4, s[60:63], s82 offen offset:512 sc1
buffer_load_dwordx4 v[84:87], v4, s[60:63], s82 offen offset:2048 sc1
buffer_load_dwordx4 v[88:91], v4, s[60:63], s82 offen offset:2560 sc1
buffer_load_dwordx2 v[124:125], v5, s[60:63], s82 offen offset:1024 sc1
buffer_load_dwordx2 v[126:127], v5, s[60:63], s82 offen offset:1280 sc1
buffer_load_dwordx2 v[128:129], v5, s[60:63], s82 offen offset:1536 sc1
buffer_load_dwordx2 v[130:131], v5, s[60:63], s82 offen offset:1792 sc1
buffer_load_dwordx2 v[132:133], v5, s[60:63], s82 offen offset:3072 sc1
buffer_load_dwordx2 v[134:135], v5, s[60:63], s82 offen offset:3328 sc1
buffer_load_dwordx2 v[136:137], v5, s[60:63], s82 offen offset:3584 sc1
buffer_load_dwordx2 v[138:139], v5, s[60:63], s82 offen offset:3840 sc1
s_cmp_lt_u32 s66, 60
s_cbranch_scc1 Lkm_61
s_waitcnt vmcnt(0)
v_max_u32 v7, v76, v77
v_max3_u32 v7, v7, v78, v79
v_max3_u32 v7, v7, v80, v81
v_max3_u32 v7, v7, v82, v83
v_max3_u32 v7, v7, v84, v85
v_max3_u32 v7, v7, v86, v87
v_max3_u32 v7, v7, v88, v89
v_max3_u32 v7, v7, v90, v91
v_max3_u32 v7, v7, v124, v125
v_max3_u32 v7, v7, v126, v127
v_max3_u32 v7, v7, v128, v129
v_max3_u32 v7, v7, v130, v131
v_max3_u32 v7, v7, v132, v133
v_max3_u32 v7, v7, v134, v135
v_max3_u32 v7, v7, v136, v137
v_max3_u32 v7, v7, v138, v139
v_cmp_eq_u32 vcc, -1, v7
s_add_u32 s78, s78, 1
s_cmp_gt_u32 s78, 0x40000
s_cbranch_scc1 Lkm_61
s_cbranch_vccnz Lkm_60
Lkm_61:
v_lshlrev_b32 v7, 3, v3
v_sub_u32 v7, v2, v7
v_mov_b32 v8, 3492320863
v_mov_b32 v9, 0xff000000
s_mov_b32 s84, 0
s_mov_b32 s85, -1
s_waitcnt vmcnt(12)
ds_write_b64 v190, v[164:165] offset:0
ds_write_b64 v190, v[166:167] offset:512
ds_write_b64 v190, v[168:169] offset:1024
ds_write_b64 v190, v[170:171] offset:1536
s_cmp_eq_u32 s79, -1
s_cbranch_scc1 Lz_62
s_barrier
s_cmp_lg_u32 s65, 0
s_cbranch_scc1 Lz_63
s_lshl_b32 s71, s86, 2
s_add_u32 s71, s71, s68
s_lshl_b32 s71, s71, 2
s_add_u32 s71, s71, 63242240
v_mov_b32 v3, 1
s_mov_b64 exec, 1
buffer_atomic_add v3, v188, s[60:63], s71 offen sc1
s_mov_b64 exec, -1
Lz_63:
v_lshrrev_b32 v3, 4, v0
Lz_62:
v_mfma_f32_16x16x32_bf16 v[140:143], v[44:47], v[12:15], 0
v_mfma_f32_16x16x32_bf16 v[144:147], v[60:63], v[12:15], 0
v_mfma_f32_16x16x32_bf16 v[152:155], v[44:47], v[28:31], 0
v_mfma_f32_16x16x32_bf16 v[156:159], v[60:63], v[28:31], 0
v_mfma_f32_16x16x32_bf16 v[140:143], v[48:51], v[16:19], v[140:143]
v_mfma_f32_16x16x32_bf16 v[144:147], v[64:67], v[16:19], v[144:147]
v_mfma_f32_16x16x32_bf16 v[152:155], v[48:51], v[32:35], v[152:155]
v_mfma_f32_16x16x32_bf16 v[156:159], v[64:67], v[32:35], v[156:159]
v_mfma_f32_16x16x32_bf16 v[140:143], v[52:55], v[20:23], v[140:143]
v_mfma_f32_16x16x32_bf16 v[144:147], v[68:71], v[20:23], v[144:147]
v_mfma_f32_16x16x32_bf16 v[152:155], v[52:55], v[36:39], v[152:155]
v_mfma_f32_16x16x32_bf16 v[156:159], v[68:71], v[36:39], v[156:159]
v_mfma_f32_16x16x32_bf16 v[140:143], v[56:59], v[24:27], v[140:143]
v_mfma_f32_16x16x32_bf16 v[144:147], v[72:75], v[24:27], v[144:147]
v_mfma_f32_16x16x32_bf16 v[152:155], v[56:59], v[40:43], v[152:155]
v_mfma_f32_16x16x32_bf16 v[156:159], v[72:75], v[40:43], v[156:159]
s_waitcnt vmcnt(8)
v_mfma_f32_16x16x32_bf16 v[148:151], v[76:79], v[12:15], 0
v_mfma_f32_16x16x32_bf16 v[160:163], v[76:79], v[28:31], 0
v_mfma_f32_16x16x32_bf16 v[148:151], v[80:83], v[16:19], v[148:151]
v_mfma_f32_16x16x32_bf16 v[160:163], v[80:83], v[32:35], v[160:163]
v_mfma_f32_16x16x32_bf16 v[148:151], v[84:87], v[20:23], v[148:151]
v_mfma_f32_16x16x32_bf16 v[160:163], v[84:87], v[36:39], v[160:163]
v_mfma_f32_16x16x32_bf16 v[148:151], v[88:91], v[24:27], v[148:151]
v_mfma_f32_16x16x32_bf16 v[160:163], v[88:91], v[40:43], v[160:163]
s_mul_i32 s80, s66, 327680
s_lshl_b32 s81, s67, 8
s_add_u32 s80, s80, s81
s_add_u32 s80, s80, 67108864
s_add_u32 s81, s80, 163840
v_mul_u32_u24 v1, 10240, v2
v_and_b32 v4, 1, v3
v_lshl_add_u32 v1, v4, 5, v1
v_lshrrev_b32 v4, 1, v3
v_lshl_add_u32 v1, v4, 4, v1
s_mov_b32 s82, 1040356334
v_mov_b32 v176, 0x3f803f80
v_mov_b32 v177, 0x3f803f80
v_mov_b32 v178, 0x3f803f80
v_mov_b32 v179, 0x3f803f80
v_cmp_le_i32 vcc, 0, v7
v_cndmask_b32 v140, v8, v140, vcc
v_cmp_le_i32 vcc, 1, v7
v_cndmask_b32 v141, v8, v141, vcc
v_cmp_le_i32 vcc, 2, v7
v_cndmask_b32 v142, v8, v142, vcc
v_cmp_le_i32 vcc, 3, v7
v_cndmask_b32 v143, v8, v143, vcc
v_cmp_le_i32 vcc, 4, v7
v_cndmask_b32 v144, v8, v144, vcc
v_cmp_le_i32 vcc, 5, v7
v_cndmask_b32 v145, v8, v145, vcc
v_cmp_le_i32 vcc, 6, v7
v_cndmask_b32 v146, v8, v146, vcc
v_cmp_le_i32 vcc, 7, v7
v_cndmask_b32 v147, v8, v147, vcc
v_cndmask_b32 v148, v148, v9, s[84:85]
v_cndmask_b32 v149, v149, v9, s[84:85]
v_cndmask_b32 v150, v150, v9, s[84:85]
v_cndmask_b32 v151, v151, v9, s[84:85]
v_max3_f32 v2, v140, v141, v142
v_max3_f32 v2, v2, v143, v144
v_max3_f32 v2, v2, v145, v146
v_max3_f32 v2, v2, v147, v148
v_max3_f32 v2, v2, v149, v150
v_max_f32 v2, v2, v151
v_mov_b32 v3, v2
s_nop 1
v_permlane32_swap_b32 v2, v3
v_max_f32 v2, v2, v3
v_mov_b32 v3, v2
s_nop 1
v_permlane16_swap_b32 v2, v3
v_max_f32 v2, v2, v3
v_mul_f32 v2, s82, v2
v_fma_f32 v140, v140, s82, -v2
v_fma_f32 v141, v141, s82, -v2
v_fma_f32 v142, v142, s82, -v2
v_fma_f32 v143, v143, s82, -v2
v_fma_f32 v144, v144, s82, -v2
v_fma_f32 v145, v145, s82, -v2
v_fma_f32 v146, v146, s82, -v2
v_fma_f32 v147, v147, s82, -v2
v_fma_f32 v148, v148, s82, -v2
v_fma_f32 v149, v149, s82, -v2
v_fma_f32 v150, v150, s82, -v2
v_fma_f32 v151, v151, s82, -v2
v_exp_f32 v140, v140
v_exp_f32 v141, v141
v_exp_f32 v142, v142
v_exp_f32 v143, v143
v_exp_f32 v144, v144
v_exp_f32 v145, v145
v_exp_f32 v146, v146
v_exp_f32 v147, v147
v_exp_f32 v148, v148
v_exp_f32 v149, v149
v_exp_f32 v150, v150
v_exp_f32 v151, v151
s_nop 0
v_cvt_pk_bf16_f32 v164, v140, v141
v_cvt_pk_bf16_f32 v165, v142, v143
v_cvt_pk_bf16_f32 v166, v144, v145
v_cvt_pk_bf16_f32 v167, v146, v147
v_cvt_pk_bf16_f32 v168, v148, v149
v_cvt_pk_bf16_f32 v169, v150, v151
v_cmp_le_i32 vcc, -16, v7
v_cndmask_b32 v152, v8, v152, vcc
v_cmp_le_i32 vcc, -15, v7
v_cndmask_b32 v153, v8, v153, vcc
v_cmp_le_i32 vcc, -14, v7
v_cndmask_b32 v154, v8, v154, vcc
v_cmp_le_i32 vcc, -13, v7
v_cndmask_b32 v155, v8, v155, vcc
v_cmp_le_i32 vcc, -12, v7
v_cndmask_b32 v156, v8, v156, vcc
v_cmp_le_i32 vcc, -11, v7
v_cndmask_b32 v157, v8, v157, vcc
v_cmp_le_i32 vcc, -10, v7
v_cndmask_b32 v158, v8, v158, vcc
v_cmp_le_i32 vcc, -9, v7
v_cndmask_b32 v159, v8, v159, vcc
v_cndmask_b32 v160, v160, v9, s[84:85]
v_cndmask_b32 v161, v161, v9, s[84:85]
v_cndmask_b32 v162, v162, v9, s[84:85]
v_cndmask_b32 v163, v163, v9, s[84:85]
v_max3_f32 v2, v152, v153, v154
v_max3_f32 v2, v2, v155, v156
v_max3_f32 v2, v2, v157, v158
v_max3_f32 v2, v2, v159, v160
v_max3_f32 v2, v2, v161, v162
v_max_f32 v2, v2, v163
v_mov_b32 v3, v2
s_nop 1
v_permlane32_swap_b32 v2, v3
v_max_f32 v2, v2, v3
v_mov_b32 v3, v2
s_nop 1
v_permlane16_swap_b32 v2, v3
v_max_f32 v2, v2, v3
v_mul_f32 v2, s82, v2
v_fma_f32 v152, v152, s82, -v2
v_fma_f32 v153, v153, s82, -v2
v_fma_f32 v154, v154, s82, -v2
v_fma_f32 v155, v155, s82, -v2
v_fma_f32 v156, v156, s82, -v2
v_fma_f32 v157, v157, s82, -v2
v_fma_f32 v158, v158, s82, -v2
v_fma_f32 v159, v159, s82, -v2
v_fma_f32 v160, v160, s82, -v2
v_fma_f32 v161, v161, s82, -v2
v_fma_f32 v162, v162, s82, -v2
v_fma_f32 v163, v163, s82, -v2
v_exp_f32 v152, v152
v_exp_f32 v153, v153
v_exp_f32 v154, v154
v_exp_f32 v155, v155
v_exp_f32 v156, v156
v_exp_f32 v157, v157
v_exp_f32 v158, v158
v_exp_f32 v159, v159
v_exp_f32 v160, v160
v_exp_f32 v161, v161
v_exp_f32 v162, v162
v_exp_f32 v163, v163
s_nop 0
v_cvt_pk_bf16_f32 v170, v152, v153
v_cvt_pk_bf16_f32 v171, v154, v155
v_cvt_pk_bf16_f32 v172, v156, v157
v_cvt_pk_bf16_f32 v173, v158, v159
v_cvt_pk_bf16_f32 v174, v160, v161
v_cvt_pk_bf16_f32 v175, v162, v163
s_waitcnt vmcnt(0)
v_mfma_f32_16x16x32_bf16 v[180:183], v[176:179], v[164:167], 0
v_mfma_f32_16x16x32_bf16 v[184:187], v[176:179], v[170:173], 0
v_mfma_f32_16x16x32_bf16 v[12:15], v[92:95], v[164:167], 0
v_mfma_f32_16x16x32_bf16 v[16:19], v[96:99], v[164:167], 0
v_mfma_f32_16x16x32_bf16 v[20:23], v[100:103], v[164:167], 0
v_mfma_f32_16x16x32_bf16 v[24:27], v[104:107], v[164:167], 0
v_mfma_f32_16x16x32_bf16 v[28:31], v[108:111], v[164:167], 0
v_mfma_f32_16x16x32_bf16 v[32:35], v[112:115], v[164:167], 0
v_mfma_f32_16x16x32_bf16 v[36:39], v[116:119], v[164:167], 0
v_mfma_f32_16x16x32_bf16 v[40:43], v[120:123], v[164:167], 0
v_mfma_f32_16x16x32_bf16 v[44:47], v[92:95], v[170:173], 0
v_mfma_f32_16x16x32_bf16 v[48:51], v[96:99], v[170:173], 0
v_mfma_f32_16x16x32_bf16 v[52:55], v[100:103], v[170:173], 0
v_mfma_f32_16x16x32_bf16 v[56:59], v[104:107], v[170:173], 0
v_mfma_f32_16x16x32_bf16 v[60:63], v[108:111], v[170:173], 0
v_mfma_f32_16x16x32_bf16 v[64:67], v[112:115], v[170:173], 0
v_mfma_f32_16x16x32_bf16 v[68:71], v[116:119], v[170:173], 0
v_mfma_f32_16x16x32_bf16 v[72:75], v[120:123], v[170:173], 0
v_mfma_f32_16x16x16_bf16 v[180:183], v[176:177], v[168:169], v[180:183]
v_mfma_f32_16x16x16_bf16 v[184:187], v[176:177], v[174:175], v[184:187]
v_mfma_f32_16x16x16_bf16 v[12:15], v[124:125], v[168:169], v[12:15]
v_mfma_f32_16x16x16_bf16 v[16:19], v[126:127], v[168:169], v[16:19]
v_mfma_f32_16x16x16_bf16 v[20:23], v[128:129], v[168:169], v[20:23]
v_mfma_f32_16x16x16_bf16 v[24:27], v[130:131], v[168:169], v[24:27]
v_mfma_f32_16x16x16_bf16 v[28:31], v[132:133], v[168:169], v[28:31]
v_mfma_f32_16x16x16_bf16 v[32:35], v[134:135], v[168:169], v[32:35]
v_mfma_f32_16x16x16_bf16 v[36:39], v[136:137], v[168:169], v[36:39]
v_mfma_f32_16x16x16_bf16 v[40:43], v[138:139], v[168:169], v[40:43]
v_mfma_f32_16x16x16_bf16 v[44:47], v[124:125], v[174:175], v[44:47]
v_mfma_f32_16x16x16_bf16 v[48:51], v[126:127], v[174:175], v[48:51]
v_mfma_f32_16x16x16_bf16 v[52:55], v[128:129], v[174:175], v[52:55]
v_mfma_f32_16x16x16_bf16 v[56:59], v[130:131], v[174:175], v[56:59]
v_mfma_f32_16x16x16_bf16 v[60:63], v[132:133], v[174:175], v[60:63]
v_mfma_f32_16x16x16_bf16 v[64:67], v[134:135], v[174:175], v[64:67]
v_mfma_f32_16x16x16_bf16 v[68:71], v[136:137], v[174:175], v[68:71]
v_mfma_f32_16x16x16_bf16 v[72:75], v[138:139], v[174:175], v[72:75]
v_rcp_f32 v180, v180
v_rcp_f32 v184, v184
s_nop 0
v_mul_f32 v180, v180, v10
v_mul_f32 v184, v184, v11
s_nop 3
v_pk_mul_f32 v[12:13], v[12:13], v[180:181] op_sel_hi:[1,0]
v_pk_mul_f32 v[14:15], v[14:15], v[180:181] op_sel_hi:[1,0]
v_pk_mul_f32 v[16:17], v[16:17], v[180:181] op_sel_hi:[1,0]
v_pk_mul_f32 v[18:19], v[18:19], v[180:181] op_sel_hi:[1,0]
v_cvt_pk_bf16_f32 v140, v12, v13
v_cvt_pk_bf16_f32 v141, v14, v15
v_cvt_pk_bf16_f32 v142, v16, v17
v_cvt_pk_bf16_f32 v143, v18, v19
v_pk_mul_f32 v[20:21], v[20:21], v[180:181] op_sel_hi:[1,0]
v_pk_mul_f32 v[22:23], v[22:23], v[180:181] op_sel_hi:[1,0]
v_pk_mul_f32 v[24:25], v[24:25], v[180:181] op_sel_hi:[1,0]
v_pk_mul_f32 v[26:27], v[26:27], v[180:181] op_sel_hi:[1,0]
v_cvt_pk_bf16_f32 v144, v20, v21
v_cvt_pk_bf16_f32 v145, v22, v23
v_cvt_pk_bf16_f32 v146, v24, v25
v_cvt_pk_bf16_f32 v147, v26, v27
v_pk_mul_f32 v[28:29], v[28:29], v[180:181] op_sel_hi:[1,0]
v_pk_mul_f32 v[30:31], v[30:31], v[180:181] op_sel_hi:[1,0]
v_pk_mul_f32 v[32:33], v[32:33], v[180:181] op_sel_hi:[1,0]
v_pk_mul_f32 v[34:35], v[34:35], v[180:181] op_sel_hi:[1,0]
v_cvt_pk_bf16_f32 v148, v28, v29
v_cvt_pk_bf16_f32 v149, v30, v31
v_cvt_pk_bf16_f32 v150, v32, v33
v_cvt_pk_bf16_f32 v151, v34, v35
v_pk_mul_f32 v[36:37], v[36:37], v[180:181] op_sel_hi:[1,0]
v_pk_mul_f32 v[38:39], v[38:39], v[180:181] op_sel_hi:[1,0]
v_pk_mul_f32 v[40:41], v[40:41], v[180:181] op_sel_hi:[1,0]
v_pk_mul_f32 v[42:43], v[42:43], v[180:181] op_sel_hi:[1,0]
v_cvt_pk_bf16_f32 v152, v36, v37
v_cvt_pk_bf16_f32 v153, v38, v39
v_cvt_pk_bf16_f32 v154, v40, v41
v_cvt_pk_bf16_f32 v155, v42, v43
v_pk_mul_f32 v[44:45], v[44:45], v[184:185] op_sel_hi:[1,0]
v_pk_mul_f32 v[46:47], v[46:47], v[184:185] op_sel_hi:[1,0]
v_pk_mul_f32 v[48:49], v[48:49], v[184:185] op_sel_hi:[1,0]
v_pk_mul_f32 v[50:51], v[50:51], v[184:185] op_sel_hi:[1,0]
v_cvt_pk_bf16_f32 v156, v44, v45
v_cvt_pk_bf16_f32 v157, v46, v47
v_cvt_pk_bf16_f32 v158, v48, v49
v_cvt_pk_bf16_f32 v159, v50, v51
v_pk_mul_f32 v[52:53], v[52:53], v[184:185] op_sel_hi:[1,0]
v_pk_mul_f32 v[54:55], v[54:55], v[184:185] op_sel_hi:[1,0]
v_pk_mul_f32 v[56:57], v[56:57], v[184:185] op_sel_hi:[1,0]
v_pk_mul_f32 v[58:59], v[58:59], v[184:185] op_sel_hi:[1,0]
v_cvt_pk_bf16_f32 v160, v52, v53
v_cvt_pk_bf16_f32 v161, v54, v55
v_cvt_pk_bf16_f32 v162, v56, v57
v_cvt_pk_bf16_f32 v163, v58, v59
v_pk_mul_f32 v[60:61], v[60:61], v[184:185] op_sel_hi:[1,0]
v_pk_mul_f32 v[62:63], v[62:63], v[184:185] op_sel_hi:[1,0]
v_pk_mul_f32 v[64:65], v[64:65], v[184:185] op_sel_hi:[1,0]
v_pk_mul_f32 v[66:67], v[66:67], v[184:185] op_sel_hi:[1,0]
v_cvt_pk_bf16_f32 v164, v60, v61
v_cvt_pk_bf16_f32 v165, v62, v63
v_cvt_pk_bf16_f32 v166, v64, v65
v_cvt_pk_bf16_f32 v167, v66, v67
v_pk_mul_f32 v[68:69], v[68:69], v[184:185] op_sel_hi:[1,0]
v_pk_mul_f32 v[70:71], v[70:71], v[184:185] op_sel_hi:[1,0]
v_pk_mul_f32 v[72:73], v[72:73], v[184:185] op_sel_hi:[1,0]
v_pk_mul_f32 v[74:75], v[74:75], v[184:185] op_sel_hi:[1,0]
v_cvt_pk_bf16_f32 v168, v68, v69
v_cvt_pk_bf16_f32 v169, v70, v71
v_cvt_pk_bf16_f32 v170, v72, v73
v_cvt_pk_bf16_f32 v171, v74, v75
s_ff1_i32_b64 s88, s[76:77]
s_bitset0_b64 s[76:77], s88
s_lshl_b32 s71, s88, 2
s_add_u32 s71, s71, 63243264
s_lshl_b32 s72, s86, 2
s_add_u32 s72, s72, s68
s_lshl_b32 s72, s72, 2
s_add_u32 s72, s72, 63242240
buffer_load_dword v8, v188, s[60:63], s72 offen sc1
buffer_load_dword v9, v188, s[60:63], s71 offen sc1
buffer_load_dwordx2 v[10:11], v188, s[56:59], 0 offen offset:160 sc1
ds_read_b64 v[172:173], v190 offset:0
ds_read_b64 v[174:175], v190 offset:512
ds_read_b64 v[176:177], v190 offset:1024
ds_read_b64 v[178:179], v190 offset:1536
s_lshl_b32 s71, s65, 15
v_add_u32 v1, s71, v189
s_lshl_b32 s71, s65, 13
v_add_u32 v2, s71, v189
v_add_u32 v3, 0x10000, v2
s_waitcnt lgkmcnt(0)
v_mfma_f32_16x16x32_bf16 v[12:15], a[0:3], v[140:143], 0
v_mfma_f32_16x16x32_bf16 v[16:19], a[0:3], v[156:159], 0
v_mfma_f32_16x16x32_bf16 v[20:23], a[16:19], v[140:143], 0
v_mfma_f32_16x16x32_bf16 v[24:27], a[16:19], v[156:159], 0
v_mfma_f32_16x16x32_bf16 v[28:31], a[32:35], v[140:143], 0
v_mfma_f32_16x16x32_bf16 v[32:35], a[32:35], v[156:159], 0
v_mfma_f32_16x16x32_bf16 v[36:39], a[48:51], v[140:143], 0
v_mfma_f32_16x16x32_bf16 v[40:43], a[48:51], v[156:159], 0
v_mfma_f32_16x16x32_bf16 v[44:47], a[64:67], v[140:143], 0
v_mfma_f32_16x16x32_bf16 v[48:51], a[64:67], v[156:159], 0
v_mfma_f32_16x16x32_bf16 v[52:55], a[80:83], v[140:143], 0
v_mfma_f32_16x16x32_bf16 v[56:59], a[80:83], v[156:159], 0
v_mfma_f32_16x16x32_bf16 v[60:63], a[96:99], v[140:143], 0
v_mfma_f32_16x16x32_bf16 v[64:67], a[96:99], v[156:159], 0
v_mfma_f32_16x16x32_bf16 v[68:71], a[112:115], v[140:143], 0
v_mfma_f32_16x16x32_bf16 v[72:75], a[112:115], v[156:159], 0
v_mfma_f32_16x16x32_bf16 v[12:15], a[4:7], v[144:147], v[12:15]
v_mfma_f32_16x16x32_bf16 v[16:19], a[4:7], v[160:163], v[16:19]
v_mfma_f32_16x16x32_bf16 v[20:23], a[20:23], v[144:147], v[20:23]
v_mfma_f32_16x16x32_bf16 v[24:27], a[20:23], v[160:163], v[24:27]
v_mfma_f32_16x16x32_bf16 v[28:31], a[36:39], v[144:147], v[28:31]
v_mfma_f32_16x16x32_bf16 v[32:35], a[36:39], v[160:163], v[32:35]
v_mfma_f32_16x16x32_bf16 v[36:39], a[52:55], v[144:147], v[36:39]
v_mfma_f32_16x16x32_bf16 v[40:43], a[52:55], v[160:163], v[40:43]
v_mfma_f32_16x16x32_bf16 v[44:47], a[68:71], v[144:147], v[44:47]
v_mfma_f32_16x16x32_bf16 v[48:51], a[68:71], v[160:163], v[48:51]
v_mfma_f32_16x16x32_bf16 v[52:55], a[84:87], v[144:147], v[52:55]
v_mfma_f32_16x16x32_bf16 v[56:59], a[84:87], v[160:163], v[56:59]
v_mfma_f32_16x16x32_bf16 v[60:63], a[100:103], v[144:147], v[60:63]
v_mfma_f32_16x16x32_bf16 v[64:67], a[100:103], v[160:163], v[64:67]
v_mfma_f32_16x16x32_bf16 v[68:71], a[116:119], v[144:147], v[68:71]
v_mfma_f32_16x16x32_bf16 v[72:75], a[116:119], v[160:163], v[72:75]
v_mfma_f32_16x16x32_bf16 v[12:15], a[8:11], v[148:151], v[12:15]
v_mfma_f32_16x16x32_bf16 v[16:19], a[8:11], v[164:167], v[16:19]
v_mfma_f32_16x16x32_bf16 v[20:23], a[24:27], v[148:151], v[20:23]
v_mfma_f32_16x16x32_bf16 v[24:27], a[24:27], v[164:167], v[24:27]
v_mfma_f32_16x16x32_bf16 v[28:31], a[40:43], v[148:151], v[28:31]
v_mfma_f32_16x16x32_bf16 v[32:35], a[40:43], v[164:167], v[32:35]
v_mfma_f32_16x16x32_bf16 v[36:39], a[56:59], v[148:151], v[36:39]
v_mfma_f32_16x16x32_bf16 v[40:43], a[56:59], v[164:167], v[40:43]
v_mfma_f32_16x16x32_bf16 v[44:47], a[72:75], v[148:151], v[44:47]
v_mfma_f32_16x16x32_bf16 v[48:51], a[72:75], v[164:167], v[48:51]
v_mfma_f32_16x16x32_bf16 v[52:55], a[88:91], v[148:151], v[52:55]
v_mfma_f32_16x16x32_bf16 v[56:59], a[88:91], v[164:167], v[56:59]
v_mfma_f32_16x16x32_bf16 v[60:63], a[104:107], v[148:151], v[60:63]
v_mfma_f32_16x16x32_bf16 v[64:67], a[104:107], v[164:167], v[64:67]
v_mfma_f32_16x16x32_bf16 v[68:71], a[120:123], v[148:151], v[68:71]
v_mfma_f32_16x16x32_bf16 v[72:75], a[120:123], v[164:167], v[72:75]
v_mfma_f32_16x16x32_bf16 v[12:15], a[12:15], v[152:155], v[12:15]
v_mfma_f32_16x16x32_bf16 v[16:19], a[12:15], v[168:171], v[16:19]
v_mfma_f32_16x16x32_bf16 v[20:23], a[28:31], v[152:155], v[20:23]
v_mfma_f32_16x16x32_bf16 v[24:27], a[28:31], v[168:171], v[24:27]
v_mfma_f32_16x16x32_bf16 v[28:31], a[44:47], v[152:155], v[28:31]
v_mfma_f32_16x16x32_bf16 v[32:35], a[44:47], v[168:171], v[32:35]
v_mfma_f32_16x16x32_bf16 v[36:39], a[60:63], v[152:155], v[36:39]
v_mfma_f32_16x16x32_bf16 v[40:43], a[60:63], v[168:171], v[40:43]
v_mfma_f32_16x16x32_bf16 v[44:47], a[76:79], v[152:155], v[44:47]
v_mfma_f32_16x16x32_bf16 v[48:51], a[76:79], v[168:171], v[48:51]
v_mfma_f32_16x16x32_bf16 v[52:55], a[92:95], v[152:155], v[52:55]
v_mfma_f32_16x16x32_bf16 v[56:59], a[92:95], v[168:171], v[56:59]
v_mfma_f32_16x16x32_bf16 v[60:63], a[108:111], v[152:155], v[60:63]
v_mfma_f32_16x16x32_bf16 v[64:67], a[108:111], v[168:171], v[64:67]
v_mfma_f32_16x16x32_bf16 v[68:71], a[124:127], v[152:155], v[68:71]
v_mfma_f32_16x16x32_bf16 v[72:75], a[124:127], v[168:171], v[72:75]
v_mfma_f32_16x16x32_bf16 v[12:15], v[192:195], v[172:175], v[12:15]
v_mfma_f32_16x16x32_bf16 v[16:19], v[192:195], v[176:179], v[16:19]
v_mfma_f32_16x16x32_bf16 v[20:23], v[196:199], v[172:175], v[20:23]
v_mfma_f32_16x16x32_bf16 v[24:27], v[196:199], v[176:179], v[24:27]
v_mfma_f32_16x16x32_bf16 v[28:31], v[200:203], v[172:175], v[28:31]
v_mfma_f32_16x16x32_bf16 v[32:35], v[200:203], v[176:179], v[32:35]
v_mfma_f32_16x16x32_bf16 v[36:39], v[204:207], v[172:175], v[36:39]
v_mfma_f32_16x16x32_bf16 v[40:43], v[204:207], v[176:179], v[40:43]
v_mfma_f32_16x16x32_bf16 v[44:47], v[208:211], v[172:175], v[44:47]
v_mfma_f32_16x16x32_bf16 v[48:51], v[208:211], v[176:179], v[48:51]
v_mfma_f32_16x16x32_bf16 v[52:55], v[212:215], v[172:175], v[52:55]
v_mfma_f32_16x16x32_bf16 v[56:59], v[212:215], v[176:179], v[56:59]
v_mfma_f32_16x16x32_bf16 v[60:63], v[216:219], v[172:175], v[60:63]
v_mfma_f32_16x16x32_bf16 v[64:67], v[216:219], v[176:179], v[64:67]
v_mfma_f32_16x16x32_bf16 v[68:71], v[220:223], v[172:175], v[68:71]
v_mfma_f32_16x16x32_bf16 v[72:75], v[220:223], v[176:179], v[72:75]
v_mfma_f32_16x16x32_bf16 v[76:79], a[128:131], v[140:143], 0
v_mfma_f32_16x16x32_bf16 v[80:83], a[128:131], v[156:159], 0
v_mfma_f32_16x16x32_bf16 v[84:87], a[144:147], v[140:143], 0
v_mfma_f32_16x16x32_bf16 v[88:91], a[144:147], v[156:159], 0
v_mfma_f32_16x16x32_bf16 v[92:95], a[160:163], v[140:143], 0
v_mfma_f32_16x16x32_bf16 v[96:99], a[160:163], v[156:159], 0
v_mfma_f32_16x16x32_bf16 v[100:103], a[176:179], v[140:143], 0
v_mfma_f32_16x16x32_bf16 v[104:107], a[176:179], v[156:159], 0
v_mfma_f32_16x16x32_bf16 v[108:111], a[192:195], v[140:143], 0
v_mfma_f32_16x16x32_bf16 v[112:115], a[192:195], v[156:159], 0
v_mfma_f32_16x16x32_bf16 v[116:119], a[208:211], v[140:143], 0
v_mfma_f32_16x16x32_bf16 v[120:123], a[208:211], v[156:159], 0
v_mfma_f32_16x16x32_bf16 v[124:127], a[224:227], v[140:143], 0
v_mfma_f32_16x16x32_bf16 v[128:131], a[224:227], v[156:159], 0
v_mfma_f32_16x16x32_bf16 v[132:135], a[240:243], v[140:143], 0
v_mfma_f32_16x16x32_bf16 v[136:139], a[240:243], v[156:159], 0
v_mfma_f32_16x16x32_bf16 v[76:79], a[132:135], v[144:147], v[76:79]
v_mfma_f32_16x16x32_bf16 v[80:83], a[132:135], v[160:163], v[80:83]
ds_write_b128 v1, v[12:15] offset:0
v_mfma_f32_16x16x32_bf16 v[84:87], a[148:151], v[144:147], v[84:87]
v_mfma_f32_16x16x32_bf16 v[88:91], a[148:151], v[160:163], v[88:91]
ds_write_b128 v1, v[16:19] offset:1024
v_mfma_f32_16x16x32_bf16 v[92:95], a[164:167], v[144:147], v[92:95]
v_mfma_f32_16x16x32_bf16 v[96:99], a[164:167], v[160:163], v[96:99]
ds_write_b128 v1, v[20:23] offset:2048
v_mfma_f32_16x16x32_bf16 v[100:103], a[180:183], v[144:147], v[100:103]
v_mfma_f32_16x16x32_bf16 v[104:107], a[180:183], v[160:163], v[104:107]
ds_write_b128 v1, v[24:27] offset:3072
v_mfma_f32_16x16x32_bf16 v[108:111], a[196:199], v[144:147], v[108:111]
v_mfma_f32_16x16x32_bf16 v[112:115], a[196:199], v[160:163], v[112:115]
ds_write_b128 v1, v[28:31] offset:4096
v_mfma_f32_16x16x32_bf16 v[116:119], a[212:215], v[144:147], v[116:119]
v_mfma_f32_16x16x32_bf16 v[120:123], a[212:215], v[160:163], v[120:123]
ds_write_b128 v1, v[32:35] offset:5120
v_mfma_f32_16x16x32_bf16 v[124:127], a[228:231], v[144:147], v[124:127]
v_mfma_f32_16x16x32_bf16 v[128:131], a[228:231], v[160:163], v[128:131]
ds_write_b128 v1, v[36:39] offset:6144
v_mfma_f32_16x16x32_bf16 v[132:135], a[244:247], v[144:147], v[132:135]
v_mfma_f32_16x16x32_bf16 v[136:139], a[244:247], v[160:163], v[136:139]
ds_write_b128 v1, v[40:43] offset:7168
v_mfma_f32_16x16x32_bf16 v[76:79], a[136:139], v[148:151], v[76:79]
v_mfma_f32_16x16x32_bf16 v[80:83], a[136:139], v[164:167], v[80:83]
ds_write_b128 v1, v[44:47] offset:8192
v_mfma_f32_16x16x32_bf16 v[84:87], a[152:155], v[148:151], v[84:87]
v_mfma_f32_16x16x32_bf16 v[88:91], a[152:155], v[164:167], v[88:91]
ds_write_b128 v1, v[48:51] offset:9216
v_mfma_f32_16x16x32_bf16 v[92:95], a[168:171], v[148:151], v[92:95]
v_mfma_f32_16x16x32_bf16 v[96:99], a[168:171], v[164:167], v[96:99]
ds_write_b128 v1, v[52:55] offset:10240
v_mfma_f32_16x16x32_bf16 v[100:103], a[184:187], v[148:151], v[100:103]
v_mfma_f32_16x16x32_bf16 v[104:107], a[184:187], v[164:167], v[104:107]
ds_write_b128 v1, v[56:59] offset:11264
v_mfma_f32_16x16x32_bf16 v[108:111], a[200:203], v[148:151], v[108:111]
v_mfma_f32_16x16x32_bf16 v[112:115], a[200:203], v[164:167], v[112:115]
ds_write_b128 v1, v[60:63] offset:12288
v_mfma_f32_16x16x32_bf16 v[116:119], a[216:219], v[148:151], v[116:119]
v_mfma_f32_16x16x32_bf16 v[120:123], a[216:219], v[164:167], v[120:123]
ds_write_b128 v1, v[64:67] offset:13312
v_mfma_f32_16x16x32_bf16 v[124:127], a[232:235], v[148:151], v[124:127]
v_mfma_f32_16x16x32_bf16 v[128:131], a[232:235], v[164:167], v[128:131]
ds_write_b128 v1, v[68:71] offset:14336
v_mfma_f32_16x16x32_bf16 v[132:135], a[248:251], v[148:151], v[132:135]
v_mfma_f32_16x16x32_bf16 v[136:139], a[248:251], v[164:167], v[136:139]
ds_write_b128 v1, v[72:75] offset:15360
v_mfma_f32_16x16x32_bf16 v[76:79], a[140:143], v[152:155], v[76:79]
v_mfma_f32_16x16x32_bf16 v[80:83], a[140:143], v[168:171], v[80:83]
v_mfma_f32_16x16x32_bf16 v[84:87], a[156:159], v[152:155], v[84:87]
v_mfma_f32_16x16x32_bf16 v[88:91], a[156:159], v[168:171], v[88:91]
v_mfma_f32_16x16x32_bf16 v[92:95], a[172:175], v[152:155], v[92:95]
v_mfma_f32_16x16x32_bf16 v[96:99], a[172:175], v[168:171], v[96:99]
v_mfma_f32_16x16x32_bf16 v[100:103], a[188:191], v[152:155], v[100:103]
v_mfma_f32_16x16x32_bf16 v[104:107], a[188:191], v[168:171], v[104:107]
v_mfma_f32_16x16x32_bf16 v[108:111], a[204:207], v[152:155], v[108:111]
v_mfma_f32_16x16x32_bf16 v[112:115], a[204:207], v[168:171], v[112:115]
v_mfma_f32_16x16x32_bf16 v[116:119], a[220:223], v[152:155], v[116:119]
v_mfma_f32_16x16x32_bf16 v[120:123], a[220:223], v[168:171], v[120:123]
v_mfma_f32_16x16x32_bf16 v[124:127], a[236:239], v[152:155], v[124:127]
v_mfma_f32_16x16x32_bf16 v[128:131], a[236:239], v[168:171], v[128:131]
v_mfma_f32_16x16x32_bf16 v[132:135], a[252:255], v[152:155], v[132:135]
v_mfma_f32_16x16x32_bf16 v[136:139], a[252:255], v[168:171], v[136:139]
v_mfma_f32_16x16x32_bf16 v[76:79], v[224:227], v[172:175], v[76:79]
v_mfma_f32_16x16x32_bf16 v[80:83], v[224:227], v[176:179], v[80:83]
v_mfma_f32_16x16x32_bf16 v[84:87], v[228:231], v[172:175], v[84:87]
v_mfma_f32_16x16x32_bf16 v[88:91], v[228:231], v[176:179], v[88:91]
v_mfma_f32_16x16x32_bf16 v[92:95], v[232:235], v[172:175], v[92:95]
v_mfma_f32_16x16x32_bf16 v[96:99], v[232:235], v[176:179], v[96:99]
v_mfma_f32_16x16x32_bf16 v[100:103], v[236:239], v[172:175], v[100:103]
v_mfma_f32_16x16x32_bf16 v[104:107], v[236:239], v[176:179], v[104:107]
v_mfma_f32_16x16x32_bf16 v[108:111], v[240:243], v[172:175], v[108:111]
v_mfma_f32_16x16x32_bf16 v[112:115], v[240:243], v[176:179], v[112:115]
v_mfma_f32_16x16x32_bf16 v[116:119], v[244:247], v[172:175], v[116:119]
v_mfma_f32_16x16x32_bf16 v[120:123], v[244:247], v[176:179], v[120:123]
v_mfma_f32_16x16x32_bf16 v[124:127], v[248:251], v[172:175], v[124:127]
v_mfma_f32_16x16x32_bf16 v[128:131], v[248:251], v[176:179], v[128:131]
v_mfma_f32_16x16x32_bf16 v[132:135], v[252:255], v[172:175], v[132:135]
v_mfma_f32_16x16x32_bf16 v[136:139], v[252:255], v[176:179], v[136:139]
ds_write_b128 v1, v[76:79] offset:16384
ds_write_b128 v1, v[80:83] offset:17408
ds_write_b128 v1, v[84:87] offset:18432
ds_write_b128 v1, v[88:91] offset:19456
ds_write_b128 v1, v[92:95] offset:20480
ds_write_b128 v1, v[96:99] offset:21504
ds_write_b128 v1, v[100:103] offset:22528
ds_write_b128 v1, v[104:107] offset:23552
ds_write_b128 v1, v[108:111] offset:24576
ds_write_b128 v1, v[112:115] offset:25600
ds_write_b128 v1, v[116:119] offset:26624
ds_write_b128 v1, v[120:123] offset:27648
ds_write_b128 v1, v[124:127] offset:28672
ds_write_b128 v1, v[128:131] offset:29696
ds_write_b128 v1, v[132:135] offset:30720
ds_write_b128 v1, v[136:139] offset:31744
s_waitcnt vmcnt(0)
v_readfirstlane_b32 s71, v9
v_readfirstlane_b32 s72, v10
s_add_u32 s87, s88, 2
s_cmp_ge_u32 s72, s87
s_cselect_b32 s71, s71, 0
s_cmp_ge_u32 s71, 4
s_cselect_b32 s71, 1, 0
v_mov_b32 v9, s71
v_readfirstlane_b32 s71, v8
s_lshl_b32 s87, s65, 2
s_add_u32 s87, s87, 147456
v_mov_b32 v10, s87
ds_write_b32 v10, v9
s_cmp_eq_u32 s86, -1
s_cbranch_scc1 Lz_64
s_cmp_ge_u32 s71, 8
s_cbranch_scc1 Lz_65
s_lshl_b32 s87, s86, 2
s_add_u32 s87, s87, s68
s_lshl_b32 s87, s87, 2
s_add_u32 s87, s87, 63242240
s_mov_b32 s78, 0
Lz_66:
buffer_load_dword v3, v188, s[60:63], s87 offen sc1
s_waitcnt vmcnt(0)
s_add_u32 s78, s78, 1
s_cmp_gt_u32 s78, 0x40000
s_cbranch_scc1 Lz_67
v_readfirstlane_b32 s71, v3
s_cmp_ge_u32 s71, 8
s_cbranch_scc1 Lz_67
s_sleep 12
s_branch Lz_66
Lz_67:
v_add_u32 v3, 0x10000, v2
Lz_65:
s_lshl_b32 s80, s86, 2
s_add_u32 s80, s80, s68
s_lshl_b32 s80, s80, 18
s_lshl_b32 s81, s69, 2
s_add_u32 s81, s81, s65
s_lshl_b32 s82, s81, 10
s_add_u32 s80, s80, s82
s_add_u32 s80, s80, 150994944
buffer_load_dwordx4 v[140:143], v189, s[60:63], s80 offen sc1
s_add_u32 s80, s80, 32768
buffer_load_dwordx4 v[144:147], v189, s[60:63], s80 offen sc1
s_add_u32 s80, s80, 32768
buffer_load_dwordx4 v[148:151], v189, s[60:63], s80 offen sc1
s_add_u32 s80, s80, 32768
buffer_load_dwordx4 v[152:155], v189, s[60:63], s80 offen sc1
s_add_u32 s80, s80, 32768
buffer_load_dwordx4 v[156:159], v189, s[60:63], s80 offen sc1
s_add_u32 s80, s80, 32768
buffer_load_dwordx4 v[160:163], v189, s[60:63], s80 offen sc1
s_add_u32 s80, s80, 32768
buffer_load_dwordx4 v[164:167], v189, s[60:63], s80 offen sc1
s_add_u32 s80, s80, 32768
buffer_load_dwordx4 v[168:171], v189, s[60:63], s80 offen sc1
s_add_u32 s80, s80, 32768
s_lshl_b32 s87, s86, 16
s_and_b32 s82, s81, 1
s_lshl_b32 s82, s82, 15
s_add_u32 s87, s87, s82
s_lshr_b32 s81, s81, 1
s_lshl_b32 s81, s81, 5
s_add_u32 s87, s87, s81
s_lshl_b32 s81, s68, 9
s_add_u32 s87, s87, s81
Lz_64:
s_lshl_b32 s80, s66, 2
s_add_u32 s80, s80, s68
s_lshl_b32 s80, s80, 3
s_add_u32 s80, s80, s69
s_lshl_b32 s80, s80, 2
s_add_u32 s80, s80, s65
s_lshl_b32 s80, s80, 13
s_add_u32 s80, s80, 150994944
s_add_u32 s82, s80, 4096
v_mov_b32 v10, 147456
s_waitcnt lgkmcnt(0)
s_barrier
ds_read_b128 v[4:7], v10
ds_read_b128 v[12:15], v2 offset:0
ds_read_b128 v[16:19], v2 offset:32768
ds_read_b128 v[20:23], v3 offset:0
ds_read_b128 v[24:27], v3 offset:32768
ds_read_b128 v[28:31], v2 offset:1024
ds_read_b128 v[32:35], v2 offset:33792
ds_read_b128 v[36:39], v3 offset:1024
ds_read_b128 v[40:43], v3 offset:33792
ds_read_b128 v[44:47], v2 offset:2048
ds_read_b128 v[48:51], v2 offset:34816
ds_read_b128 v[52:55], v3 offset:2048
ds_read_b128 v[56:59], v3 offset:34816
ds_read_b128 v[60:63], v2 offset:3072
ds_read_b128 v[64:67], v2 offset:35840
ds_read_b128 v[68:71], v3 offset:3072
ds_read_b128 v[72:75], v3 offset:35840
ds_read_b128 v[76:79], v2 offset:4096
ds_read_b128 v[80:83], v2 offset:36864
ds_read_b128 v[84:87], v3 offset:4096
ds_read_b128 v[88:91], v3 offset:36864
ds_read_b128 v[92:95], v2 offset:5120
ds_read_b128 v[96:99], v2 offset:37888
ds_read_b128 v[100:103], v3 offset:5120
ds_read_b128 v[104:107], v3 offset:37888
ds_read_b128 v[108:111], v2 offset:6144
ds_read_b128 v[112:115], v2 offset:38912
ds_read_b128 v[116:119], v3 offset:6144
ds_read_b128 v[120:123], v3 offset:38912
ds_read_b128 v[124:127], v2 offset:7168
ds_read_b128 v[128:131], v2 offset:39936
ds_read_b128 v[132:135], v3 offset:7168
ds_read_b128 v[136:139], v3 offset:39936
s_waitcnt lgkmcnt(15)
v_pk_add_f32 v[12:13], v[12:13], v[16:17]
v_pk_add_f32 v[14:15], v[14:15], v[18:19]
v_pk_add_f32 v[20:21], v[20:21], v[24:25]
v_pk_add_f32 v[22:23], v[22:23], v[26:27]
v_pk_add_f32 v[12:13], v[12:13], v[20:21]
v_pk_add_f32 v[14:15], v[14:15], v[22:23]
buffer_store_dwordx4 v[12:15], v189, s[60:63], s80 offen offset:0 sc1
s_waitcnt lgkmcnt(15)
v_pk_add_f32 v[28:29], v[28:29], v[32:33]
v_pk_add_f32 v[30:31], v[30:31], v[34:35]
v_pk_add_f32 v[36:37], v[36:37], v[40:41]
v_pk_add_f32 v[38:39], v[38:39], v[42:43]
v_pk_add_f32 v[28:29], v[28:29], v[36:37]
v_pk_add_f32 v[30:31], v[30:31], v[38:39]
buffer_store_dwordx4 v[28:31], v189, s[60:63], s80 offen offset:1024 sc1
s_waitcnt lgkmcnt(15)
v_pk_add_f32 v[44:45], v[44:45], v[48:49]
v_pk_add_f32 v[46:47], v[46:47], v[50:51]
v_pk_add_f32 v[52:53], v[52:53], v[56:57]
v_pk_add_f32 v[54:55], v[54:55], v[58:59]
v_pk_add_f32 v[44:45], v[44:45], v[52:53]
v_pk_add_f32 v[46:47], v[46:47], v[54:55]
buffer_store_dwordx4 v[44:47], v189, s[60:63], s80 offen offset:2048 sc1
s_waitcnt lgkmcnt(15)
v_pk_add_f32 v[60:61], v[60:61], v[64:65]
v_pk_add_f32 v[62:63], v[62:63], v[66:67]
v_pk_add_f32 v[68:69], v[68:69], v[72:73]
v_pk_add_f32 v[70:71], v[70:71], v[74:75]
v_pk_add_f32 v[60:61], v[60:61], v[68:69]
v_pk_add_f32 v[62:63], v[62:63], v[70:71]
buffer_store_dwordx4 v[60:63], v189, s[60:63], s80 offen offset:3072 sc1
s_waitcnt lgkmcnt(12)
v_pk_add_f32 v[76:77], v[76:77], v[80:81]
v_pk_add_f32 v[78:79], v[78:79], v[82:83]
v_pk_add_f32 v[84:85], v[84:85], v[88:89]
v_pk_add_f32 v[86:87], v[86:87], v[90:91]
v_pk_add_f32 v[76:77], v[76:77], v[84:85]
v_pk_add_f32 v[78:79], v[78:79], v[86:87]
buffer_store_dwordx4 v[76:79], v189, s[60:63], s82 offen offset:0 sc1
s_waitcnt lgkmcnt(8)
v_pk_add_f32 v[92:93], v[92:93], v[96:97]
v_pk_add_f32 v[94:95], v[94:95], v[98:99]
v_pk_add_f32 v[100:101], v[100:101], v[104:105]
v_pk_add_f32 v[102:103], v[102:103], v[106:107]
v_pk_add_f32 v[92:93], v[92:93], v[100:101]
v_pk_add_f32 v[94:95], v[94:95], v[102:103]
buffer_store_dwordx4 v[92:95], v189, s[60:63], s82 offen offset:1024 sc1
s_waitcnt lgkmcnt(4)
v_pk_add_f32 v[108:109], v[108:109], v[112:113]
v_pk_add_f32 v[110:111], v[110:111], v[114:115]
v_pk_add_f32 v[116:117], v[116:117], v[120:121]
v_pk_add_f32 v[118:119], v[118:119], v[122:123]
v_pk_add_f32 v[108:109], v[108:109], v[116:117]
v_pk_add_f32 v[110:111], v[110:111], v[118:119]
buffer_store_dwordx4 v[108:111], v189, s[60:63], s82 offen offset:2048 sc1
s_waitcnt lgkmcnt(0)
v_pk_add_f32 v[124:125], v[124:125], v[128:129]
v_pk_add_f32 v[126:127], v[126:127], v[130:131]
v_pk_add_f32 v[132:133], v[132:133], v[136:137]
v_pk_add_f32 v[134:135], v[134:135], v[138:139]
v_pk_add_f32 v[124:125], v[124:125], v[132:133]
v_pk_add_f32 v[126:127], v[126:127], v[134:135]
buffer_store_dwordx4 v[124:127], v189, s[60:63], s82 offen offset:3072 sc1
v_and_b32 v4, v4, v5
v_and_b32 v6, v6, v7
v_and_b32 v4, v4, v6
s_cmp_eq_u32 s86, -1
v_readfirstlane_b32 s91, v4
s_cbranch_scc1 Lz_68
s_waitcnt vmcnt(8)
v_pk_add_f32 v[140:141], v[140:141], v[144:145]
v_pk_add_f32 v[142:143], v[142:143], v[146:147]
v_pk_add_f32 v[148:149], v[148:149], v[152:153]
v_pk_add_f32 v[150:151], v[150:151], v[154:155]
v_pk_add_f32 v[156:157], v[156:157], v[160:161]
v_pk_add_f32 v[158:159], v[158:159], v[162:163]
v_pk_add_f32 v[164:165], v[164:165], v[168:169]
v_pk_add_f32 v[166:167], v[166:167], v[170:171]
v_pk_add_f32 v[140:141], v[140:141], v[148:149]
v_pk_add_f32 v[142:143], v[142:143], v[150:151]
v_pk_add_f32 v[156:157], v[156:157], v[164:165]
v_pk_add_f32 v[158:159], v[158:159], v[166:167]
v_pk_add_f32 v[140:141], v[140:141], v[156:157]
v_pk_add_f32 v[142:143], v[142:143], v[158:159]
v_cvt_pk_bf16_f32 v140, v140, v141
v_cvt_pk_bf16_f32 v141, v142, v143
buffer_store_dwordx2 v[140:141], v191, s[52:55], s87 offen
Lz_68:
s_mov_b32 s86, s66
s_mov_b32 s66, s88
s_cmp_lg_u32 s66, -1
s_cbranch_scc1 L_z_seg
s_mov_b32 s78, 0
L_z_last:
s_lshl_b32 s80, s86, 2
s_add_u32 s80, s80, s68
s_lshl_b32 s80, s80, 18
s_lshl_b32 s81, s69, 2
s_add_u32 s81, s81, s65
s_lshl_b32 s82, s81, 10
s_add_u32 s80, s80, s82
s_add_u32 s80, s80, 150994944
buffer_load_dwordx4 v[140:143], v189, s[60:63], s80 offen sc1
s_add_u32 s80, s80, 32768
buffer_load_dwordx4 v[144:147], v189, s[60:63], s80 offen sc1
s_add_u32 s80, s80, 32768
buffer_load_dwordx4 v[148:151], v189, s[60:63], s80 offen sc1
s_add_u32 s80, s80, 32768
buffer_load_dwordx4 v[152:155], v189, s[60:63], s80 offen sc1
s_add_u32 s80, s80, 32768
buffer_load_dwordx4 v[156:159], v189, s[60:63], s80 offen sc1
s_add_u32 s80, s80, 32768
buffer_load_dwordx4 v[160:163], v189, s[60:63], s80 offen sc1
s_add_u32 s80, s80, 32768
buffer_load_dwordx4 v[164:167], v189, s[60:63], s80 offen sc1
s_add_u32 s80, s80, 32768
buffer_load_dwordx4 v[168:171], v189, s[60:63], s80 offen sc1
s_add_u32 s80, s80, 32768
s_lshl_b32 s87, s86, 16
s_and_b32 s82, s81, 1
s_lshl_b32 s82, s82, 15
s_add_u32 s87, s87, s82
s_lshr_b32 s81, s81, 1
s_lshl_b32 s81, s81, 5
s_add_u32 s87, s87, s81
s_lshl_b32 s81, s68, 9
s_add_u32 s87, s87, s81
s_waitcnt vmcnt(0)
v_max_u32 v7, v140, v141
v_max3_u32 v7, v7, v142, v143
v_max3_u32 v7, v7, v144, v145
v_max3_u32 v7, v7, v146, v147
v_max3_u32 v7, v7, v148, v149
v_max3_u32 v7, v7, v150, v151
v_max3_u32 v7, v7, v152, v153
v_max3_u32 v7, v7, v154, v155
v_max3_u32 v7, v7, v156, v157
v_max3_u32 v7, v7, v158, v159
v_max3_u32 v7, v7, v160, v161
v_max3_u32 v7, v7, v162, v163
v_max3_u32 v7, v7, v164, v165
v_max3_u32 v7, v7, v166, v167
v_max3_u32 v7, v7, v168, v169
v_max3_u32 v7, v7, v170, v171
v_cmp_eq_u32 vcc, -1, v7
s_add_u32 s78, s78, 1
s_cmp_gt_u32 s78, 0x40000
s_cbranch_scc1 L_z_done
s_cbranch_vccnz L_z_last
L_z_done:
v_pk_add_f32 v[140:141], v[140:141], v[144:145]
v_pk_add_f32 v[142:143], v[142:143], v[146:147]
v_pk_add_f32 v[148:149], v[148:149], v[152:153]
v_pk_add_f32 v[150:151], v[150:151], v[154:155]
v_pk_add_f32 v[156:157], v[156:157], v[160:161]
v_pk_add_f32 v[158:159], v[158:159], v[162:163]
v_pk_add_f32 v[164:165], v[164:165], v[168:169]
v_pk_add_f32 v[166:167], v[166:167], v[170:171]
v_pk_add_f32 v[140:141], v[140:141], v[148:149]
v_pk_add_f32 v[142:143], v[142:143], v[150:151]
v_pk_add_f32 v[156:157], v[156:157], v[164:165]
v_pk_add_f32 v[158:159], v[158:159], v[166:167]
v_pk_add_f32 v[140:141], v[140:141], v[156:157]
v_pk_add_f32 v[142:143], v[142:143], v[158:159]
v_cvt_pk_bf16_f32 v140, v140, v141
v_cvt_pk_bf16_f32 v141, v142, v143
buffer_store_dwordx2 v[140:141], v191, s[52:55], s87 offen
L_exit:
s_endpgm
.section .rodata,"a"
.p2align 6
.amdhsa_kernel gated_mix__memory_aug_recurrent_mem_tr__grouped_kv_mqa__prompt_kernel
.amdhsa_next_free_vgpr 512
.amdhsa_next_free_sgpr 102
.amdhsa_accum_offset 256
.amdhsa_group_segment_fixed_size 0
.amdhsa_kernarg_size 128
.amdhsa_user_sgpr_count 2
.amdhsa_user_sgpr_kernarg_segment_ptr 1
.amdhsa_system_sgpr_workgroup_id_x 1
.end_amdhsa_kernel
```
